```python
import torch

def _softmax(x, axis=-1):
    return torch.softmax(x, dim=axis)
def _gelu(x):
    return torch.nn.functional.gelu(x, approximate="tanh")
def _silu(x):
    return torch.nn.functional.silu(x)
def _sigmoid(x):
    return torch.sigmoid(x)
def _layernorm(x, axis=-1, eps=1e-5):
    m = x.mean(dim=axis, keepdim=True)
    v = x.var(dim=axis, keepdim=True, unbiased=False)
    return (x - m) / torch.sqrt(v + eps)
def _scatter_add(tgt, idx, src, axis=0):
    return tgt.clone().index_add_(axis, idx, src)
def _segment_sum(src, seg, n):
    out = torch.zeros((n,) + src.shape[1:], dtype=src.dtype)
    return out.index_add_(0, seg, src)
def _pad(x, pw):
    flat = tuple(v for pair in reversed(pw) for v in pair)
    return torch.nn.functional.pad(x, flat)

kernel_name = 'standalone__gqa_block_cached__near_ridge'

def setup_inputs():

    _w = (lambda a: (lambda t: t.to(torch.bfloat16) if t.is_floating_point() else t)(torch.as_tensor(a)))
    B, Sq, D = 16, 64, 576
    Hq, Hkv, Sk, Dh = 32, 16, 512, 128
    assert Hq % Hkv == 0, (Hq, Hkv)
    return {
        "x": _w((lambda *s: torch.randn(*s, dtype=torch.bfloat16) * 0.8)(B, Sq, D)),
        "k_cache": _w((lambda *s: torch.randn(*s, dtype=torch.bfloat16) * 0.8)(B, Hkv, Sk, Dh)),
        "v_cache": _w((lambda *s: torch.randn(*s, dtype=torch.bfloat16) * 0.05)(B, Hkv, Sk, Dh)),
        "wq": _w((lambda *s: torch.randn(*s, dtype=torch.bfloat16) * 0.8)(D, Hq * Dh) * (D ** -0.5)),
        "wo": _w((lambda *s: torch.randn(*s, dtype=torch.bfloat16) * 0.05)(Hq * Dh, D) * ((Hq * Dh) ** -0.5)),
    }

def reference(x, k_cache, v_cache, wq, wo):
    B, Sq, D = x.shape
    Hq, Dh = 32, 128
    Hkv = k_cache.shape[1]
    rep = Hq // Hkv
    q = (lambda x, *d: x.permute(*d))((x @ wq).reshape(B, Sq, Hq, Dh), 0, 2, 1, 3)
    k = (lambda x, n, axis: torch.repeat_interleave(x, n, dim=axis))(k_cache, rep, axis=1)
    v = (lambda x, n, axis: torch.repeat_interleave(x, n, dim=axis))(v_cache, rep, axis=1)
    scores = torch.einsum("bhqd,bhkd->bhqk", q, k) * (Dh ** -0.5)
    p = _softmax(scores, axis=-1)
    o = torch.einsum("bhqk,bhkd->bhqd", p, v)
    return (lambda x, *d: x.permute(*d))(o, 0, 2, 1, 3).reshape(B, Sq, Hq * Dh) @ wo
```

```asm
; @launch grid=(256,1,1) block=(256,1,1) lds=163840
.amdgcn_target "amdgcn-amd-amdhsa--gfx950"
.text
.globl standalone__gqa_block_cached__near_ridge_kernel
.p2align 8
.type standalone__gqa_block_cached__near_ridge_kernel,@function
standalone__gqa_block_cached__near_ridge_kernel:
    s_cmp_ge_u32 s2, 256
    s_cbranch_scc1 L_end
    s_load_dwordx8 s[4:11], s[0:1], 0
    s_load_dwordx8 s[12:19], s[0:1], 32
    s_memrealtime s[100:101]
    s_getpc_b64 s[98:99]
L_pc:
    s_lshr_b32 s3, s2, 3
    v_lshl_add_u32 v9, s3, 4, v0
    v_lshlrev_b32 v9, 7, v9
    v_min_u32 v9, L_textend-L_pc-4, v9
    v_cmp_gt_u32 vcc, 16, v0
    s_nop 0
    s_and_saveexec_b64 s[20:21], vcc
    s_cbranch_execz L_nocpf
    global_load_dword v12, v9, s[98:99]
L_nocpf:
    s_mov_b64 exec, -1
    v_lshrrev_b32 v1, 6, v0
    s_lshr_b32 s46, s2, 4
    v_readfirstlane_b32 s44, v1
    s_sub_u32 s48, s46, 9
    s_cselect_b32 s3, s46, s48
    s_and_b32 s48, s2, 7
    s_add_u32 s3, s3, s48
    s_sub_u32 s48, s3, 9
    s_cselect_b32 s3, s3, s48
    s_lshl_b32 s53, s3, 19
    s_lshl_b32 s60, s3, 7
    s_mul_i32 s48, s46, 73728
    s_lshl_b32 s56, s44, 11
    v_bfe_u32 v2, v0, 3, 3
    v_and_b32 v3, 7, v0
    v_lshrrev_b32 v6, 1, v2
    v_xor_b32 v7, v3, v6
    v_lshlrev_b32 v7, 4, v7
    v_mul_u32_u24 v8, 1152, v2
    v_mul_u32_u24 v9, 18432, v1
    v_add_u32 v9, v9, v8
    v_add_u32 v96, v9, v7
    v_xor_b32 v7, 64, v7
    v_add_u32 v97, v9, v7
    v_add_u32 v97, 8192, v97
    s_and_b32 s45, s2, 7
    s_lshl_b32 s45, s45, 1
    s_bfe_u32 s52, s2, 0x10003
    s_add_u32 s45, s45, s52
    s_lshl_b32 s62, s44, 12
    s_lshl_b32 s52, s45, 9
    v_bfe_u32 v4, v0, 4, 2
    v_and_b32 v5, 15, v0
    v_lshlrev_b32 v7, 2, v4
    v_xor_b32 v7, v5, v7
    v_lshlrev_b32 v7, 4, v7
    v_lshl_add_u32 v9, v4, 13, v7
    v_lshrrev_b32 v10, 1, v1
    v_lshl_add_u32 v9, v10, 17, v9
    v_and_b32 v10, 1, v1
    v_lshl_add_u32 v100, v10, 8, v9
    v_add_u32 v101, 31744, v100
    v_add_u32 v102, 63488, v100
    v_add_u32 v103, 95232, v100
    s_waitcnt lgkmcnt(0)
    s_add_u32 s32, s10, s52
    s_addc_u32 s33, s11, 0
    s_and_b32 s33, s33, 0xffff
    s_mov_b32 s34, 4710912
    s_mov_b32 s35, 0x00020000
    s_add_u32 m0, s62, 114688
    s_nop 0
    buffer_load_dwordx4 v100, s[32:35], s53 offen lds
    buffer_load_dwordx4 v101, s[32:35], s53 offen offset:1024 lds
    buffer_load_dwordx4 v102, s[32:35], s53 offen offset:2048 lds
    buffer_load_dwordx4 v103, s[32:35], s53 offen offset:3072 lds
    s_add_u32 s53, s53, 262144
    s_sub_u32 s49, s53, 4718592
    s_cselect_b32 s53, s53, s49
    s_add_u32 m0, s62, 131072
    s_nop 0
    buffer_load_dwordx4 v100, s[32:35], s53 offen lds
    buffer_load_dwordx4 v101, s[32:35], s53 offen offset:1024 lds
    buffer_load_dwordx4 v102, s[32:35], s53 offen offset:2048 lds
    buffer_load_dwordx4 v103, s[32:35], s53 offen offset:3072 lds
    s_add_u32 s53, s53, 262144
    s_sub_u32 s49, s53, 4718592
    s_cselect_b32 s53, s53, s49
    s_add_u32 s20, s4, s48
    s_addc_u32 s21, s5, 0
    s_and_b32 s21, s21, 0xffff
    s_mov_b32 s22, 73728
    s_mov_b32 s23, 0x00020000
    s_add_u32 m0, s56, 73728
    s_nop 0
    buffer_load_dwordx4 v96, s[20:23], s60 offen lds
    buffer_load_dwordx4 v97, s[20:23], s60 offen offset:1024 lds
    s_add_u32 s60, s60, 128
    s_sub_u32 s49, s60, 1152
    s_cselect_b32 s60, s60, s49
    s_add_u32 m0, s56, 81920
    s_nop 0
    buffer_load_dwordx4 v96, s[20:23], s60 offen lds
    buffer_load_dwordx4 v97, s[20:23], s60 offen offset:1024 lds
    s_add_u32 s60, s60, 128
    s_sub_u32 s49, s60, 1152
    s_cselect_b32 s60, s60, s49
    v_lshl_add_u32 v9, v4, 8, v7
    v_lshl_add_u32 v54, v1, 11, v9
    v_xor_b32 v7, v5, v4
    v_lshlrev_b32 v7, 4, v7
    v_lshl_add_u32 v9, v4, 8, v7
    v_lshlrev_b32 v10, 7, v10
    v_xor_b32 v9, v9, v10
    v_lshl_add_u32 v52, v1, 11, v9
    v_xor_b32 v53, 64, v52
    s_mov_b32 s64, 0
    s_mov_b32 s65, 8192
    s_mov_b32 s66, 16384
    s_mov_b32 s67, 24576
    s_mov_b32 s68, 32768
    s_mov_b32 s69, 40960
    s_mov_b32 s70, 49152
    s_mov_b32 s71, 57344
    s_mov_b32 s72, 65536
    s_mov_b32 s73, 73728
    s_mov_b32 s74, 81920
    s_mov_b32 s75, 90112
    s_mov_b32 s76, 98304
    s_mov_b32 s77, 106496
    s_mov_b32 s78, 114688
    s_mov_b32 s79, 122880
    s_lshl_b32 s57, s44, 13
    s_lshr_b32 s47, s46, 1
    s_lshl_b32 s54, s47, 7
    s_lshl_b32 s63, s46, 4
    s_add_u32 s63, s63, s45
    s_lshl_b32 s3, s63, 17
    s_add_u32 s24, s6, s3
    s_addc_u32 s25, s7, 0
    s_and_b32 s25, s25, 0xffff
    s_mov_b32 s26, 131072
    s_mov_b32 s27, 0x00020000
    s_add_u32 s28, s8, s3
    s_addc_u32 s29, s9, 0
    s_and_b32 s29, s29, 0xffff
    s_mov_b32 s30, 131072
    s_mov_b32 s31, 0x00020000
    s_mov_b32 s92, s16
    s_and_b32 s93, s17, 0xffff
    s_mov_b32 s94, 256
    s_mov_b32 s95, 0x00020000
    s_cmp_lg_u32 s2, 0
    s_cbranch_scc1 L_noepoch
    v_lshlrev_b32 v9, 8, v0
    v_mov_b32 v10, s100
    v_mov_b32 v11, s101
    buffer_store_dwordx2 v[10:11], v9, s[92:95], 0 offen sc1
L_noepoch:
    s_mul_i32 s3, s45, 294912
    s_add_u32 s36, s12, s3
    s_addc_u32 s37, s13, 0
    s_and_b32 s37, s37, 0xffff
    s_mov_b32 s38, 294912
    s_mov_b32 s39, 0x00020000
    s_mul_i32 s3, s63, 73728
    s_add_u32 s40, s18, s3
    s_addc_u32 s41, s19, 0
    s_and_b32 s41, s41, 0xffff
    s_mov_b32 s42, 73728
    s_mov_b32 s43, 0x00020000
    s_mul_i32 s3, s46, 16384
    s_add_u32 s3, s3, 18874368
    s_add_u32 s80, s18, s3
    s_addc_u32 s81, s19, 0
    s_and_b32 s81, s81, 0xffff
    s_mov_b32 s82, 16384
    s_mov_b32 s83, 0x00020000
    s_mul_i32 s3, s46, 1179648
    s_add_u32 s84, s18, s3
    s_addc_u32 s85, s19, 0
    s_and_b32 s85, s85, 0xffff
    s_mov_b32 s86, 1179648
    s_mov_b32 s87, 0x00020000
    s_mul_i32 s3, s46, 73728
    s_add_u32 s88, s14, s3
    s_addc_u32 s89, s15, 0
    s_and_b32 s89, s89, 0xffff
    s_mov_b32 s90, 73728
    s_mov_b32 s91, 0x00020000
    s_mov_b32 s58, 0x3e0293ee
    s_mov_b32 s59, 0x3e0293ee
    v_bfe_u32 v9, v0, 5, 1
    v_and_b32 v10, 31, v0
    v_bfe_u32 v11, v0, 2, 2
    v_and_b32 v7, 3, v0
    v_bfe_u32 v13, v0, 4, 1
    v_and_b32 v14, 1, v1
    v_lshl_add_u32 v14, v14, 5, v10
    v_bfe_u32 v15, v14, 1, 3
    v_xor_b32 v15, v15, v9
    v_lshlrev_b32 v15, 4, v15
    v_lshl_add_u32 v80, v14, 7, v15
    v_xor_b32 v81, 32, v80
    v_xor_b32 v82, 64, v80
    v_xor_b32 v83, 96, v80
    v_add_u32 v84, 0x10000, v80
    v_add_u32 v85, 0x10000, v81
    v_add_u32 v86, 0x10000, v82
    v_add_u32 v87, 0x10000, v83
    v_lshrrev_b32 v14, 1, v1
    v_lshlrev_b32 v14, 12, v14
    v_lshl_add_u32 v14, v9, 11, v14
    v_lshl_add_u32 v14, v11, 8, v14
    v_lshl_add_u32 v14, v11, 6, v14
    v_lshl_add_u32 v14, v13, 5, v14
    v_and_b32 v15, 1, v7
    v_lshl_add_u32 v14, v15, 4, v14
    v_lshrrev_b32 v15, 1, v7
    v_lshl_add_u32 v14, v15, 3, v14
    v_add_u32 v88, 0x10000, v14
    v_xor_b32 v89, 64, v88
    v_xor_b32 v90, 128, v88
    v_xor_b32 v91, 192, v88
    v_add_u32 v92, 0x10000, v88
    v_add_u32 v93, 0x10000, v89
    v_add_u32 v94, 0x10000, v90
    v_add_u32 v95, 0x10000, v91
    v_xor_b32 v14, v9, v5
    v_lshlrev_b32 v14, 4, v14
    v_lshl_add_u32 v16, v10, 8, v14
    v_xor_b32 v17, 32, v16
    v_xor_b32 v18, 64, v16
    v_xor_b32 v19, 96, v16
    v_xor_b32 v20, 128, v16
    v_xor_b32 v21, 160, v16
    v_xor_b32 v22, 192, v16
    v_xor_b32 v23, 224, v16
    v_add_u32 v24, 65536, v16
    v_add_u32 v25, 65536, v17
    v_add_u32 v26, 65536, v18
    v_add_u32 v27, 65536, v19
    v_add_u32 v28, 65536, v20
    v_add_u32 v29, 65536, v21
    v_add_u32 v30, 65536, v22
    v_add_u32 v31, 65536, v23
    v_add_u32 v32, 131072, v16
    v_add_u32 v33, 131072, v17
    v_add_u32 v34, 131072, v18
    v_add_u32 v35, 131072, v19
    v_add_u32 v36, 131072, v20
    v_add_u32 v37, 131072, v21
    v_add_u32 v38, 131072, v22
    v_add_u32 v39, 131072, v23
    v_lshlrev_b32 v14, 10, v9
    v_lshl_add_u32 v14, v11, 8, v14
    v_lshl_add_u32 v14, v11, 6, v14
    v_lshl_add_u32 v14, v13, 5, v14
    v_lshl_add_u32 v40, v7, 3, v14
    v_xor_b32 v41, 64, v40
    v_xor_b32 v42, 128, v40
    v_xor_b32 v43, 192, v40
    v_add_u32 v44, 65536, v40
    v_add_u32 v45, 65536, v41
    v_add_u32 v46, 65536, v42
    v_add_u32 v47, 65536, v43
    v_add_u32 v48, 131072, v40
    v_add_u32 v49, 131072, v41
    v_add_u32 v50, 131072, v42
    v_add_u32 v51, 131072, v43
    v_lshrrev_b32 v4, 1, v1
    v_lshlrev_b32 v14, 9, v9
    v_lshl_add_u32 v14, v11, 7, v14
    v_lshrrev_b32 v15, 1, v11
    v_xor_b32 v15, v15, v4
    v_lshl_add_u32 v14, v15, 6, v14
    v_and_b32 v15, 1, v7
    v_lshl_add_u32 v14, v15, 5, v14
    v_lshl_add_u32 v14, v13, 4, v14
    v_lshrrev_b32 v15, 1, v7
    v_lshl_add_u32 v14, v15, 3, v14
    v_lshl_add_u32 v55, v4, 14, v14
    v_xor_b32 v56, 0x4000, v55
    v_add_u32 v57, 65536, v55
    v_add_u32 v58, 65536, v56
    v_add_u32 v59, 131072, v55
    v_add_u32 v60, 131072, v56
    v_and_b32 v14, 63, v0
    v_lshlrev_b32 v77, 4, v14
    v_lshl_add_u32 v61, v1, 13, v77
    v_add_u32 v61, 65536, v61
    v_xor_b32 v62, 0x4000, v61
    v_lshl_add_u32 v67, v1, 11, v77
    v_lshlrev_b32 v14, 20, v14
    v_lshl_add_u32 v14, v1, 7, v14
    s_lshl_b32 s3, s45, 9
    v_add_u32 v76, s3, v14
    v_and_b32 v14, 1, v6
    v_lshlrev_b32 v14, 2, v14
    v_xor_b32 v14, v14, v3
    v_lshl_add_u32 v14, v14, 4, v8
    v_mul_u32_u24 v15, 73728, v1
    v_add_u32 v63, v14, v15
    v_add_u32 v64, 8192, v63
    v_add_u32 v65, 16384, v63
    v_add_u32 v66, 24576, v63
    v_bfe_u32 v14, v0, 2, 1
    v_cmp_eq_u32 vcc, v14, v13
    v_mov_b32 v14, 0x3f803f80
    s_nop 0
    v_cndmask_b32 v14, 0, v14, vcc
    v_accvgpr_write_b32 a240, v14
    v_accvgpr_write_b32 a241, v14
    v_accvgpr_write_b32 a242, v14
    v_accvgpr_write_b32 a243, v14
    v_and_b32 v14, 1, v0
    v_lshlrev_b32 v14, 4, v14
    v_mov_b32 v15, 0x3f80
    v_lshlrev_b32 v14, v14, v15
    v_bfe_u32 v15, v0, 2, 1
    v_xor_b32 v15, v15, v9
    v_or_b32 v15, v15, v13
    v_lshlrev_b32 v15, 3, v15
    v_bfe_u32 v2, v0, 3, 1
    v_bfe_u32 v3, v0, 1, 1
    v_lshl_add_u32 v2, v2, 1, v3
    v_add_u32 v2, v2, v15
    v_cmp_eq_u32 vcc, 0, v2
    s_nop 1
    v_cndmask_b32 v3, 0, v14, vcc
    v_accvgpr_write_b32 a244, v3
    v_cmp_eq_u32 vcc, 1, v2
    s_nop 1
    v_cndmask_b32 v3, 0, v14, vcc
    v_accvgpr_write_b32 a245, v3
    v_cmp_eq_u32 vcc, 2, v2
    s_nop 1
    v_cndmask_b32 v3, 0, v14, vcc
    v_accvgpr_write_b32 a246, v3
    v_cmp_eq_u32 vcc, 3, v2
    s_nop 1
    v_cndmask_b32 v3, 0, v14, vcc
    v_accvgpr_write_b32 a247, v3
    s_add_u32 m0, s56, 90112
    s_nop 0
    buffer_load_dwordx4 v96, s[20:23], s60 offen lds
    buffer_load_dwordx4 v97, s[20:23], s60 offen offset:1024 lds
    s_add_u32 s60, s60, 128
    s_sub_u32 s49, s60, 1152
    s_cselect_b32 s60, s60, s49
    s_add_u32 m0, s56, 0
    s_nop 0
    buffer_load_dwordx4 v96, s[20:23], s60 offen lds
    buffer_load_dwordx4 v97, s[20:23], s60 offen offset:1024 lds
    s_add_u32 s60, s60, 128
    s_sub_u32 s49, s60, 1152
    s_cselect_b32 s60, s60, s49
    s_add_u32 m0, s56, 8192
    s_nop 0
    buffer_load_dwordx4 v96, s[20:23], s60 offen lds
    buffer_load_dwordx4 v97, s[20:23], s60 offen offset:1024 lds
    s_add_u32 s60, s60, 128
    s_sub_u32 s49, s60, 1152
    s_cselect_b32 s60, s60, s49
    s_waitcnt vmcnt(6)
    s_barrier
    ds_read_b128 a[0:3], v84 offset:8192
    ds_read_b128 a[4:7], v85 offset:8192
    ds_read_b128 a[8:11], v86 offset:8192
    ds_read_b128 a[12:15], v87 offset:8192
    ds_read_b128 a[16:19], v84 offset:16384
    ds_read_b128 a[20:23], v85 offset:16384
    ds_read_b128 a[24:27], v86 offset:16384
    ds_read_b128 a[28:31], v87 offset:16384
    ds_read_b64_tr_b16 a[144:145], v88 offset:49152
    ds_read_b64_tr_b16 a[146:147], v88 offset:50176
    ds_read_b64_tr_b16 a[148:149], v89 offset:49152
    ds_read_b64_tr_b16 a[150:151], v89 offset:50176
    ds_read_b64_tr_b16 a[152:153], v90 offset:49152
    ds_read_b64_tr_b16 a[154:155], v90 offset:50176
    ds_read_b64_tr_b16 a[156:157], v91 offset:49152
    ds_read_b64_tr_b16 a[158:159], v91 offset:50176
    ds_read_b64_tr_b16 a[160:161], v88 offset:57344
    ds_read_b64_tr_b16 a[162:163], v88 offset:58368
    ds_read_b64_tr_b16 a[164:165], v89 offset:57344
    ds_read_b64_tr_b16 a[166:167], v89 offset:58368
    ds_read_b64_tr_b16 a[168:169], v90 offset:57344
    ds_read_b64_tr_b16 a[170:171], v90 offset:58368
    ds_read_b64_tr_b16 a[172:173], v91 offset:57344
    ds_read_b64_tr_b16 a[174:175], v91 offset:58368
    s_add_u32 m0, s56, 16384
    s_nop 0
    buffer_load_dwordx4 v96, s[20:23], s60 offen lds
    buffer_load_dwordx4 v97, s[20:23], s60 offen offset:1024 lds
    s_add_u32 s60, s60, 128
    s_sub_u32 s49, s60, 1152
    s_cselect_b32 s60, s60, s49
    s_add_u32 m0, s56, 24576
    s_nop 0
    buffer_load_dwordx4 v96, s[20:23], s60 offen lds
    buffer_load_dwordx4 v97, s[20:23], s60 offen offset:1024 lds
    s_add_u32 s60, s60, 128
    s_sub_u32 s49, s60, 1152
    s_cselect_b32 s60, s60, s49
    s_add_u32 m0, s56, 98304
    s_nop 0
    buffer_load_dwordx4 v96, s[20:23], s60 offen lds
    buffer_load_dwordx4 v97, s[20:23], s60 offen offset:1024 lds
    s_add_u32 s60, s60, 128
    s_sub_u32 s49, s60, 1152
    s_cselect_b32 s60, s60, s49
    s_waitcnt vmcnt(10) lgkmcnt(0)
    s_barrier
    ds_read_b64_tr_b16 a[176:177], v92 offset:0
    ds_read_b64_tr_b16 a[178:179], v92 offset:1024
    ds_read_b64_tr_b16 a[180:181], v93 offset:0
    v_mfma_f32_32x32x16_bf16 v[144:159], a[144:147], a[0:3], 0
    ds_read_b64_tr_b16 a[182:183], v93 offset:1024
    ds_read_b64_tr_b16 a[184:185], v94 offset:0
    ds_read_b64_tr_b16 a[186:187], v94 offset:1024
    v_mfma_f32_32x32x16_bf16 v[160:175], a[148:151], a[0:3], 0
    ds_read_b64_tr_b16 a[188:189], v95 offset:0
    ds_read_b64_tr_b16 a[190:191], v95 offset:1024
    ds_read_b64_tr_b16 a[192:193], v92 offset:8192
    v_mfma_f32_32x32x16_bf16 v[176:191], a[152:155], a[0:3], 0
    ds_read_b64_tr_b16 a[194:195], v92 offset:9216
    ds_read_b64_tr_b16 a[196:197], v93 offset:8192
    ds_read_b64_tr_b16 a[198:199], v93 offset:9216
    v_mfma_f32_32x32x16_bf16 v[192:207], a[156:159], a[0:3], 0
    ds_read_b64_tr_b16 a[200:201], v94 offset:8192
    ds_read_b64_tr_b16 a[202:203], v94 offset:9216
    ds_read_b64_tr_b16 a[204:205], v95 offset:8192
    v_mfma_f32_32x32x16_bf16 v[144:159], a[160:163], a[4:7], v[144:159]
    ds_read_b64_tr_b16 a[206:207], v95 offset:9216
    ds_read_b128 a[32:35], v84 offset:24576
    ds_read_b128 a[36:39], v85 offset:24576
    v_mfma_f32_32x32x16_bf16 v[160:175], a[164:167], a[4:7], v[160:175]
    ds_read_b128 a[40:43], v86 offset:24576
    ds_read_b128 a[44:47], v87 offset:24576
    v_mfma_f32_32x32x16_bf16 v[176:191], a[168:171], a[4:7], v[176:191]
    v_mfma_f32_32x32x16_bf16 v[192:207], a[172:175], a[4:7], v[192:207]
    s_and_b32 s3, s46, 1
    s_cbranch_scc0 L_grpA
    s_add_u32 m0, s56, 106496
    s_nop 0
    buffer_load_dwordx4 v96, s[20:23], s60 offen lds
    buffer_load_dwordx4 v97, s[20:23], s60 offen offset:1024 lds
    s_add_u32 s60, s60, 128
    s_sub_u32 s49, s60, 1152
    s_cselect_b32 s60, s60, s49
    s_add_u32 m0, s62, 147456
    s_nop 0
    buffer_load_dwordx4 v100, s[32:35], s53 offen lds
    buffer_load_dwordx4 v101, s[32:35], s53 offen offset:1024 lds
    buffer_load_dwordx4 v102, s[32:35], s53 offen offset:2048 lds
    buffer_load_dwordx4 v103, s[32:35], s53 offen offset:3072 lds
    s_add_u32 s53, s53, 262144
    s_sub_u32 s49, s53, 4718592
    s_cselect_b32 s53, s53, s49
    s_waitcnt vmcnt(10) lgkmcnt(0)
    s_barrier
    ds_read_b128 a[48:51], v80 offset:0
    ds_read_b128 a[52:55], v81 offset:0
    ds_read_b128 a[56:59], v82 offset:0
    v_mfma_f32_32x32x16_bf16 v[144:159], a[176:179], a[8:11], v[144:159]
    ds_read_b128 a[60:63], v83 offset:0
    ds_read_b128 a[64:67], v80 offset:8192
    v_mfma_f32_32x32x16_bf16 v[160:175], a[180:183], a[8:11], v[160:175]
    ds_read_b128 a[68:71], v81 offset:8192
    ds_read_b128 a[72:75], v82 offset:8192
    ds_read_b128 a[76:79], v83 offset:8192
    v_mfma_f32_32x32x16_bf16 v[176:191], a[184:187], a[8:11], v[176:191]
    ds_read_b128 a[80:83], v80 offset:16384
    ds_read_b128 a[84:87], v81 offset:16384
    v_mfma_f32_32x32x16_bf16 v[192:207], a[188:191], a[8:11], v[192:207]
    ds_read_b128 a[88:91], v82 offset:16384
    ds_read_b128 a[92:95], v83 offset:16384
    v_mfma_f32_32x32x16_bf16 v[144:159], a[192:195], a[12:15], v[144:159]
    v_mfma_f32_32x32x16_bf16 v[160:175], a[196:199], a[12:15], v[160:175]
    v_mfma_f32_32x32x16_bf16 v[176:191], a[200:203], a[12:15], v[176:191]
    v_mfma_f32_32x32x16_bf16 v[192:207], a[204:207], a[12:15], v[192:207]
    s_add_u32 m0, s62, 114688
    s_nop 0
    buffer_load_dwordx4 v100, s[32:35], s53 offen lds
    buffer_load_dwordx4 v101, s[32:35], s53 offen offset:1024 lds
    buffer_load_dwordx4 v102, s[32:35], s53 offen offset:2048 lds
    buffer_load_dwordx4 v103, s[32:35], s53 offen offset:3072 lds
    s_add_u32 s53, s53, 262144
    s_sub_u32 s49, s53, 4718592
    s_cselect_b32 s53, s53, s49
    s_add_u32 m0, s62, 131072
    s_nop 0
    buffer_load_dwordx4 v100, s[32:35], s53 offen lds
    buffer_load_dwordx4 v101, s[32:35], s53 offen offset:1024 lds
    buffer_load_dwordx4 v102, s[32:35], s53 offen offset:2048 lds
    buffer_load_dwordx4 v103, s[32:35], s53 offen offset:3072 lds
    s_add_u32 s53, s53, 262144
    s_sub_u32 s49, s53, 4718592
    s_cselect_b32 s53, s53, s49
    s_waitcnt vmcnt(12) lgkmcnt(0)
    s_barrier
    ds_read_b128 a[96:99], v80 offset:24576
    ds_read_b128 a[100:103], v81 offset:24576
    ds_read_b128 a[104:107], v82 offset:24576
    ds_read_b128 a[108:111], v83 offset:24576
    ds_read_b128 a[112:115], v84 offset:32768
    ds_read_b128 a[116:119], v85 offset:32768
    ds_read_b128 a[120:123], v86 offset:32768
    ds_read_b128 a[124:127], v87 offset:32768
    ds_read_b128 a[128:131], v84 offset:40960
    ds_read_b128 a[132:135], v85 offset:40960
    ds_read_b128 a[136:139], v86 offset:40960
    ds_read_b128 a[140:143], v87 offset:40960
    s_waitcnt lgkmcnt(0)
    s_barrier
    s_waitcnt vmcnt(8)
    s_barrier
    ds_read_b64_tr_b16 a[144:145], v92 offset:16384
    ds_read_b64_tr_b16 a[146:147], v92 offset:17408
    ds_read_b64_tr_b16 a[148:149], v93 offset:16384
    ds_read_b64_tr_b16 a[150:151], v93 offset:17408
    ds_read_b64_tr_b16 a[152:153], v94 offset:16384
    ds_read_b64_tr_b16 a[154:155], v94 offset:17408
    ds_read_b64_tr_b16 a[156:157], v95 offset:16384
    ds_read_b64_tr_b16 a[158:159], v95 offset:17408
    ds_read_b64_tr_b16 a[160:161], v92 offset:24576
    ds_read_b64_tr_b16 a[162:163], v92 offset:25600
    ds_read_b64_tr_b16 a[164:165], v93 offset:24576
    ds_read_b64_tr_b16 a[166:167], v93 offset:25600
    ds_read_b64_tr_b16 a[168:169], v94 offset:24576
    ds_read_b64_tr_b16 a[170:171], v94 offset:25600
    ds_read_b64_tr_b16 a[172:173], v95 offset:24576
    ds_read_b64_tr_b16 a[174:175], v95 offset:25600
    s_waitcnt vmcnt(4) lgkmcnt(0)
    s_barrier
    ds_read_b64_tr_b16 a[176:177], v88 offset:49152
    ds_read_b64_tr_b16 a[178:179], v88 offset:50176
    ds_read_b64_tr_b16 a[180:181], v89 offset:49152
    v_mfma_f32_32x32x16_bf16 v[144:159], a[144:147], a[16:19], v[144:159]
    ds_read_b64_tr_b16 a[182:183], v89 offset:50176
    ds_read_b64_tr_b16 a[184:185], v90 offset:49152
    s_add_u32 m0, s62, 147456
    v_mfma_f32_32x32x16_bf16 v[160:175], a[148:151], a[16:19], v[160:175]
    ds_read_b64_tr_b16 a[186:187], v90 offset:50176
    ds_read_b64_tr_b16 a[188:189], v91 offset:49152
    buffer_load_dwordx4 v100, s[32:35], s53 offen lds
    v_mfma_f32_32x32x16_bf16 v[176:191], a[152:155], a[16:19], v[176:191]
    ds_read_b64_tr_b16 a[190:191], v91 offset:50176
    ds_read_b64_tr_b16 a[192:193], v88 offset:57344
    ds_read_b64_tr_b16 a[194:195], v88 offset:58368
    buffer_load_dwordx4 v101, s[32:35], s53 offen offset:1024 lds
    v_mfma_f32_32x32x16_bf16 v[192:207], a[156:159], a[16:19], v[192:207]
    ds_read_b64_tr_b16 a[196:197], v89 offset:57344
    ds_read_b64_tr_b16 a[198:199], v89 offset:58368
    buffer_load_dwordx4 v102, s[32:35], s53 offen offset:2048 lds
    v_mfma_f32_32x32x16_bf16 v[144:159], a[160:163], a[20:23], v[144:159]
    ds_read_b64_tr_b16 a[200:201], v90 offset:57344
    ds_read_b64_tr_b16 a[202:203], v90 offset:58368
    buffer_load_dwordx4 v103, s[32:35], s53 offen offset:3072 lds
    v_mfma_f32_32x32x16_bf16 v[160:175], a[164:167], a[20:23], v[160:175]
    ds_read_b64_tr_b16 a[204:205], v91 offset:57344
    ds_read_b64_tr_b16 a[206:207], v91 offset:58368
    s_add_u32 s53, s53, 262144
    v_mfma_f32_32x32x16_bf16 v[176:191], a[168:171], a[20:23], v[176:191]
    s_sub_u32 s49, s53, 4718592
    s_cselect_b32 s53, s53, s49
    v_mfma_f32_32x32x16_bf16 v[192:207], a[172:175], a[20:23], v[192:207]
    s_waitcnt vmcnt(4) lgkmcnt(0)
    s_barrier
    ds_read_b64_tr_b16 a[144:145], v92 offset:0
    ds_read_b64_tr_b16 a[146:147], v92 offset:1024
    ds_read_b64_tr_b16 a[148:149], v93 offset:0
    v_mfma_f32_32x32x16_bf16 v[144:159], a[176:179], a[24:27], v[144:159]
    ds_read_b64_tr_b16 a[150:151], v93 offset:1024
    ds_read_b64_tr_b16 a[152:153], v94 offset:0
    s_add_u32 m0, s62, 114688
    v_mfma_f32_32x32x16_bf16 v[160:175], a[180:183], a[24:27], v[160:175]
    ds_read_b64_tr_b16 a[154:155], v94 offset:1024
    ds_read_b64_tr_b16 a[156:157], v95 offset:0
    buffer_load_dwordx4 v100, s[32:35], s53 offen lds
    v_mfma_f32_32x32x16_bf16 v[176:191], a[184:187], a[24:27], v[176:191]
    ds_read_b64_tr_b16 a[158:159], v95 offset:1024
    ds_read_b64_tr_b16 a[160:161], v92 offset:8192
    ds_read_b64_tr_b16 a[162:163], v92 offset:9216
    buffer_load_dwordx4 v101, s[32:35], s53 offen offset:1024 lds
    v_mfma_f32_32x32x16_bf16 v[192:207], a[188:191], a[24:27], v[192:207]
    ds_read_b64_tr_b16 a[164:165], v93 offset:8192
    ds_read_b64_tr_b16 a[166:167], v93 offset:9216
    buffer_load_dwordx4 v102, s[32:35], s53 offen offset:2048 lds
    v_mfma_f32_32x32x16_bf16 v[144:159], a[192:195], a[28:31], v[144:159]
    ds_read_b64_tr_b16 a[168:169], v94 offset:8192
    ds_read_b64_tr_b16 a[170:171], v94 offset:9216
    buffer_load_dwordx4 v103, s[32:35], s53 offen offset:3072 lds
    v_mfma_f32_32x32x16_bf16 v[160:175], a[196:199], a[28:31], v[160:175]
    ds_read_b64_tr_b16 a[172:173], v95 offset:8192
    ds_read_b64_tr_b16 a[174:175], v95 offset:9216
    s_add_u32 s53, s53, 262144
    v_mfma_f32_32x32x16_bf16 v[176:191], a[200:203], a[28:31], v[176:191]
    s_sub_u32 s49, s53, 4718592
    s_cselect_b32 s53, s53, s49
    v_mfma_f32_32x32x16_bf16 v[192:207], a[204:207], a[28:31], v[192:207]
    s_waitcnt vmcnt(4) lgkmcnt(0)
    s_barrier
    ds_read_b64_tr_b16 a[176:177], v92 offset:16384
    ds_read_b64_tr_b16 a[178:179], v92 offset:17408
    ds_read_b64_tr_b16 a[180:181], v93 offset:16384
    v_mfma_f32_32x32x16_bf16 v[144:159], a[144:147], a[32:35], v[144:159]
    ds_read_b64_tr_b16 a[182:183], v93 offset:17408
    ds_read_b64_tr_b16 a[184:185], v94 offset:16384
    s_add_u32 m0, s62, 131072
    v_mfma_f32_32x32x16_bf16 v[160:175], a[148:151], a[32:35], v[160:175]
    ds_read_b64_tr_b16 a[186:187], v94 offset:17408
    ds_read_b64_tr_b16 a[188:189], v95 offset:16384
    buffer_load_dwordx4 v100, s[32:35], s53 offen lds
    v_mfma_f32_32x32x16_bf16 v[176:191], a[152:155], a[32:35], v[176:191]
    ds_read_b64_tr_b16 a[190:191], v95 offset:17408
    ds_read_b64_tr_b16 a[192:193], v92 offset:24576
    ds_read_b64_tr_b16 a[194:195], v92 offset:25600
    buffer_load_dwordx4 v101, s[32:35], s53 offen offset:1024 lds
    v_mfma_f32_32x32x16_bf16 v[192:207], a[156:159], a[32:35], v[192:207]
    ds_read_b64_tr_b16 a[196:197], v93 offset:24576
    ds_read_b64_tr_b16 a[198:199], v93 offset:25600
    buffer_load_dwordx4 v102, s[32:35], s53 offen offset:2048 lds
    v_mfma_f32_32x32x16_bf16 v[144:159], a[160:163], a[36:39], v[144:159]
    ds_read_b64_tr_b16 a[200:201], v94 offset:24576
    ds_read_b64_tr_b16 a[202:203], v94 offset:25600
    buffer_load_dwordx4 v103, s[32:35], s53 offen offset:3072 lds
    v_mfma_f32_32x32x16_bf16 v[160:175], a[164:167], a[36:39], v[160:175]
    ds_read_b64_tr_b16 a[204:205], v95 offset:24576
    ds_read_b64_tr_b16 a[206:207], v95 offset:25600
    s_add_u32 s53, s53, 262144
    v_mfma_f32_32x32x16_bf16 v[176:191], a[168:171], a[36:39], v[176:191]
    s_sub_u32 s49, s53, 4718592
    s_cselect_b32 s53, s53, s49
    v_mfma_f32_32x32x16_bf16 v[192:207], a[172:175], a[36:39], v[192:207]
    s_waitcnt vmcnt(4) lgkmcnt(0)
    s_barrier
    ds_read_b64_tr_b16 a[144:145], v88 offset:49152
    ds_read_b64_tr_b16 a[146:147], v88 offset:50176
    ds_read_b64_tr_b16 a[148:149], v89 offset:49152
    v_mfma_f32_32x32x16_bf16 v[144:159], a[176:179], a[40:43], v[144:159]
    ds_read_b64_tr_b16 a[150:151], v89 offset:50176
    ds_read_b64_tr_b16 a[152:153], v90 offset:49152
    s_add_u32 m0, s62, 147456
    v_mfma_f32_32x32x16_bf16 v[160:175], a[180:183], a[40:43], v[160:175]
    ds_read_b64_tr_b16 a[154:155], v90 offset:50176
    ds_read_b64_tr_b16 a[156:157], v91 offset:49152
    buffer_load_dwordx4 v100, s[32:35], s53 offen lds
    v_mfma_f32_32x32x16_bf16 v[176:191], a[184:187], a[40:43], v[176:191]
    ds_read_b64_tr_b16 a[158:159], v91 offset:50176
    ds_read_b64_tr_b16 a[160:161], v88 offset:57344
    ds_read_b64_tr_b16 a[162:163], v88 offset:58368
    buffer_load_dwordx4 v101, s[32:35], s53 offen offset:1024 lds
    v_mfma_f32_32x32x16_bf16 v[192:207], a[188:191], a[40:43], v[192:207]
    ds_read_b64_tr_b16 a[164:165], v89 offset:57344
    ds_read_b64_tr_b16 a[166:167], v89 offset:58368
    buffer_load_dwordx4 v102, s[32:35], s53 offen offset:2048 lds
    v_mfma_f32_32x32x16_bf16 v[144:159], a[192:195], a[44:47], v[144:159]
    ds_read_b64_tr_b16 a[168:169], v90 offset:57344
    ds_read_b64_tr_b16 a[170:171], v90 offset:58368
    buffer_load_dwordx4 v103, s[32:35], s53 offen offset:3072 lds
    v_mfma_f32_32x32x16_bf16 v[160:175], a[196:199], a[44:47], v[160:175]
    ds_read_b64_tr_b16 a[172:173], v91 offset:57344
    ds_read_b64_tr_b16 a[174:175], v91 offset:58368
    s_add_u32 s53, s53, 262144
    v_mfma_f32_32x32x16_bf16 v[176:191], a[200:203], a[44:47], v[176:191]
    s_sub_u32 s49, s53, 4718592
    s_cselect_b32 s53, s53, s49
    v_mfma_f32_32x32x16_bf16 v[192:207], a[204:207], a[44:47], v[192:207]
    s_waitcnt vmcnt(4) lgkmcnt(0)
    s_barrier
    ds_read_b64_tr_b16 a[176:177], v92 offset:0
    ds_read_b64_tr_b16 a[178:179], v92 offset:1024
    ds_read_b64_tr_b16 a[180:181], v93 offset:0
    v_mfma_f32_32x32x16_bf16 v[144:159], a[144:147], a[48:51], v[144:159]
    ds_read_b64_tr_b16 a[182:183], v93 offset:1024
    ds_read_b64_tr_b16 a[184:185], v94 offset:0
    s_add_u32 m0, s62, 114688
    v_mfma_f32_32x32x16_bf16 v[160:175], a[148:151], a[48:51], v[160:175]
    ds_read_b64_tr_b16 a[186:187], v94 offset:1024
    ds_read_b64_tr_b16 a[188:189], v95 offset:0
    buffer_load_dwordx4 v100, s[32:35], s53 offen lds
    v_mfma_f32_32x32x16_bf16 v[176:191], a[152:155], a[48:51], v[176:191]
    ds_read_b64_tr_b16 a[190:191], v95 offset:1024
    ds_read_b64_tr_b16 a[192:193], v92 offset:8192
    ds_read_b64_tr_b16 a[194:195], v92 offset:9216
    buffer_load_dwordx4 v101, s[32:35], s53 offen offset:1024 lds
    v_mfma_f32_32x32x16_bf16 v[192:207], a[156:159], a[48:51], v[192:207]
    ds_read_b64_tr_b16 a[196:197], v93 offset:8192
    ds_read_b64_tr_b16 a[198:199], v93 offset:9216
    buffer_load_dwordx4 v102, s[32:35], s53 offen offset:2048 lds
    v_mfma_f32_32x32x16_bf16 v[144:159], a[160:163], a[52:55], v[144:159]
    ds_read_b64_tr_b16 a[200:201], v94 offset:8192
    ds_read_b64_tr_b16 a[202:203], v94 offset:9216
    buffer_load_dwordx4 v103, s[32:35], s53 offen offset:3072 lds
    v_mfma_f32_32x32x16_bf16 v[160:175], a[164:167], a[52:55], v[160:175]
    ds_read_b64_tr_b16 a[204:205], v95 offset:8192
    ds_read_b64_tr_b16 a[206:207], v95 offset:9216
    s_add_u32 s53, s53, 262144
    v_mfma_f32_32x32x16_bf16 v[176:191], a[168:171], a[52:55], v[176:191]
    s_sub_u32 s49, s53, 4718592
    s_cselect_b32 s53, s53, s49
    v_mfma_f32_32x32x16_bf16 v[192:207], a[172:175], a[52:55], v[192:207]
    s_waitcnt vmcnt(4) lgkmcnt(0)
    s_barrier
    ds_read_b64_tr_b16 a[144:145], v92 offset:16384
    ds_read_b64_tr_b16 a[146:147], v92 offset:17408
    ds_read_b64_tr_b16 a[148:149], v93 offset:16384
    v_mfma_f32_32x32x16_bf16 v[144:159], a[176:179], a[56:59], v[144:159]
    ds_read_b64_tr_b16 a[150:151], v93 offset:17408
    ds_read_b64_tr_b16 a[152:153], v94 offset:16384
    s_add_u32 m0, s62, 131072
    v_mfma_f32_32x32x16_bf16 v[160:175], a[180:183], a[56:59], v[160:175]
    ds_read_b64_tr_b16 a[154:155], v94 offset:17408
    ds_read_b64_tr_b16 a[156:157], v95 offset:16384
    buffer_load_dwordx4 v100, s[32:35], s53 offen lds
    v_mfma_f32_32x32x16_bf16 v[176:191], a[184:187], a[56:59], v[176:191]
    ds_read_b64_tr_b16 a[158:159], v95 offset:17408
    ds_read_b64_tr_b16 a[160:161], v92 offset:24576
    ds_read_b64_tr_b16 a[162:163], v92 offset:25600
    buffer_load_dwordx4 v101, s[32:35], s53 offen offset:1024 lds
    v_mfma_f32_32x32x16_bf16 v[192:207], a[188:191], a[56:59], v[192:207]
    ds_read_b64_tr_b16 a[164:165], v93 offset:24576
    ds_read_b64_tr_b16 a[166:167], v93 offset:25600
    buffer_load_dwordx4 v102, s[32:35], s53 offen offset:2048 lds
    v_mfma_f32_32x32x16_bf16 v[144:159], a[192:195], a[60:63], v[144:159]
    ds_read_b64_tr_b16 a[168:169], v94 offset:24576
    ds_read_b64_tr_b16 a[170:171], v94 offset:25600
    buffer_load_dwordx4 v103, s[32:35], s53 offen offset:3072 lds
    v_mfma_f32_32x32x16_bf16 v[160:175], a[196:199], a[60:63], v[160:175]
    ds_read_b64_tr_b16 a[172:173], v95 offset:24576
    ds_read_b64_tr_b16 a[174:175], v95 offset:25600
    s_add_u32 s53, s53, 262144
    v_mfma_f32_32x32x16_bf16 v[176:191], a[200:203], a[60:63], v[176:191]
    s_sub_u32 s49, s53, 4718592
    s_cselect_b32 s53, s53, s49
    v_mfma_f32_32x32x16_bf16 v[192:207], a[204:207], a[60:63], v[192:207]
    s_waitcnt vmcnt(4) lgkmcnt(0)
    s_barrier
    ds_read_b64_tr_b16 a[176:177], v88 offset:49152
    ds_read_b64_tr_b16 a[178:179], v88 offset:50176
    ds_read_b64_tr_b16 a[180:181], v89 offset:49152
    v_mfma_f32_32x32x16_bf16 v[144:159], a[144:147], a[64:67], v[144:159]
    ds_read_b64_tr_b16 a[182:183], v89 offset:50176
    ds_read_b64_tr_b16 a[184:185], v90 offset:49152
    s_add_u32 m0, s62, 147456
    v_mfma_f32_32x32x16_bf16 v[160:175], a[148:151], a[64:67], v[160:175]
    ds_read_b64_tr_b16 a[186:187], v90 offset:50176
    ds_read_b64_tr_b16 a[188:189], v91 offset:49152
    buffer_load_dwordx4 v100, s[32:35], s53 offen lds
    v_mfma_f32_32x32x16_bf16 v[176:191], a[152:155], a[64:67], v[176:191]
    ds_read_b64_tr_b16 a[190:191], v91 offset:50176
    ds_read_b64_tr_b16 a[192:193], v88 offset:57344
    ds_read_b64_tr_b16 a[194:195], v88 offset:58368
    buffer_load_dwordx4 v101, s[32:35], s53 offen offset:1024 lds
    v_mfma_f32_32x32x16_bf16 v[192:207], a[156:159], a[64:67], v[192:207]
    ds_read_b64_tr_b16 a[196:197], v89 offset:57344
    ds_read_b64_tr_b16 a[198:199], v89 offset:58368
    buffer_load_dwordx4 v102, s[32:35], s53 offen offset:2048 lds
    v_mfma_f32_32x32x16_bf16 v[144:159], a[160:163], a[68:71], v[144:159]
    ds_read_b64_tr_b16 a[200:201], v90 offset:57344
    ds_read_b64_tr_b16 a[202:203], v90 offset:58368
    buffer_load_dwordx4 v103, s[32:35], s53 offen offset:3072 lds
    v_mfma_f32_32x32x16_bf16 v[160:175], a[164:167], a[68:71], v[160:175]
    ds_read_b64_tr_b16 a[204:205], v91 offset:57344
    ds_read_b64_tr_b16 a[206:207], v91 offset:58368
    s_add_u32 s53, s53, 262144
    v_mfma_f32_32x32x16_bf16 v[176:191], a[168:171], a[68:71], v[176:191]
    s_sub_u32 s49, s53, 4718592
    s_cselect_b32 s53, s53, s49
    v_mfma_f32_32x32x16_bf16 v[192:207], a[172:175], a[68:71], v[192:207]
    s_waitcnt vmcnt(4) lgkmcnt(0)
    s_barrier
    ds_read_b64_tr_b16 a[144:145], v92 offset:0
    ds_read_b64_tr_b16 a[146:147], v92 offset:1024
    ds_read_b64_tr_b16 a[148:149], v93 offset:0
    v_mfma_f32_32x32x16_bf16 v[144:159], a[176:179], a[72:75], v[144:159]
    ds_read_b64_tr_b16 a[150:151], v93 offset:1024
    ds_read_b64_tr_b16 a[152:153], v94 offset:0
    s_add_u32 m0, s62, 114688
    v_mfma_f32_32x32x16_bf16 v[160:175], a[180:183], a[72:75], v[160:175]
    ds_read_b64_tr_b16 a[154:155], v94 offset:1024
    ds_read_b64_tr_b16 a[156:157], v95 offset:0
    buffer_load_dwordx4 v100, s[32:35], s53 offen lds
    v_mfma_f32_32x32x16_bf16 v[176:191], a[184:187], a[72:75], v[176:191]
    ds_read_b64_tr_b16 a[158:159], v95 offset:1024
    ds_read_b64_tr_b16 a[160:161], v92 offset:8192
    ds_read_b64_tr_b16 a[162:163], v92 offset:9216
    buffer_load_dwordx4 v101, s[32:35], s53 offen offset:1024 lds
    v_mfma_f32_32x32x16_bf16 v[192:207], a[188:191], a[72:75], v[192:207]
    ds_read_b64_tr_b16 a[164:165], v93 offset:8192
    ds_read_b64_tr_b16 a[166:167], v93 offset:9216
    buffer_load_dwordx4 v102, s[32:35], s53 offen offset:2048 lds
    v_mfma_f32_32x32x16_bf16 v[144:159], a[192:195], a[76:79], v[144:159]
    ds_read_b64_tr_b16 a[168:169], v94 offset:8192
    ds_read_b64_tr_b16 a[170:171], v94 offset:9216
    buffer_load_dwordx4 v103, s[32:35], s53 offen offset:3072 lds
    v_mfma_f32_32x32x16_bf16 v[160:175], a[196:199], a[76:79], v[160:175]
    ds_read_b64_tr_b16 a[172:173], v95 offset:8192
    ds_read_b64_tr_b16 a[174:175], v95 offset:9216
    s_add_u32 s53, s53, 262144
    v_mfma_f32_32x32x16_bf16 v[176:191], a[200:203], a[76:79], v[176:191]
    s_sub_u32 s49, s53, 4718592
    s_cselect_b32 s53, s53, s49
    v_mfma_f32_32x32x16_bf16 v[192:207], a[204:207], a[76:79], v[192:207]
    s_waitcnt vmcnt(4) lgkmcnt(0)
    s_barrier
    ds_read_b64_tr_b16 a[176:177], v92 offset:16384
    ds_read_b64_tr_b16 a[178:179], v92 offset:17408
    ds_read_b64_tr_b16 a[180:181], v93 offset:16384
    v_mfma_f32_32x32x16_bf16 v[144:159], a[144:147], a[80:83], v[144:159]
    ds_read_b64_tr_b16 a[182:183], v93 offset:17408
    ds_read_b64_tr_b16 a[184:185], v94 offset:16384
    s_add_u32 m0, s62, 131072
    v_mfma_f32_32x32x16_bf16 v[160:175], a[148:151], a[80:83], v[160:175]
    ds_read_b64_tr_b16 a[186:187], v94 offset:17408
    ds_read_b64_tr_b16 a[188:189], v95 offset:16384
    buffer_load_dwordx4 v100, s[32:35], s53 offen lds
    v_mfma_f32_32x32x16_bf16 v[176:191], a[152:155], a[80:83], v[176:191]
    ds_read_b64_tr_b16 a[190:191], v95 offset:17408
    ds_read_b64_tr_b16 a[192:193], v92 offset:24576
    ds_read_b64_tr_b16 a[194:195], v92 offset:25600
    buffer_load_dwordx4 v101, s[32:35], s53 offen offset:1024 lds
    v_mfma_f32_32x32x16_bf16 v[192:207], a[156:159], a[80:83], v[192:207]
    ds_read_b64_tr_b16 a[196:197], v93 offset:24576
    ds_read_b64_tr_b16 a[198:199], v93 offset:25600
    buffer_load_dwordx4 v102, s[32:35], s53 offen offset:2048 lds
    v_mfma_f32_32x32x16_bf16 v[144:159], a[160:163], a[84:87], v[144:159]
    ds_read_b64_tr_b16 a[200:201], v94 offset:24576
    ds_read_b64_tr_b16 a[202:203], v94 offset:25600
    buffer_load_dwordx4 v103, s[32:35], s53 offen offset:3072 lds
    v_mfma_f32_32x32x16_bf16 v[160:175], a[164:167], a[84:87], v[160:175]
    ds_read_b64_tr_b16 a[204:205], v95 offset:24576
    ds_read_b64_tr_b16 a[206:207], v95 offset:25600
    s_add_u32 s53, s53, 262144
    v_mfma_f32_32x32x16_bf16 v[176:191], a[168:171], a[84:87], v[176:191]
    s_sub_u32 s49, s53, 4718592
    s_cselect_b32 s53, s53, s49
    v_mfma_f32_32x32x16_bf16 v[192:207], a[172:175], a[84:87], v[192:207]
    s_waitcnt vmcnt(4) lgkmcnt(0)
    s_barrier
    ds_read_b64_tr_b16 a[144:145], v88 offset:49152
    ds_read_b64_tr_b16 a[146:147], v88 offset:50176
    ds_read_b64_tr_b16 a[148:149], v89 offset:49152
    v_mfma_f32_32x32x16_bf16 v[144:159], a[176:179], a[88:91], v[144:159]
    ds_read_b64_tr_b16 a[150:151], v89 offset:50176
    ds_read_b64_tr_b16 a[152:153], v90 offset:49152
    s_add_u32 m0, s62, 147456
    v_mfma_f32_32x32x16_bf16 v[160:175], a[180:183], a[88:91], v[160:175]
    ds_read_b64_tr_b16 a[154:155], v90 offset:50176
    ds_read_b64_tr_b16 a[156:157], v91 offset:49152
    buffer_load_dwordx4 v100, s[32:35], s53 offen lds
    v_mfma_f32_32x32x16_bf16 v[176:191], a[184:187], a[88:91], v[176:191]
    ds_read_b64_tr_b16 a[158:159], v91 offset:50176
    ds_read_b64_tr_b16 a[160:161], v88 offset:57344
    ds_read_b64_tr_b16 a[162:163], v88 offset:58368
    buffer_load_dwordx4 v101, s[32:35], s53 offen offset:1024 lds
    v_mfma_f32_32x32x16_bf16 v[192:207], a[188:191], a[88:91], v[192:207]
    ds_read_b64_tr_b16 a[164:165], v89 offset:57344
    ds_read_b64_tr_b16 a[166:167], v89 offset:58368
    buffer_load_dwordx4 v102, s[32:35], s53 offen offset:2048 lds
    v_mfma_f32_32x32x16_bf16 v[144:159], a[192:195], a[92:95], v[144:159]
    ds_read_b64_tr_b16 a[168:169], v90 offset:57344
    ds_read_b64_tr_b16 a[170:171], v90 offset:58368
    buffer_load_dwordx4 v103, s[32:35], s53 offen offset:3072 lds
    v_mfma_f32_32x32x16_bf16 v[160:175], a[196:199], a[92:95], v[160:175]
    ds_read_b64_tr_b16 a[172:173], v91 offset:57344
    ds_read_b64_tr_b16 a[174:175], v91 offset:58368
    s_add_u32 s53, s53, 262144
    v_mfma_f32_32x32x16_bf16 v[176:191], a[200:203], a[92:95], v[176:191]
    s_sub_u32 s49, s53, 4718592
    s_cselect_b32 s53, s53, s49
    v_mfma_f32_32x32x16_bf16 v[192:207], a[204:207], a[92:95], v[192:207]
    s_waitcnt vmcnt(4) lgkmcnt(0)
    s_barrier
    ds_read_b64_tr_b16 a[176:177], v92 offset:0
    ds_read_b64_tr_b16 a[178:179], v92 offset:1024
    ds_read_b64_tr_b16 a[180:181], v93 offset:0
    v_mfma_f32_32x32x16_bf16 v[144:159], a[144:147], a[96:99], v[144:159]
    ds_read_b64_tr_b16 a[182:183], v93 offset:1024
    ds_read_b64_tr_b16 a[184:185], v94 offset:0
    s_add_u32 m0, s62, 114688
    v_mfma_f32_32x32x16_bf16 v[160:175], a[148:151], a[96:99], v[160:175]
    ds_read_b64_tr_b16 a[186:187], v94 offset:1024
    ds_read_b64_tr_b16 a[188:189], v95 offset:0
    buffer_load_dwordx4 v100, s[32:35], s53 offen lds
    v_mfma_f32_32x32x16_bf16 v[176:191], a[152:155], a[96:99], v[176:191]
    ds_read_b64_tr_b16 a[190:191], v95 offset:1024
    ds_read_b64_tr_b16 a[192:193], v92 offset:8192
    ds_read_b64_tr_b16 a[194:195], v92 offset:9216
    buffer_load_dwordx4 v101, s[32:35], s53 offen offset:1024 lds
    v_mfma_f32_32x32x16_bf16 v[192:207], a[156:159], a[96:99], v[192:207]
    ds_read_b64_tr_b16 a[196:197], v93 offset:8192
    ds_read_b64_tr_b16 a[198:199], v93 offset:9216
    buffer_load_dwordx4 v102, s[32:35], s53 offen offset:2048 lds
    v_mfma_f32_32x32x16_bf16 v[144:159], a[160:163], a[100:103], v[144:159]
    ds_read_b64_tr_b16 a[200:201], v94 offset:8192
    ds_read_b64_tr_b16 a[202:203], v94 offset:9216
    buffer_load_dwordx4 v103, s[32:35], s53 offen offset:3072 lds
    v_mfma_f32_32x32x16_bf16 v[160:175], a[164:167], a[100:103], v[160:175]
    ds_read_b64_tr_b16 a[204:205], v95 offset:8192
    ds_read_b64_tr_b16 a[206:207], v95 offset:9216
    s_add_u32 s53, s53, 262144
    v_mfma_f32_32x32x16_bf16 v[176:191], a[168:171], a[100:103], v[176:191]
    s_sub_u32 s49, s53, 4718592
    s_cselect_b32 s53, s53, s49
    v_mfma_f32_32x32x16_bf16 v[192:207], a[172:175], a[100:103], v[192:207]
    s_waitcnt vmcnt(4) lgkmcnt(0)
    s_barrier
    ds_read_b64_tr_b16 a[144:145], v92 offset:16384
    ds_read_b64_tr_b16 a[146:147], v92 offset:17408
    ds_read_b64_tr_b16 a[148:149], v93 offset:16384
    v_mfma_f32_32x32x16_bf16 v[144:159], a[176:179], a[104:107], v[144:159]
    ds_read_b64_tr_b16 a[150:151], v93 offset:17408
    ds_read_b64_tr_b16 a[152:153], v94 offset:16384
    s_add_u32 m0, s62, 131072
    v_mfma_f32_32x32x16_bf16 v[160:175], a[180:183], a[104:107], v[160:175]
    ds_read_b64_tr_b16 a[154:155], v94 offset:17408
    ds_read_b64_tr_b16 a[156:157], v95 offset:16384
    buffer_load_dwordx4 v100, s[32:35], s53 offen lds
    v_mfma_f32_32x32x16_bf16 v[176:191], a[184:187], a[104:107], v[176:191]
    ds_read_b64_tr_b16 a[158:159], v95 offset:17408
    ds_read_b64_tr_b16 a[160:161], v92 offset:24576
    ds_read_b64_tr_b16 a[162:163], v92 offset:25600
    buffer_load_dwordx4 v101, s[32:35], s53 offen offset:1024 lds
    v_mfma_f32_32x32x16_bf16 v[192:207], a[188:191], a[104:107], v[192:207]
    ds_read_b64_tr_b16 a[164:165], v93 offset:24576
    ds_read_b64_tr_b16 a[166:167], v93 offset:25600
    buffer_load_dwordx4 v102, s[32:35], s53 offen offset:2048 lds
    v_mfma_f32_32x32x16_bf16 v[144:159], a[192:195], a[108:111], v[144:159]
    ds_read_b64_tr_b16 a[168:169], v94 offset:24576
    ds_read_b64_tr_b16 a[170:171], v94 offset:25600
    buffer_load_dwordx4 v103, s[32:35], s53 offen offset:3072 lds
    v_mfma_f32_32x32x16_bf16 v[160:175], a[196:199], a[108:111], v[160:175]
    ds_read_b64_tr_b16 a[172:173], v95 offset:24576
    ds_read_b64_tr_b16 a[174:175], v95 offset:25600
    s_add_u32 s53, s53, 262144
    v_mfma_f32_32x32x16_bf16 v[176:191], a[200:203], a[108:111], v[176:191]
    s_sub_u32 s49, s53, 4718592
    s_cselect_b32 s53, s53, s49
    v_mfma_f32_32x32x16_bf16 v[192:207], a[204:207], a[108:111], v[192:207]
    s_waitcnt vmcnt(4) lgkmcnt(0)
    s_barrier
    ds_read_b64_tr_b16 a[176:177], v88 offset:49152
    ds_read_b64_tr_b16 a[178:179], v88 offset:50176
    ds_read_b64_tr_b16 a[180:181], v89 offset:49152
    v_mfma_f32_32x32x16_bf16 v[144:159], a[144:147], a[112:115], v[144:159]
    ds_read_b64_tr_b16 a[182:183], v89 offset:50176
    ds_read_b64_tr_b16 a[184:185], v90 offset:49152
    s_add_u32 m0, s62, 147456
    s_nop 0
    buffer_load_dwordx4 v100, s[32:35], s53 offen lds
    v_mfma_f32_32x32x16_bf16 v[160:175], a[148:151], a[112:115], v[160:175]
    ds_read_b64_tr_b16 a[186:187], v90 offset:50176
    ds_read_b64_tr_b16 a[188:189], v91 offset:49152
    buffer_load_dwordx4 v101, s[32:35], s53 offen offset:1024 lds
    buffer_load_dwordx4 v102, s[32:35], s53 offen offset:2048 lds
    v_mfma_f32_32x32x16_bf16 v[176:191], a[152:155], a[112:115], v[176:191]
    ds_read_b64_tr_b16 a[190:191], v91 offset:50176
    ds_read_b64_tr_b16 a[192:193], v88 offset:57344
    ds_read_b64_tr_b16 a[194:195], v88 offset:58368
    buffer_load_dwordx4 v103, s[32:35], s53 offen offset:3072 lds
    v_mfma_f32_32x32x16_bf16 v[192:207], a[156:159], a[112:115], v[192:207]
    ds_read_b64_tr_b16 a[196:197], v89 offset:57344
    ds_read_b64_tr_b16 a[198:199], v89 offset:58368
    s_add_u32 s53, s53, 262144
    s_sub_u32 s49, s53, 4718592
    s_cselect_b32 s53, s53, s49
    v_mfma_f32_32x32x16_bf16 v[144:159], a[160:163], a[116:119], v[144:159]
    ds_read_b64_tr_b16 a[200:201], v90 offset:57344
    ds_read_b64_tr_b16 a[202:203], v90 offset:58368
    s_add_u32 m0, s56, 32768
    s_nop 0
    buffer_load_dwordx4 v52, s[24:27], s64 offen nt lds
    v_mfma_f32_32x32x16_bf16 v[160:175], a[164:167], a[116:119], v[160:175]
    ds_read_b64_tr_b16 a[204:205], v91 offset:57344
    ds_read_b64_tr_b16 a[206:207], v91 offset:58368
    buffer_load_dwordx4 v53, s[24:27], s64 offen offset:1024 nt lds
    v_mfma_f32_32x32x16_bf16 v[176:191], a[168:171], a[116:119], v[176:191]
    s_add_u32 m0, s56, 40960
    s_nop 0
    buffer_load_dwordx4 v52, s[24:27], s65 offen nt lds
    v_mfma_f32_32x32x16_bf16 v[192:207], a[172:175], a[116:119], v[192:207]
    buffer_load_dwordx4 v53, s[24:27], s65 offen offset:1024 nt lds
    s_waitcnt vmcnt(8) lgkmcnt(0)
    s_barrier
    ds_read_b64_tr_b16 a[144:145], v92 offset:0
    ds_read_b64_tr_b16 a[146:147], v92 offset:1024
    ds_read_b64_tr_b16 a[148:149], v93 offset:0
    v_mfma_f32_32x32x16_bf16 v[144:159], a[176:179], a[120:123], v[144:159]
    ds_read_b64_tr_b16 a[150:151], v93 offset:1024
    ds_read_b64_tr_b16 a[152:153], v94 offset:0
    s_add_u32 m0, s56, 49152
    v_mfma_f32_32x32x16_bf16 v[160:175], a[180:183], a[120:123], v[160:175]
    ds_read_b64_tr_b16 a[154:155], v94 offset:1024
    ds_read_b64_tr_b16 a[156:157], v95 offset:0
    buffer_load_dwordx4 v54, s[28:31], s64 offen nt lds
    v_mfma_f32_32x32x16_bf16 v[176:191], a[184:187], a[120:123], v[176:191]
    ds_read_b64_tr_b16 a[158:159], v95 offset:1024
    ds_read_b64_tr_b16 a[160:161], v92 offset:8192
    ds_read_b64_tr_b16 a[162:163], v92 offset:9216
    buffer_load_dwordx4 v54, s[28:31], s64 offen offset:1024 nt lds
    v_mfma_f32_32x32x16_bf16 v[192:207], a[188:191], a[120:123], v[192:207]
    ds_read_b64_tr_b16 a[164:165], v93 offset:8192
    ds_read_b64_tr_b16 a[166:167], v93 offset:9216
    v_mfma_f32_32x32x16_bf16 v[144:159], a[192:195], a[124:127], v[144:159]
    ds_read_b64_tr_b16 a[168:169], v94 offset:8192
    ds_read_b64_tr_b16 a[170:171], v94 offset:9216
    s_add_u32 m0, s56, 57344
    v_mfma_f32_32x32x16_bf16 v[160:175], a[196:199], a[124:127], v[160:175]
    ds_read_b64_tr_b16 a[172:173], v95 offset:8192
    ds_read_b64_tr_b16 a[174:175], v95 offset:9216
    buffer_load_dwordx4 v52, s[24:27], s66 offen nt lds
    v_mfma_f32_32x32x16_bf16 v[176:191], a[200:203], a[124:127], v[176:191]
    buffer_load_dwordx4 v53, s[24:27], s66 offen offset:1024 nt lds
    v_mfma_f32_32x32x16_bf16 v[192:207], a[204:207], a[124:127], v[192:207]
    s_waitcnt vmcnt(8) lgkmcnt(0)
    s_barrier
    ds_read_b64_tr_b16 a[176:177], v92 offset:16384
    ds_read_b64_tr_b16 a[178:179], v92 offset:17408
    ds_read_b64_tr_b16 a[192:193], v92 offset:24576
    ds_read_b64_tr_b16 a[194:195], v92 offset:25600
    v_mfma_f32_32x32x16_bf16 v[144:159], a[144:147], a[128:131], v[144:159]
    ds_read_b64_tr_b16 a[180:181], v93 offset:16384
    ds_read_b64_tr_b16 a[182:183], v93 offset:17408
    ds_read_b64_tr_b16 a[196:197], v93 offset:24576
    v_mfma_f32_32x32x16_bf16 v[144:159], a[160:163], a[132:135], v[144:159]
    ds_read_b64_tr_b16 a[198:199], v93 offset:25600
    ds_read_b64_tr_b16 a[184:185], v94 offset:16384
    ds_read_b64_tr_b16 a[186:187], v94 offset:17408
    v_mfma_f32_32x32x16_bf16 v[160:175], a[148:151], a[128:131], v[160:175]
    ds_read_b64_tr_b16 a[200:201], v94 offset:24576
    ds_read_b64_tr_b16 a[202:203], v94 offset:25600
    ds_read_b64_tr_b16 a[188:189], v95 offset:16384
    s_add_u32 m0, s56, 65536
    s_nop 0
    buffer_load_dwordx4 v54, s[28:31], s65 offen nt lds
    v_mfma_f32_32x32x16_bf16 v[160:175], a[164:167], a[132:135], v[160:175]
    ds_read_b64_tr_b16 a[190:191], v95 offset:17408
    ds_read_b64_tr_b16 a[204:205], v95 offset:24576
    ds_read_b64_tr_b16 a[206:207], v95 offset:25600
    buffer_load_dwordx4 v54, s[28:31], s65 offen offset:1024 nt lds
    s_add_u32 m0, s56, 73728
    s_waitcnt lgkmcnt(14)
    v_mfma_f32_32x32x16_bf16 v[144:159], a[176:179], a[136:139], v[144:159]
    buffer_load_dwordx4 v52, s[24:27], s67 offen nt lds
    buffer_load_dwordx4 v53, s[24:27], s67 offen offset:1024 nt lds
    s_waitcnt lgkmcnt(12)
    v_mfma_f32_32x32x16_bf16 v[144:159], a[192:195], a[140:143], v[144:159]
    s_add_u32 m0, s56, 81920
    s_nop 0
    buffer_load_dwordx4 v54, s[28:31], s66 offen nt lds
    s_waitcnt lgkmcnt(10)
    v_mfma_f32_32x32x16_bf16 v[160:175], a[180:183], a[136:139], v[160:175]
    buffer_load_dwordx4 v54, s[28:31], s66 offen offset:1024 nt lds
    s_add_u32 m0, s56, 90112
    s_waitcnt lgkmcnt(8)
    v_mfma_f32_32x32x16_bf16 v[160:175], a[196:199], a[140:143], v[160:175]
    buffer_load_dwordx4 v52, s[24:27], s68 offen nt lds
    buffer_load_dwordx4 v53, s[24:27], s68 offen offset:1024 nt lds
    s_nop 0
    v_mul_f32 v144, s58, v144
    v_mul_f32 v145, s58, v145
    v_mul_f32 v146, s58, v146
    v_mul_f32 v147, s58, v147
    v_mul_f32 v148, s58, v148
    v_mul_f32 v149, s58, v149
    v_mfma_f32_32x32x16_bf16 v[176:191], a[152:155], a[128:131], v[176:191]
    v_mul_f32 v150, s58, v150
    v_mul_f32 v151, s58, v151
    v_mul_f32 v152, s58, v152
    v_mul_f32 v153, s58, v153
    v_mul_f32 v154, s58, v154
    v_mul_f32 v155, s58, v155
    v_mfma_f32_32x32x16_bf16 v[176:191], a[168:171], a[132:135], v[176:191]
    v_mul_f32 v156, s58, v156
    v_mul_f32 v157, s58, v157
    v_mul_f32 v158, s58, v158
    v_mul_f32 v159, s58, v159
    v_cvt_pk_bf16_f32 v224, v144, v145
    v_cvt_pk_bf16_f32 v225, v146, v147
    s_waitcnt lgkmcnt(6)
    v_mfma_f32_32x32x16_bf16 v[176:191], a[184:187], a[136:139], v[176:191]
    v_cvt_pk_bf16_f32 v226, v148, v149
    v_cvt_pk_bf16_f32 v227, v150, v151
    v_cvt_pk_bf16_f32 v228, v152, v153
    v_cvt_pk_bf16_f32 v229, v154, v155
    v_cvt_pk_bf16_f32 v230, v156, v157
    v_cvt_pk_bf16_f32 v231, v158, v159
    s_waitcnt lgkmcnt(4)
    v_mfma_f32_32x32x16_bf16 v[176:191], a[200:203], a[140:143], v[176:191]
    v_mul_f32 v160, s58, v160
    v_mul_f32 v161, s58, v161
    v_mul_f32 v162, s58, v162
    v_mul_f32 v163, s58, v163
    v_mul_f32 v164, s58, v164
    v_mul_f32 v165, s58, v165
    v_mul_f32 v166, s58, v166
    v_mul_f32 v167, s58, v167
    v_mfma_f32_32x32x16_bf16 v[192:207], a[156:159], a[128:131], v[192:207]
    v_mul_f32 v168, s58, v168
    v_mul_f32 v169, s58, v169
    v_mul_f32 v170, s58, v170
    v_mul_f32 v171, s58, v171
    v_mul_f32 v172, s58, v172
    v_mul_f32 v173, s58, v173
    v_mul_f32 v174, s58, v174
    v_mul_f32 v175, s58, v175
    v_mfma_f32_32x32x16_bf16 v[192:207], a[172:175], a[132:135], v[192:207]
    v_cvt_pk_bf16_f32 v232, v160, v161
    v_cvt_pk_bf16_f32 v233, v162, v163
    v_cvt_pk_bf16_f32 v234, v164, v165
    v_cvt_pk_bf16_f32 v235, v166, v167
    v_cvt_pk_bf16_f32 v236, v168, v169
    v_cvt_pk_bf16_f32 v237, v170, v171
    v_cvt_pk_bf16_f32 v238, v172, v173
    v_cvt_pk_bf16_f32 v239, v174, v175
    s_waitcnt lgkmcnt(2)
    v_mfma_f32_32x32x16_bf16 v[192:207], a[188:191], a[136:139], v[192:207]
    v_mul_f32 v176, s58, v176
    v_mul_f32 v177, s58, v177
    v_mul_f32 v178, s58, v178
    v_mul_f32 v179, s58, v179
    v_mul_f32 v180, s58, v180
    v_mul_f32 v181, s58, v181
    v_mul_f32 v182, s58, v182
    v_mul_f32 v183, s58, v183
    v_mul_f32 v184, s58, v184
    v_mul_f32 v185, s58, v185
    v_mul_f32 v186, s58, v186
    v_mul_f32 v187, s58, v187
    s_waitcnt lgkmcnt(0)
    v_mfma_f32_32x32x16_bf16 v[192:207], a[204:207], a[140:143], v[192:207]
    v_mul_f32 v188, s58, v188
    v_mul_f32 v189, s58, v189
    v_mul_f32 v190, s58, v190
    v_mul_f32 v191, s58, v191
    v_cvt_pk_bf16_f32 v240, v176, v177
    v_cvt_pk_bf16_f32 v241, v178, v179
    v_cvt_pk_bf16_f32 v242, v180, v181
    v_cvt_pk_bf16_f32 v243, v182, v183
    v_cvt_pk_bf16_f32 v244, v184, v185
    v_cvt_pk_bf16_f32 v245, v186, v187
    v_cvt_pk_bf16_f32 v246, v188, v189
    v_cvt_pk_bf16_f32 v247, v190, v191
    v_mul_f32 v192, s58, v192
    v_mul_f32 v193, s58, v193
    v_mul_f32 v194, s58, v194
    v_mul_f32 v195, s58, v195
    v_mul_f32 v196, s58, v196
    v_mul_f32 v197, s58, v197
    v_mul_f32 v198, s58, v198
    v_mul_f32 v199, s58, v199
    v_mul_f32 v200, s58, v200
    v_mul_f32 v201, s58, v201
    v_mul_f32 v202, s58, v202
    v_mul_f32 v203, s58, v203
    v_mul_f32 v204, s58, v204
    v_mul_f32 v205, s58, v205
    v_mul_f32 v206, s58, v206
    v_mul_f32 v207, s58, v207
    v_cvt_pk_bf16_f32 v248, v192, v193
    v_cvt_pk_bf16_f32 v249, v194, v195
    v_cvt_pk_bf16_f32 v250, v196, v197
    v_cvt_pk_bf16_f32 v251, v198, v199
    v_cvt_pk_bf16_f32 v252, v200, v201
    v_cvt_pk_bf16_f32 v253, v202, v203
    v_cvt_pk_bf16_f32 v254, v204, v205
    v_cvt_pk_bf16_f32 v255, v206, v207
    s_waitcnt vmcnt(10)
    s_barrier
    ds_read_b128 a[0:3], v16 offset:32768
    ds_read_b128 a[4:7], v17 offset:32768
    ds_read_b128 a[8:11], v18 offset:32768
    ds_read_b128 a[12:15], v19 offset:32768
    ds_read_b128 a[16:19], v20 offset:32768
    ds_read_b128 a[20:23], v21 offset:32768
    ds_read_b128 a[24:27], v22 offset:32768
    ds_read_b128 a[28:31], v23 offset:32768
    s_waitcnt lgkmcnt(7)
    v_mfma_f32_32x32x16_bf16 v[80:95], a[0:3], v[224:227], 0
    ds_read_b128 a[32:35], v16 offset:40960
    ds_read_b128 a[36:39], v17 offset:40960
    ds_read_b128 a[40:43], v18 offset:40960
    s_add_u32 m0, s56, 0
    s_waitcnt lgkmcnt(9)
    v_mfma_f32_32x32x16_bf16 v[80:95], a[4:7], v[228:231], v[80:95]
    ds_read_b128 a[44:47], v19 offset:40960
    ds_read_b128 a[48:51], v20 offset:40960
    ds_read_b128 a[52:55], v21 offset:40960
    buffer_load_dwordx4 v54, s[28:31], s67 offen nt lds
    s_waitcnt lgkmcnt(11)
    v_mfma_f32_32x32x16_bf16 v[80:95], a[8:11], v[232:235], v[80:95]
    ds_read_b128 a[56:59], v22 offset:40960
    ds_read_b128 a[60:63], v23 offset:40960
    buffer_load_dwordx4 v54, s[28:31], s67 offen offset:1024 nt lds
    s_waitcnt lgkmcnt(12)
    v_mfma_f32_32x32x16_bf16 v[80:95], a[12:15], v[236:239], v[80:95]
    ds_read_b64_tr_b16 a[192:193], v40 offset:49152
    ds_read_b64_tr_b16 a[194:195], v40 offset:51200
    ds_read_b64_tr_b16 a[196:197], v41 offset:49152
    ds_read_b64_tr_b16 a[198:199], v41 offset:51200
    s_waitcnt lgkmcnt(14)
    v_mfma_f32_32x32x16_bf16 v[80:95], a[16:19], v[240:243], v[80:95]
    ds_read_b64_tr_b16 a[200:201], v42 offset:49152
    ds_read_b64_tr_b16 a[202:203], v42 offset:51200
    ds_read_b64_tr_b16 a[204:205], v43 offset:49152
    v_mfma_f32_32x32x16_bf16 v[80:95], a[20:23], v[244:247], v[80:95]
    ds_read_b64_tr_b16 a[206:207], v43 offset:51200
    ds_read_b64_tr_b16 a[208:209], v40 offset:53248
    ds_read_b64_tr_b16 a[210:211], v40 offset:55296
    s_waitcnt lgkmcnt(14)
    v_mfma_f32_32x32x16_bf16 v[80:95], a[24:27], v[248:251], v[80:95]
    ds_read_b64_tr_b16 a[212:213], v41 offset:53248
    ds_read_b64_tr_b16 a[214:215], v41 offset:55296
    ds_read_b64_tr_b16 a[216:217], v42 offset:53248
    v_mfma_f32_32x32x16_bf16 v[80:95], a[28:31], v[252:255], v[80:95]
    ds_read_b64_tr_b16 a[218:219], v42 offset:55296
    ds_read_b64_tr_b16 a[220:221], v43 offset:53248
    ds_read_b64_tr_b16 a[222:223], v43 offset:55296
    v_mfma_f32_32x32x16_bf16 v[96:111], a[32:35], v[224:227], 0
    v_mfma_f32_32x32x16_bf16 v[96:111], a[36:39], v[228:231], v[96:111]
    s_nop 6
    v_max3_f32 v68, v80, v81, v82
    v_max3_f32 v69, v83, v84, v85
    v_max3_f32 v68, v68, v86, v87
    v_max3_f32 v69, v69, v88, v89
    v_max3_f32 v68, v68, v90, v91
    v_max3_f32 v69, v69, v92, v93
    v_max3_f32 v68, v68, v94, v95
    v_max_f32 v68, v68, v69
    v_mov_b32 v69, v68
    s_nop 1
    v_permlane32_swap_b32 v68, v69
    v_mfma_f32_32x32x16_bf16 v[96:111], a[40:43], v[232:235], v[96:111]
    v_max_f32 v68, v68, v69
    v_sub_f32 v80, v80, v68
    v_sub_f32 v81, v81, v68
    v_sub_f32 v82, v82, v68
    v_sub_f32 v83, v83, v68
    v_sub_f32 v84, v84, v68
    v_sub_f32 v85, v85, v68
    v_sub_f32 v86, v86, v68
    v_sub_f32 v87, v87, v68
    v_sub_f32 v88, v88, v68
    v_mfma_f32_32x32x16_bf16 v[96:111], a[44:47], v[236:239], v[96:111]
    v_sub_f32 v89, v89, v68
    v_sub_f32 v90, v90, v68
    v_sub_f32 v91, v91, v68
    v_sub_f32 v92, v92, v68
    v_sub_f32 v93, v93, v68
    v_sub_f32 v94, v94, v68
    v_sub_f32 v95, v95, v68
    v_exp_f32 v80, v80
    v_exp_f32 v81, v81
    s_waitcnt lgkmcnt(14)
    v_mfma_f32_32x32x16_bf16 v[96:111], a[48:51], v[240:243], v[96:111]
    v_exp_f32 v82, v82
    v_exp_f32 v83, v83
    v_cvt_pk_bf16_f32 v128, v80, v81
    v_exp_f32 v84, v84
    v_exp_f32 v85, v85
    v_cvt_pk_bf16_f32 v129, v82, v83
    v_exp_f32 v86, v86
    v_exp_f32 v87, v87
    v_cvt_pk_bf16_f32 v130, v84, v85
    v_exp_f32 v88, v88
    v_mfma_f32_32x32x16_bf16 v[96:111], a[52:55], v[244:247], v[96:111]
    v_exp_f32 v89, v89
    v_cvt_pk_bf16_f32 v131, v86, v87
    v_exp_f32 v90, v90
    v_exp_f32 v91, v91
    v_cvt_pk_bf16_f32 v132, v88, v89
    v_exp_f32 v92, v92
    v_exp_f32 v93, v93
    v_cvt_pk_bf16_f32 v133, v90, v91
    v_exp_f32 v94, v94
    v_mfma_f32_32x32x16_bf16 v[96:111], a[56:59], v[248:251], v[96:111]
    v_exp_f32 v95, v95
    v_cvt_pk_bf16_f32 v134, v92, v93
    v_cvt_pk_bf16_f32 v135, v94, v95
    v_sub_f32 v112, 0, v68
    v_sub_f32 v113, 0, v68
    v_sub_f32 v114, 0, v68
    v_sub_f32 v115, 0, v68
    v_sub_f32 v116, 0, v68
    v_sub_f32 v117, 0, v68
    v_sub_f32 v118, 0, v68
    v_mfma_f32_32x32x16_bf16 v[96:111], a[60:63], v[252:255], v[96:111]
    v_sub_f32 v119, 0, v68
    v_sub_f32 v120, 0, v68
    v_sub_f32 v121, 0, v68
    v_sub_f32 v122, 0, v68
    v_sub_f32 v123, 0, v68
    v_sub_f32 v124, 0, v68
    v_sub_f32 v125, 0, v68
    v_sub_f32 v126, 0, v68
    v_sub_f32 v127, 0, v68
    s_waitcnt vmcnt(8) lgkmcnt(0)
    s_barrier
    v_mfma_f32_32x32x16_bf16 v[144:159], a[192:195], v[128:131], 0
    ds_read_b128 a[0:3], v16 offset:57344
    ds_read_b128 a[4:7], v17 offset:57344
    s_add_u32 m0, s56, 8192
    s_nop 0
    buffer_load_dwordx4 v52, s[24:27], s69 offen nt lds
    ds_read_b128 a[8:11], v18 offset:57344
    v_mfma_f32_32x32x16_bf16 v[160:175], a[196:199], v[128:131], 0
    v_add_f32 v96, v96, v112
    v_add_f32 v97, v97, v112
    v_add_f32 v98, v98, v112
    v_add_f32 v99, v99, v112
    v_add_f32 v100, v100, v112
    v_add_f32 v101, v101, v112
    v_add_f32 v102, v102, v112
    v_mfma_f32_32x32x16_bf16 v[176:191], a[200:203], v[128:131], 0
    v_add_f32 v103, v103, v112
    v_add_f32 v104, v104, v112
    v_add_f32 v105, v105, v112
    v_add_f32 v106, v106, v112
    v_add_f32 v107, v107, v112
    v_add_f32 v108, v108, v112
    v_add_f32 v109, v109, v112
    v_add_f32 v110, v110, v112
    v_mfma_f32_32x32x16_bf16 v[192:207], a[204:207], v[128:131], 0
    v_add_f32 v111, v111, v112
    v_max3_f32 v68, v96, v97, v98
    v_max3_f32 v69, v99, v100, v101
    v_max3_f32 v68, v68, v102, v103
    v_max3_f32 v69, v69, v104, v105
    v_max3_f32 v68, v68, v106, v107
    v_mfma_f32_16x16x32_bf16 v[208:211], a[240:243], v[128:131], 0
    v_max3_f32 v69, v69, v108, v109
    v_max3_f32 v68, v68, v110, v111
    v_mfma_f32_32x32x16_bf16 v[144:159], a[208:211], v[132:135], v[144:159]
    v_max_f32 v68, v68, v69
    v_cmp_lt_f32 vcc, 0x41000000, v68
    s_cbranch_vccnz L_stubB1
L_backB1:
    ds_read_b128 a[12:15], v19 offset:57344
    v_exp_f32 v96, v96
    v_mfma_f32_32x32x16_bf16 v[160:175], a[212:215], v[132:135], v[160:175]
    ds_read_b128 a[16:19], v20 offset:57344
    ds_read_b128 a[20:23], v21 offset:57344
    v_exp_f32 v97, v97
    v_exp_f32 v98, v98
    v_mfma_f32_32x32x16_bf16 v[176:191], a[216:219], v[132:135], v[176:191]
    ds_read_b128 a[24:27], v22 offset:57344
    ds_read_b128 a[28:31], v23 offset:57344
    v_exp_f32 v99, v99
    v_cvt_pk_bf16_f32 v136, v96, v97
    ds_read_b64_tr_b16 a[32:33], v44 offset:0
    v_mfma_f32_32x32x16_bf16 v[192:207], a[220:223], v[132:135], v[192:207]
    v_exp_f32 v100, v100
    v_exp_f32 v101, v101
    v_cvt_pk_bf16_f32 v137, v98, v99
    v_exp_f32 v102, v102
    v_mfma_f32_16x16x32_bf16 v[208:211], a[240:243], v[132:135], v[208:211]
    s_waitcnt lgkmcnt(1)
    v_exp_f32 v103, v103
    v_mfma_f32_32x32x16_bf16 v[80:95], a[0:3], v[224:227], v[112:127]
    ds_read_b64_tr_b16 a[34:35], v44 offset:2048
    ds_read_b64_tr_b16 a[36:37], v45 offset:0
    v_cvt_pk_bf16_f32 v138, v100, v101
    ds_read_b64_tr_b16 a[38:39], v45 offset:2048
    buffer_load_dwordx4 v53, s[24:27], s69 offen offset:1024 nt lds
    v_mfma_f32_32x32x16_bf16 v[80:95], a[4:7], v[228:231], v[80:95]
    ds_read_b64_tr_b16 a[40:41], v46 offset:0
    v_exp_f32 v104, v104
    ds_read_b64_tr_b16 a[42:43], v46 offset:2048
    s_add_u32 m0, s56, 16384
    v_exp_f32 v105, v105
    v_mfma_f32_32x32x16_bf16 v[80:95], a[8:11], v[232:235], v[80:95]
    ds_read_b64_tr_b16 a[44:45], v47 offset:0
    buffer_load_dwordx4 v54, s[28:31], s68 offen nt lds
    ds_read_b64_tr_b16 a[46:47], v47 offset:2048
    v_cvt_pk_bf16_f32 v139, v102, v103
    ds_read_b64_tr_b16 a[48:49], v44 offset:4096
    v_mfma_f32_32x32x16_bf16 v[80:95], a[12:15], v[236:239], v[80:95]
    buffer_load_dwordx4 v54, s[28:31], s68 offen offset:1024 nt lds
    ds_read_b64_tr_b16 a[50:51], v44 offset:6144
    v_exp_f32 v106, v106
    ds_read_b64_tr_b16 a[52:53], v45 offset:4096
    v_mfma_f32_32x32x16_bf16 v[80:95], a[16:19], v[240:243], v[80:95]
    ds_read_b64_tr_b16 a[54:55], v45 offset:6144
    s_add_u32 m0, s57, 98304
    ds_read_b64_tr_b16 a[56:57], v46 offset:4096
    v_exp_f32 v107, v107
    buffer_load_dwordx4 v63, s[36:39], s54 offen lds
    v_mfma_f32_32x32x16_bf16 v[80:95], a[20:23], v[244:247], v[80:95]
    ds_read_b64_tr_b16 a[58:59], v46 offset:6144
    ds_read_b64_tr_b16 a[60:61], v47 offset:4096
    ds_read_b64_tr_b16 a[62:63], v47 offset:6144
    buffer_load_dwordx4 v64, s[36:39], s54 offen offset:1024 lds
    v_cvt_pk_bf16_f32 v140, v104, v105
    v_mfma_f32_32x32x16_bf16 v[80:95], a[24:27], v[248:251], v[80:95]
    buffer_load_dwordx4 v65, s[36:39], s54 offen offset:2048 lds
    buffer_load_dwordx4 v66, s[36:39], s54 offen offset:3072 lds
    v_exp_f32 v108, v108
    v_mfma_f32_32x32x16_bf16 v[80:95], a[28:31], v[252:255], v[80:95]
    v_exp_f32 v109, v109
    v_cvt_pk_bf16_f32 v141, v106, v107
    v_exp_f32 v110, v110
    v_exp_f32 v111, v111
    v_cvt_pk_bf16_f32 v142, v108, v109
    v_cvt_pk_bf16_f32 v143, v110, v111
    s_waitcnt vmcnt(12) lgkmcnt(0)
    s_barrier
    v_mfma_f32_32x32x16_bf16 v[144:159], a[32:35], v[136:139], v[144:159]
    ds_read_b128 a[0:3], v24 offset:8192
    ds_read_b128 a[4:7], v25 offset:8192
    ds_read_b128 a[8:11], v26 offset:8192
    ds_read_b128 a[12:15], v27 offset:8192
    v_mfma_f32_32x32x16_bf16 v[160:175], a[36:39], v[136:139], v[160:175]
    v_max3_f32 v68, v80, v81, v82
    v_max3_f32 v69, v83, v84, v85
    v_max3_f32 v68, v68, v86, v87
    v_max3_f32 v69, v69, v88, v89
    v_max3_f32 v68, v68, v90, v91
    v_mfma_f32_32x32x16_bf16 v[176:191], a[40:43], v[136:139], v[176:191]
    v_max3_f32 v69, v69, v92, v93
    v_max3_f32 v68, v68, v94, v95
    v_max_f32 v68, v68, v69
    v_cmp_lt_f32 vcc, 0x41000000, v68
    s_cbranch_vccnz L_stubB2
L_backB2:
    v_mfma_f32_32x32x16_bf16 v[192:207], a[44:47], v[136:139], v[192:207]
    v_exp_f32 v80, v80
    v_exp_f32 v81, v81
    v_exp_f32 v82, v82
    v_mfma_f32_16x16x32_bf16 v[208:211], a[240:243], v[136:139], v[208:211]
    v_exp_f32 v83, v83
    v_mfma_f32_32x32x16_bf16 v[144:159], a[48:51], v[140:143], v[144:159]
    ds_read_b128 a[16:19], v28 offset:8192
    v_cvt_pk_bf16_f32 v128, v80, v81
    v_exp_f32 v84, v84
    ds_read_b128 a[20:23], v29 offset:8192
    v_mfma_f32_32x32x16_bf16 v[160:175], a[52:55], v[140:143], v[160:175]
    ds_read_b128 a[24:27], v30 offset:8192
    v_exp_f32 v85, v85
    v_cvt_pk_bf16_f32 v129, v82, v83
    ds_read_b64_tr_b16 a[192:193], v44 offset:16384
    v_mfma_f32_32x32x16_bf16 v[176:191], a[56:59], v[140:143], v[176:191]
    ds_read_b128 a[28:31], v31 offset:8192
    v_exp_f32 v86, v86
    v_exp_f32 v87, v87
    v_mfma_f32_32x32x16_bf16 v[192:207], a[60:63], v[140:143], v[192:207]
    ds_read_b64_tr_b16 a[194:195], v44 offset:18432
    v_cvt_pk_bf16_f32 v130, v84, v85
    ds_read_b64_tr_b16 a[196:197], v45 offset:16384
    v_exp_f32 v88, v88
    v_mfma_f32_16x16x32_bf16 v[208:211], a[240:243], v[140:143], v[208:211]
    s_waitcnt lgkmcnt(2)
    ds_read_b64_tr_b16 a[198:199], v45 offset:18432
    v_mfma_f32_32x32x16_bf16 v[96:111], a[0:3], v[224:227], v[112:127]
    ds_read_b64_tr_b16 a[200:201], v46 offset:16384
    v_exp_f32 v89, v89
    ds_read_b64_tr_b16 a[202:203], v46 offset:18432
    v_cvt_pk_bf16_f32 v131, v86, v87
    v_mfma_f32_32x32x16_bf16 v[96:111], a[4:7], v[228:231], v[96:111]
    ds_read_b64_tr_b16 a[204:205], v47 offset:16384
    v_exp_f32 v90, v90
    ds_read_b64_tr_b16 a[206:207], v47 offset:18432
    ds_read_b64_tr_b16 a[208:209], v44 offset:20480
    v_mfma_f32_32x32x16_bf16 v[96:111], a[8:11], v[232:235], v[96:111]
    v_exp_f32 v91, v91
    s_add_u32 m0, s56, 24576
    ds_read_b64_tr_b16 a[210:211], v44 offset:22528
    v_cvt_pk_bf16_f32 v132, v88, v89
    v_mfma_f32_32x32x16_bf16 v[96:111], a[12:15], v[236:239], v[96:111]
    ds_read_b64_tr_b16 a[212:213], v45 offset:20480
    buffer_load_dwordx4 v52, s[24:27], s70 offen nt lds
    ds_read_b64_tr_b16 a[214:215], v45 offset:22528
    ds_read_b64_tr_b16 a[216:217], v46 offset:20480
    v_mfma_f32_32x32x16_bf16 v[96:111], a[16:19], v[240:243], v[96:111]
    buffer_load_dwordx4 v53, s[24:27], s70 offen offset:1024 nt lds
    v_exp_f32 v92, v92
    ds_read_b64_tr_b16 a[218:219], v46 offset:22528
    v_mfma_f32_32x32x16_bf16 v[96:111], a[20:23], v[244:247], v[96:111]
    ds_read_b64_tr_b16 a[220:221], v47 offset:20480
    ds_read_b64_tr_b16 a[222:223], v47 offset:22528
    s_add_u32 m0, s56, 32768
    s_nop 0
    buffer_load_dwordx4 v54, s[28:31], s69 offen nt lds
    v_mfma_f32_32x32x16_bf16 v[96:111], a[24:27], v[248:251], v[96:111]
    buffer_load_dwordx4 v54, s[28:31], s69 offen offset:1024 nt lds
    v_exp_f32 v93, v93
    v_cvt_pk_bf16_f32 v133, v90, v91
    v_mfma_f32_32x32x16_bf16 v[96:111], a[28:31], v[252:255], v[96:111]
    v_exp_f32 v94, v94
    v_exp_f32 v95, v95
    v_cvt_pk_bf16_f32 v134, v92, v93
    v_cvt_pk_bf16_f32 v135, v94, v95
    s_waitcnt vmcnt(12) lgkmcnt(0)
    s_barrier
    v_mfma_f32_32x32x16_bf16 v[144:159], a[192:195], v[128:131], v[144:159]
    ds_read_b128 a[0:3], v24 offset:24576
    s_add_u32 m0, s56, 40960
    s_nop 0
    buffer_load_dwordx4 v52, s[24:27], s71 offen nt lds
    ds_read_b128 a[4:7], v25 offset:24576
    v_mfma_f32_32x32x16_bf16 v[160:175], a[196:199], v[128:131], v[160:175]
    v_max3_f32 v68, v96, v97, v98
    v_max3_f32 v69, v99, v100, v101
    v_max3_f32 v68, v68, v102, v103
    v_max3_f32 v69, v69, v104, v105
    v_max3_f32 v68, v68, v106, v107
    v_mfma_f32_32x32x16_bf16 v[176:191], a[200:203], v[128:131], v[176:191]
    v_max3_f32 v69, v69, v108, v109
    v_max3_f32 v68, v68, v110, v111
    v_max_f32 v68, v68, v69
    v_cmp_lt_f32 vcc, 0x41000000, v68
    s_cbranch_vccnz L_stubB3
L_backB3:
    ds_read_b128 a[8:11], v26 offset:24576
    v_mfma_f32_32x32x16_bf16 v[192:207], a[204:207], v[128:131], v[192:207]
    v_exp_f32 v96, v96
    v_exp_f32 v97, v97
    v_exp_f32 v98, v98
    v_mfma_f32_16x16x32_bf16 v[208:211], a[240:243], v[128:131], v[208:211]
    v_exp_f32 v99, v99
    v_mfma_f32_32x32x16_bf16 v[144:159], a[208:211], v[132:135], v[144:159]
    ds_read_b128 a[12:15], v27 offset:24576
    ds_read_b128 a[16:19], v28 offset:24576
    v_cvt_pk_bf16_f32 v136, v96, v97
    v_exp_f32 v100, v100
    v_mfma_f32_32x32x16_bf16 v[160:175], a[212:215], v[132:135], v[160:175]
    ds_read_b128 a[20:23], v29 offset:24576
    ds_read_b128 a[24:27], v30 offset:24576
    v_exp_f32 v101, v101
    v_cvt_pk_bf16_f32 v137, v98, v99
    v_mfma_f32_32x32x16_bf16 v[176:191], a[216:219], v[132:135], v[176:191]
    ds_read_b128 a[28:31], v31 offset:24576
    v_exp_f32 v102, v102
    buffer_load_dwordx4 v53, s[24:27], s71 offen offset:1024 nt lds
    ds_read_b64_tr_b16 a[32:33], v40 offset:0
    v_mfma_f32_32x32x16_bf16 v[192:207], a[220:223], v[132:135], v[192:207]
    v_exp_f32 v103, v103
    ds_read_b64_tr_b16 a[34:35], v40 offset:2048
    s_add_u32 m0, s56, 49152
    v_cvt_pk_bf16_f32 v138, v100, v101
    ds_read_b64_tr_b16 a[36:37], v41 offset:0
    v_mfma_f32_16x16x32_bf16 v[208:211], a[240:243], v[132:135], v[208:211]
    s_waitcnt lgkmcnt(3)
    ds_read_b64_tr_b16 a[38:39], v41 offset:2048
    v_mfma_f32_32x32x16_bf16 v[80:95], a[0:3], v[224:227], v[112:127]
    buffer_load_dwordx4 v54, s[28:31], s70 offen nt lds
    v_exp_f32 v104, v104
    ds_read_b64_tr_b16 a[40:41], v42 offset:0
    ds_read_b64_tr_b16 a[42:43], v42 offset:2048
    v_mfma_f32_32x32x16_bf16 v[80:95], a[4:7], v[228:231], v[80:95]
    buffer_load_dwordx4 v54, s[28:31], s70 offen offset:1024 nt lds
    v_exp_f32 v105, v105
    ds_read_b64_tr_b16 a[44:45], v43 offset:0
    s_add_u32 m0, s57, 102400
    v_mfma_f32_32x32x16_bf16 v[80:95], a[8:11], v[232:235], v[80:95]
    ds_read_b64_tr_b16 a[46:47], v43 offset:2048
    v_cvt_pk_bf16_f32 v139, v102, v103
    s_add_u32 s48, s54, 36864
    v_exp_f32 v106, v106
    ds_read_b64_tr_b16 a[48:49], v40 offset:4096
    v_mfma_f32_32x32x16_bf16 v[80:95], a[12:15], v[236:239], v[80:95]
    buffer_load_dwordx4 v63, s[36:39], s48 offen lds
    ds_read_b64_tr_b16 a[50:51], v40 offset:6144
    ds_read_b64_tr_b16 a[52:53], v41 offset:4096
    v_exp_f32 v107, v107
    v_mfma_f32_32x32x16_bf16 v[80:95], a[16:19], v[240:243], v[80:95]
    ds_read_b64_tr_b16 a[54:55], v41 offset:6144
    buffer_load_dwordx4 v64, s[36:39], s48 offen offset:1024 lds
    ds_read_b64_tr_b16 a[56:57], v42 offset:4096
    v_cvt_pk_bf16_f32 v140, v104, v105
    v_mfma_f32_32x32x16_bf16 v[80:95], a[20:23], v[244:247], v[80:95]
    ds_read_b64_tr_b16 a[58:59], v42 offset:6144
    ds_read_b64_tr_b16 a[60:61], v43 offset:4096
    ds_read_b64_tr_b16 a[62:63], v43 offset:6144
    buffer_load_dwordx4 v65, s[36:39], s48 offen offset:2048 lds
    v_mfma_f32_32x32x16_bf16 v[80:95], a[24:27], v[248:251], v[80:95]
    buffer_load_dwordx4 v66, s[36:39], s48 offen offset:3072 lds
    s_add_u32 s54, s54, 128
    s_sub_u32 s49, s54, 1152
    s_cselect_b32 s54, s54, s49
    v_mfma_f32_32x32x16_bf16 v[80:95], a[28:31], v[252:255], v[80:95]
    v_exp_f32 v108, v108
    v_exp_f32 v109, v109
    v_cvt_pk_bf16_f32 v141, v106, v107
    v_exp_f32 v110, v110
    v_exp_f32 v111, v111
    v_cvt_pk_bf16_f32 v142, v108, v109
    v_cvt_pk_bf16_f32 v143, v110, v111
    s_waitcnt vmcnt(16) lgkmcnt(0)
    s_barrier
    v_mfma_f32_32x32x16_bf16 v[144:159], a[32:35], v[136:139], v[144:159]
    ds_read_b128 a[0:3], v16 offset:8192
    ds_read_b128 a[4:7], v17 offset:8192
    ds_read_b128 a[8:11], v18 offset:8192
    ds_read_b128 a[12:15], v19 offset:8192
    v_mfma_f32_32x32x16_bf16 v[160:175], a[36:39], v[136:139], v[160:175]
    v_max3_f32 v68, v80, v81, v82
    v_max3_f32 v69, v83, v84, v85
    v_max3_f32 v68, v68, v86, v87
    v_max3_f32 v69, v69, v88, v89
    v_max3_f32 v68, v68, v90, v91
    v_mfma_f32_32x32x16_bf16 v[176:191], a[40:43], v[136:139], v[176:191]
    v_max3_f32 v69, v69, v92, v93
    v_max3_f32 v68, v68, v94, v95
    v_max_f32 v68, v68, v69
    v_cmp_lt_f32 vcc, 0x41000000, v68
    s_cbranch_vccnz L_stubB4
L_backB4:
    v_mfma_f32_32x32x16_bf16 v[192:207], a[44:47], v[136:139], v[192:207]
    v_exp_f32 v80, v80
    v_exp_f32 v81, v81
    v_exp_f32 v82, v82
    v_mfma_f32_16x16x32_bf16 v[208:211], a[240:243], v[136:139], v[208:211]
    v_exp_f32 v83, v83
    v_mfma_f32_32x32x16_bf16 v[144:159], a[48:51], v[140:143], v[144:159]
    ds_read_b128 a[16:19], v20 offset:8192
    v_cvt_pk_bf16_f32 v128, v80, v81
    v_exp_f32 v84, v84
    ds_read_b128 a[20:23], v21 offset:8192
    v_mfma_f32_32x32x16_bf16 v[160:175], a[52:55], v[140:143], v[160:175]
    ds_read_b128 a[24:27], v22 offset:8192
    v_exp_f32 v85, v85
    v_cvt_pk_bf16_f32 v129, v82, v83
    ds_read_b64_tr_b16 a[192:193], v40 offset:16384
    v_mfma_f32_32x32x16_bf16 v[176:191], a[56:59], v[140:143], v[176:191]
    ds_read_b128 a[28:31], v23 offset:8192
    v_exp_f32 v86, v86
    v_exp_f32 v87, v87
    v_mfma_f32_32x32x16_bf16 v[192:207], a[60:63], v[140:143], v[192:207]
    ds_read_b64_tr_b16 a[194:195], v40 offset:18432
    v_cvt_pk_bf16_f32 v130, v84, v85
    ds_read_b64_tr_b16 a[196:197], v41 offset:16384
    v_exp_f32 v88, v88
    v_mfma_f32_16x16x32_bf16 v[208:211], a[240:243], v[140:143], v[208:211]
    s_waitcnt lgkmcnt(2)
    ds_read_b64_tr_b16 a[198:199], v41 offset:18432
    v_mfma_f32_32x32x16_bf16 v[96:111], a[0:3], v[224:227], v[112:127]
    ds_read_b64_tr_b16 a[200:201], v42 offset:16384
    v_exp_f32 v89, v89
    ds_read_b64_tr_b16 a[202:203], v42 offset:18432
    v_cvt_pk_bf16_f32 v131, v86, v87
    v_mfma_f32_32x32x16_bf16 v[96:111], a[4:7], v[228:231], v[96:111]
    ds_read_b64_tr_b16 a[204:205], v43 offset:16384
    v_exp_f32 v90, v90
    ds_read_b64_tr_b16 a[206:207], v43 offset:18432
    ds_read_b64_tr_b16 a[208:209], v40 offset:20480
    v_mfma_f32_32x32x16_bf16 v[96:111], a[8:11], v[232:235], v[96:111]
    v_exp_f32 v91, v91
    s_add_u32 m0, s56, 57344
    ds_read_b64_tr_b16 a[210:211], v40 offset:22528
    v_cvt_pk_bf16_f32 v132, v88, v89
    v_mfma_f32_32x32x16_bf16 v[96:111], a[12:15], v[236:239], v[96:111]
    ds_read_b64_tr_b16 a[212:213], v41 offset:20480
    buffer_load_dwordx4 v52, s[24:27], s72 offen nt lds
    ds_read_b64_tr_b16 a[214:215], v41 offset:22528
    ds_read_b64_tr_b16 a[216:217], v42 offset:20480
    v_mfma_f32_32x32x16_bf16 v[96:111], a[16:19], v[240:243], v[96:111]
    buffer_load_dwordx4 v53, s[24:27], s72 offen offset:1024 nt lds
    v_exp_f32 v92, v92
    ds_read_b64_tr_b16 a[218:219], v42 offset:22528
    v_mfma_f32_32x32x16_bf16 v[96:111], a[20:23], v[244:247], v[96:111]
    ds_read_b64_tr_b16 a[220:221], v43 offset:20480
    ds_read_b64_tr_b16 a[222:223], v43 offset:22528
    s_add_u32 m0, s56, 65536
    s_nop 0
    buffer_load_dwordx4 v54, s[28:31], s71 offen nt lds
    v_mfma_f32_32x32x16_bf16 v[96:111], a[24:27], v[248:251], v[96:111]
    buffer_load_dwordx4 v54, s[28:31], s71 offen offset:1024 nt lds
    v_exp_f32 v93, v93
    v_cvt_pk_bf16_f32 v133, v90, v91
    v_mfma_f32_32x32x16_bf16 v[96:111], a[28:31], v[252:255], v[96:111]
    v_exp_f32 v94, v94
    v_exp_f32 v95, v95
    v_cvt_pk_bf16_f32 v134, v92, v93
    v_cvt_pk_bf16_f32 v135, v94, v95
    s_waitcnt vmcnt(12) lgkmcnt(0)
    s_barrier
    v_mfma_f32_32x32x16_bf16 v[144:159], a[192:195], v[128:131], v[144:159]
    ds_read_b128 a[0:3], v16 offset:24576
    ds_read_b128 a[4:7], v17 offset:24576
    s_add_u32 m0, s56, 73728
    s_nop 0
    buffer_load_dwordx4 v52, s[24:27], s73 offen nt lds
    v_mfma_f32_32x32x16_bf16 v[160:175], a[196:199], v[128:131], v[160:175]
    v_max3_f32 v68, v96, v97, v98
    v_max3_f32 v69, v99, v100, v101
    v_max3_f32 v68, v68, v102, v103
    v_max3_f32 v69, v69, v104, v105
    v_max3_f32 v68, v68, v106, v107
    v_mfma_f32_32x32x16_bf16 v[176:191], a[200:203], v[128:131], v[176:191]
    v_max3_f32 v69, v69, v108, v109
    v_max3_f32 v68, v68, v110, v111
    v_max_f32 v68, v68, v69
    v_cmp_lt_f32 vcc, 0x41000000, v68
    s_cbranch_vccnz L_stubB5
L_backB5:
    ds_read_b64_tr_b16 a[32:33], v40 offset:32768
    v_mfma_f32_32x32x16_bf16 v[192:207], a[204:207], v[128:131], v[192:207]
    v_exp_f32 v96, v96
    v_exp_f32 v97, v97
    v_exp_f32 v98, v98
    v_mfma_f32_16x16x32_bf16 v[208:211], a[240:243], v[128:131], v[208:211]
    ds_read_b128 a[8:11], v18 offset:24576
    v_mfma_f32_32x32x16_bf16 v[144:159], a[208:211], v[132:135], v[144:159]
    ds_read_b128 a[12:15], v19 offset:24576
    v_exp_f32 v99, v99
    ds_read_b128 a[16:19], v20 offset:24576
    v_cvt_pk_bf16_f32 v136, v96, v97
    v_mfma_f32_32x32x16_bf16 v[160:175], a[212:215], v[132:135], v[160:175]
    ds_read_b128 a[20:23], v21 offset:24576
    v_exp_f32 v100, v100
    ds_read_b128 a[24:27], v22 offset:24576
    v_exp_f32 v101, v101
    v_mfma_f32_32x32x16_bf16 v[176:191], a[216:219], v[132:135], v[176:191]
    ds_read_b128 a[28:31], v23 offset:24576
    v_cvt_pk_bf16_f32 v137, v98, v99
    v_exp_f32 v102, v102
    ds_read_b64_tr_b16 a[34:35], v40 offset:34816
    v_mfma_f32_32x32x16_bf16 v[192:207], a[220:223], v[132:135], v[192:207]
    v_exp_f32 v103, v103
    v_cvt_pk_bf16_f32 v138, v100, v101
    ds_read_b64_tr_b16 a[36:37], v41 offset:32768
    v_exp_f32 v104, v104
    v_mfma_f32_16x16x32_bf16 v[208:211], a[240:243], v[132:135], v[208:211]
    s_waitcnt lgkmcnt(2)
    ds_read_b64_tr_b16 a[38:39], v41 offset:34816
    v_mfma_f32_32x32x16_bf16 v[80:95], a[0:3], v[224:227], v[112:127]
    buffer_load_dwordx4 v53, s[24:27], s73 offen offset:1024 nt lds
    ds_read_b64_tr_b16 a[40:41], v42 offset:32768
    v_exp_f32 v105, v105
    s_add_u32 m0, s56, 81920
    v_mfma_f32_32x32x16_bf16 v[80:95], a[4:7], v[228:231], v[80:95]
    ds_read_b64_tr_b16 a[42:43], v42 offset:34816
    buffer_load_dwordx4 v54, s[28:31], s72 offen nt lds
    ds_read_b64_tr_b16 a[44:45], v43 offset:32768
    v_cvt_pk_bf16_f32 v139, v102, v103
    v_mfma_f32_32x32x16_bf16 v[80:95], a[8:11], v[232:235], v[80:95]
    ds_read_b64_tr_b16 a[46:47], v43 offset:34816
    v_exp_f32 v106, v106
    buffer_load_dwordx4 v54, s[28:31], s72 offen offset:1024 nt lds
    ds_read_b64_tr_b16 a[48:49], v40 offset:36864
    v_mfma_f32_32x32x16_bf16 v[80:95], a[12:15], v[236:239], v[80:95]
    ds_read_b64_tr_b16 a[50:51], v40 offset:38912
    ds_read_b64_tr_b16 a[52:53], v41 offset:36864
    v_exp_f32 v107, v107
    s_add_u32 m0, s57, 131072
    v_mfma_f32_32x32x16_bf16 v[80:95], a[16:19], v[240:243], v[80:95]
    ds_read_b64_tr_b16 a[54:55], v41 offset:38912
    ds_read_b64_tr_b16 a[56:57], v42 offset:36864
    buffer_load_dwordx4 v63, s[36:39], s54 offen lds
    v_cvt_pk_bf16_f32 v140, v104, v105
    v_mfma_f32_32x32x16_bf16 v[80:95], a[20:23], v[244:247], v[80:95]
    ds_read_b64_tr_b16 a[58:59], v42 offset:38912
    ds_read_b64_tr_b16 a[60:61], v43 offset:36864
    ds_read_b64_tr_b16 a[62:63], v43 offset:38912
    buffer_load_dwordx4 v64, s[36:39], s54 offen offset:1024 lds
    v_mfma_f32_32x32x16_bf16 v[80:95], a[24:27], v[248:251], v[80:95]
    buffer_load_dwordx4 v65, s[36:39], s54 offen offset:2048 lds
    buffer_load_dwordx4 v66, s[36:39], s54 offen offset:3072 lds
    v_exp_f32 v108, v108
    v_mfma_f32_32x32x16_bf16 v[80:95], a[28:31], v[252:255], v[80:95]
    v_exp_f32 v109, v109
    v_cvt_pk_bf16_f32 v141, v106, v107
    v_exp_f32 v110, v110
    v_exp_f32 v111, v111
    v_cvt_pk_bf16_f32 v142, v108, v109
    v_cvt_pk_bf16_f32 v143, v110, v111
    s_waitcnt vmcnt(16) lgkmcnt(0)
    s_barrier
    v_mfma_f32_32x32x16_bf16 v[144:159], a[32:35], v[136:139], v[144:159]
    ds_read_b128 a[0:3], v16 offset:40960
    ds_read_b128 a[4:7], v17 offset:40960
    ds_read_b128 a[8:11], v18 offset:40960
    ds_read_b128 a[12:15], v19 offset:40960
    v_mfma_f32_32x32x16_bf16 v[160:175], a[36:39], v[136:139], v[160:175]
    v_max3_f32 v68, v80, v81, v82
    v_max3_f32 v69, v83, v84, v85
    v_max3_f32 v68, v68, v86, v87
    v_max3_f32 v69, v69, v88, v89
    v_max3_f32 v68, v68, v90, v91
    v_mfma_f32_32x32x16_bf16 v[176:191], a[40:43], v[136:139], v[176:191]
    v_max3_f32 v69, v69, v92, v93
    v_max3_f32 v68, v68, v94, v95
    v_max_f32 v68, v68, v69
    v_cmp_lt_f32 vcc, 0x41000000, v68
    s_cbranch_vccnz L_stubB6
L_backB6:
    v_mfma_f32_32x32x16_bf16 v[192:207], a[44:47], v[136:139], v[192:207]
    v_exp_f32 v80, v80
    v_exp_f32 v81, v81
    v_exp_f32 v82, v82
    v_mfma_f32_16x16x32_bf16 v[208:211], a[240:243], v[136:139], v[208:211]
    v_exp_f32 v83, v83
    v_mfma_f32_32x32x16_bf16 v[144:159], a[48:51], v[140:143], v[144:159]
    ds_read_b128 a[16:19], v20 offset:40960
    v_cvt_pk_bf16_f32 v128, v80, v81
    v_exp_f32 v84, v84
    ds_read_b128 a[20:23], v21 offset:40960
    v_mfma_f32_32x32x16_bf16 v[160:175], a[52:55], v[140:143], v[160:175]
    ds_read_b128 a[24:27], v22 offset:40960
    v_exp_f32 v85, v85
    v_cvt_pk_bf16_f32 v129, v82, v83
    ds_read_b64_tr_b16 a[192:193], v40 offset:49152
    v_mfma_f32_32x32x16_bf16 v[176:191], a[56:59], v[140:143], v[176:191]
    ds_read_b128 a[28:31], v23 offset:40960
    v_exp_f32 v86, v86
    v_exp_f32 v87, v87
    v_mfma_f32_32x32x16_bf16 v[192:207], a[60:63], v[140:143], v[192:207]
    ds_read_b64_tr_b16 a[194:195], v40 offset:51200
    v_cvt_pk_bf16_f32 v130, v84, v85
    ds_read_b64_tr_b16 a[196:197], v41 offset:49152
    v_exp_f32 v88, v88
    v_mfma_f32_16x16x32_bf16 v[208:211], a[240:243], v[140:143], v[208:211]
    s_waitcnt lgkmcnt(2)
    ds_read_b64_tr_b16 a[198:199], v41 offset:51200
    v_mfma_f32_32x32x16_bf16 v[96:111], a[0:3], v[224:227], v[112:127]
    ds_read_b64_tr_b16 a[200:201], v42 offset:49152
    v_exp_f32 v89, v89
    ds_read_b64_tr_b16 a[202:203], v42 offset:51200
    v_cvt_pk_bf16_f32 v131, v86, v87
    v_mfma_f32_32x32x16_bf16 v[96:111], a[4:7], v[228:231], v[96:111]
    ds_read_b64_tr_b16 a[204:205], v43 offset:49152
    v_exp_f32 v90, v90
    ds_read_b64_tr_b16 a[206:207], v43 offset:51200
    ds_read_b64_tr_b16 a[208:209], v40 offset:53248
    v_mfma_f32_32x32x16_bf16 v[96:111], a[8:11], v[232:235], v[96:111]
    v_exp_f32 v91, v91
    s_add_u32 m0, s56, 90112
    ds_read_b64_tr_b16 a[210:211], v40 offset:55296
    v_cvt_pk_bf16_f32 v132, v88, v89
    v_mfma_f32_32x32x16_bf16 v[96:111], a[12:15], v[236:239], v[96:111]
    ds_read_b64_tr_b16 a[212:213], v41 offset:53248
    buffer_load_dwordx4 v52, s[24:27], s74 offen nt lds
    ds_read_b64_tr_b16 a[214:215], v41 offset:55296
    ds_read_b64_tr_b16 a[216:217], v42 offset:53248
    v_mfma_f32_32x32x16_bf16 v[96:111], a[16:19], v[240:243], v[96:111]
    buffer_load_dwordx4 v53, s[24:27], s74 offen offset:1024 nt lds
    v_exp_f32 v92, v92
    ds_read_b64_tr_b16 a[218:219], v42 offset:55296
    v_mfma_f32_32x32x16_bf16 v[96:111], a[20:23], v[244:247], v[96:111]
    ds_read_b64_tr_b16 a[220:221], v43 offset:53248
    ds_read_b64_tr_b16 a[222:223], v43 offset:55296
    s_add_u32 m0, s56, 0
    s_nop 0
    buffer_load_dwordx4 v54, s[28:31], s73 offen nt lds
    v_mfma_f32_32x32x16_bf16 v[96:111], a[24:27], v[248:251], v[96:111]
    buffer_load_dwordx4 v54, s[28:31], s73 offen offset:1024 nt lds
    v_exp_f32 v93, v93
    v_cvt_pk_bf16_f32 v133, v90, v91
    v_mfma_f32_32x32x16_bf16 v[96:111], a[28:31], v[252:255], v[96:111]
    v_exp_f32 v94, v94
    v_exp_f32 v95, v95
    v_cvt_pk_bf16_f32 v134, v92, v93
    v_cvt_pk_bf16_f32 v135, v94, v95
    s_waitcnt vmcnt(12) lgkmcnt(0)
    s_barrier
    v_mfma_f32_32x32x16_bf16 v[144:159], a[192:195], v[128:131], v[144:159]
    s_add_u32 m0, s56, 8192
    s_nop 0
    buffer_load_dwordx4 v52, s[24:27], s75 offen nt lds
    ds_read_b128 a[0:3], v16 offset:57344
    buffer_load_dwordx4 v53, s[24:27], s75 offen offset:1024 nt lds
    s_add_u32 m0, s56, 16384
    v_mfma_f32_32x32x16_bf16 v[160:175], a[196:199], v[128:131], v[160:175]
    v_max3_f32 v68, v96, v97, v98
    v_max3_f32 v69, v99, v100, v101
    v_max3_f32 v68, v68, v102, v103
    v_max3_f32 v69, v69, v104, v105
    v_max3_f32 v68, v68, v106, v107
    v_max3_f32 v69, v69, v108, v109
    v_mfma_f32_32x32x16_bf16 v[176:191], a[200:203], v[128:131], v[176:191]
    ds_read_b64_tr_b16 a[32:33], v44 offset:0
    v_max3_f32 v68, v68, v110, v111
    ds_read_b64_tr_b16 a[34:35], v44 offset:2048
    v_max_f32 v68, v68, v69
    v_cmp_lt_f32 vcc, 0x41000000, v68
    s_cbranch_vccnz L_stubB7
L_backB7:
    ds_read_b64_tr_b16 a[36:37], v45 offset:0
    v_mfma_f32_32x32x16_bf16 v[192:207], a[204:207], v[128:131], v[192:207]
    ds_read_b64_tr_b16 a[38:39], v45 offset:2048
    v_exp_f32 v96, v96
    ds_read_b64_tr_b16 a[40:41], v46 offset:0
    ds_read_b64_tr_b16 a[42:43], v46 offset:2048
    v_exp_f32 v97, v97
    v_mfma_f32_16x16x32_bf16 v[208:211], a[240:243], v[128:131], v[208:211]
    ds_read_b128 a[4:7], v17 offset:57344
    ds_read_b64_tr_b16 a[44:45], v47 offset:0
    v_mfma_f32_32x32x16_bf16 v[144:159], a[208:211], v[132:135], v[144:159]
    ds_read_b128 a[8:11], v18 offset:57344
    ds_read_b128 a[12:15], v19 offset:57344
    v_exp_f32 v98, v98
    ds_read_b64_tr_b16 a[46:47], v47 offset:2048
    ds_read_b64_tr_b16 a[48:49], v44 offset:4096
    ds_read_b64_tr_b16 a[50:51], v44 offset:6144
    v_mfma_f32_32x32x16_bf16 v[160:175], a[212:215], v[132:135], v[160:175]
    ds_read_b128 a[16:19], v20 offset:57344
    ds_read_b128 a[20:23], v21 offset:57344
    v_exp_f32 v99, v99
    ds_read_b64_tr_b16 a[52:53], v45 offset:4096
    v_cvt_pk_bf16_f32 v136, v96, v97
    v_mfma_f32_32x32x16_bf16 v[176:191], a[216:219], v[132:135], v[176:191]
    ds_read_b128 a[24:27], v22 offset:57344
    ds_read_b128 a[28:31], v23 offset:57344
    ds_read_b64_tr_b16 a[54:55], v45 offset:6144
    v_exp_f32 v100, v100
    ds_read_b64_tr_b16 a[56:57], v46 offset:4096
    ds_read_b64_tr_b16 a[58:59], v46 offset:6144
    v_mfma_f32_32x32x16_bf16 v[192:207], a[220:223], v[132:135], v[192:207]
    v_exp_f32 v101, v101
    ds_read_b64_tr_b16 a[60:61], v47 offset:4096
    v_cvt_pk_bf16_f32 v137, v98, v99
    ds_read_b64_tr_b16 a[62:63], v47 offset:6144
    v_exp_f32 v102, v102
    v_mfma_f32_16x16x32_bf16 v[208:211], a[240:243], v[132:135], v[208:211]
    s_waitcnt lgkmcnt(5)
    ds_read_b64_tr_b16 a[64:65], v57 offset:32768
    v_mfma_f32_32x32x16_bf16 v[80:95], a[0:3], v[224:227], v[112:127]
    buffer_load_dwordx4 v54, s[28:31], s74 offen nt lds
    ds_read_b64_tr_b16 a[66:67], v57 offset:33792
    v_exp_f32 v103, v103
    buffer_load_dwordx4 v54, s[28:31], s74 offen offset:1024 nt lds
    v_mfma_f32_32x32x16_bf16 v[80:95], a[4:7], v[228:231], v[80:95]
    ds_read_b64_tr_b16 a[68:69], v57 offset:34816
    ds_read_b64_tr_b16 a[70:71], v57 offset:35840
    v_cvt_pk_bf16_f32 v138, v100, v101
    ds_read_b64_tr_b16 a[72:73], v57 offset:36864
    s_add_u32 m0, s57, 135168
    v_exp_f32 v104, v104
    v_mfma_f32_32x32x16_bf16 v[80:95], a[8:11], v[232:235], v[80:95]
    ds_read_b64_tr_b16 a[74:75], v57 offset:37888
    s_add_u32 s48, s54, 36864
    buffer_load_dwordx4 v63, s[36:39], s48 offen lds
    ds_read_b64_tr_b16 a[76:77], v57 offset:38912
    v_exp_f32 v105, v105
    v_mfma_f32_32x32x16_bf16 v[80:95], a[12:15], v[236:239], v[80:95]
    ds_read_b64_tr_b16 a[78:79], v57 offset:39936
    ds_read_b64_tr_b16 a[80:81], v57 offset:40960
    buffer_load_dwordx4 v64, s[36:39], s48 offen offset:1024 lds
    v_cvt_pk_bf16_f32 v139, v102, v103
    ds_read_b64_tr_b16 a[82:83], v57 offset:41984
    ds_read_b64_tr_b16 a[84:85], v57 offset:43008
    v_mfma_f32_32x32x16_bf16 v[80:95], a[16:19], v[240:243], v[80:95]
    ds_read_b64_tr_b16 a[86:87], v57 offset:44032
    buffer_load_dwordx4 v65, s[36:39], s48 offen offset:2048 lds
    v_exp_f32 v106, v106
    ds_read_b64_tr_b16 a[88:89], v57 offset:45056
    ds_read_b64_tr_b16 a[90:91], v57 offset:46080
    v_mfma_f32_32x32x16_bf16 v[80:95], a[20:23], v[244:247], v[80:95]
    ds_read_b64_tr_b16 a[92:93], v57 offset:47104
    ds_read_b64_tr_b16 a[94:95], v57 offset:48128
    buffer_load_dwordx4 v66, s[36:39], s48 offen offset:3072 lds
    v_exp_f32 v107, v107
    s_add_u32 s54, s54, 128
    v_mfma_f32_32x32x16_bf16 v[80:95], a[24:27], v[248:251], v[80:95]
    s_sub_u32 s49, s54, 1152
    s_cselect_b32 s54, s54, s49
    v_mov_b32 v1, 0
    buffer_load_dwordx2 v[74:75], v1, s[92:95], 0 offen sc1
    v_cvt_pk_bf16_f32 v140, v104, v105
    v_mfma_f32_32x32x16_bf16 v[80:95], a[28:31], v[252:255], v[80:95]
    v_exp_f32 v108, v108
    v_exp_f32 v109, v109
    v_cvt_pk_bf16_f32 v141, v106, v107
    v_exp_f32 v110, v110
    v_exp_f32 v111, v111
    v_cvt_pk_bf16_f32 v142, v108, v109
    v_cvt_pk_bf16_f32 v143, v110, v111
    s_waitcnt vmcnt(17) lgkmcnt(0)
    s_barrier
    v_mfma_f32_32x32x16_bf16 v[144:159], a[32:35], v[136:139], v[144:159]
    ds_read_b128 a[0:3], v24 offset:8192
    ds_read_b128 a[4:7], v25 offset:8192
    ds_read_b128 a[8:11], v26 offset:8192
    ds_read_b128 a[12:15], v27 offset:8192
    ds_read_b128 a[16:19], v28 offset:8192
    v_mfma_f32_32x32x16_bf16 v[160:175], a[36:39], v[136:139], v[160:175]
    v_max3_f32 v68, v80, v81, v82
    v_max3_f32 v69, v83, v84, v85
    v_max3_f32 v68, v68, v86, v87
    v_max3_f32 v69, v69, v88, v89
    v_max3_f32 v68, v68, v90, v91
    s_add_u32 m0, s56, 24576
    v_mfma_f32_32x32x16_bf16 v[176:191], a[40:43], v[136:139], v[176:191]
    v_max3_f32 v69, v69, v92, v93
    ds_read_b64_tr_b16 a[192:193], v44 offset:16384
    v_max3_f32 v68, v68, v94, v95
    ds_read_b64_tr_b16 a[194:195], v44 offset:18432
    v_max_f32 v68, v68, v69
    v_mfma_f32_32x32x16_bf16 v[192:207], a[44:47], v[136:139], v[192:207]
    ds_read_b64_tr_b16 a[196:197], v45 offset:16384
    v_cmp_lt_f32 vcc, 0x41000000, v68
    s_cbranch_vccnz L_stubB8
L_backB8:
    ds_read_b64_tr_b16 a[198:199], v45 offset:18432
    v_exp_f32 v80, v80
    v_mfma_f32_16x16x32_bf16 v[208:211], a[240:243], v[136:139], v[208:211]
    ds_read_b64_tr_b16 a[200:201], v46 offset:16384
    ds_read_b64_tr_b16 a[202:203], v46 offset:18432
    v_mfma_f32_32x32x16_bf16 v[144:159], a[48:51], v[140:143], v[144:159]
    v_exp_f32 v81, v81
    ds_read_b64_tr_b16 a[204:205], v47 offset:16384
    v_exp_f32 v82, v82
    ds_read_b64_tr_b16 a[206:207], v47 offset:18432
    v_mfma_f32_32x32x16_bf16 v[160:175], a[52:55], v[140:143], v[160:175]
    ds_read_b128 a[20:23], v29 offset:8192
    ds_read_b64_tr_b16 a[208:209], v44 offset:20480
    v_exp_f32 v83, v83
    ds_read_b64_tr_b16 a[210:211], v44 offset:22528
    ds_read_b64_tr_b16 a[212:213], v45 offset:20480
    v_mfma_f32_32x32x16_bf16 v[176:191], a[56:59], v[140:143], v[176:191]
    ds_read_b128 a[24:27], v30 offset:8192
    ds_read_b128 a[28:31], v31 offset:8192
    v_cvt_pk_bf16_f32 v128, v80, v81
    ds_read_b64_tr_b16 a[214:215], v45 offset:22528
    v_exp_f32 v84, v84
    v_mfma_f32_32x32x16_bf16 v[192:207], a[60:63], v[140:143], v[192:207]
    ds_read_b64_tr_b16 a[216:217], v46 offset:20480
    ds_read_b64_tr_b16 a[218:219], v46 offset:22528
    v_exp_f32 v85, v85
    ds_read_b64_tr_b16 a[220:221], v47 offset:20480
    v_cvt_pk_bf16_f32 v129, v82, v83
    v_mfma_f32_16x16x32_bf16 v[208:211], a[240:243], v[140:143], v[208:211]
    s_waitcnt lgkmcnt(4)
    ds_read_b64_tr_b16 a[222:223], v47 offset:22528
    v_mfma_f32_32x32x16_bf16 v[96:111], a[0:3], v[224:227], v[112:127]
    ds_read_b64_tr_b16 a[96:97], v58 offset:32768
    v_exp_f32 v86, v86
    ds_read_b64_tr_b16 a[98:99], v58 offset:33792
    v_exp_f32 v87, v87
    v_mfma_f32_32x32x16_bf16 v[96:111], a[4:7], v[228:231], v[96:111]
    ds_read_b64_tr_b16 a[100:101], v58 offset:34816
    ds_read_b64_tr_b16 a[102:103], v58 offset:35840
    v_cvt_pk_bf16_f32 v130, v84, v85
    ds_read_b64_tr_b16 a[104:105], v58 offset:36864
    v_exp_f32 v88, v88
    v_mfma_f32_32x32x16_bf16 v[96:111], a[8:11], v[232:235], v[96:111]
    ds_read_b64_tr_b16 a[106:107], v58 offset:37888
    ds_read_b64_tr_b16 a[108:109], v58 offset:38912
    v_exp_f32 v89, v89
    ds_read_b64_tr_b16 a[110:111], v58 offset:39936
    v_cvt_pk_bf16_f32 v131, v86, v87
    v_mfma_f32_32x32x16_bf16 v[96:111], a[12:15], v[236:239], v[96:111]
    ds_read_b64_tr_b16 a[112:113], v58 offset:40960
    ds_read_b64_tr_b16 a[114:115], v58 offset:41984
    v_exp_f32 v90, v90
    ds_read_b64_tr_b16 a[116:117], v58 offset:43008
    ds_read_b64_tr_b16 a[118:119], v58 offset:44032
    v_mfma_f32_32x32x16_bf16 v[96:111], a[16:19], v[240:243], v[96:111]
    buffer_load_dwordx4 v52, s[24:27], s76 offen nt lds
    ds_read_b64_tr_b16 a[120:121], v58 offset:45056
    v_exp_f32 v91, v91
    v_cvt_pk_bf16_f32 v132, v88, v89
    v_mfma_f32_32x32x16_bf16 v[96:111], a[20:23], v[244:247], v[96:111]
    ds_read_b64_tr_b16 a[122:123], v58 offset:46080
    ds_read_b64_tr_b16 a[124:125], v58 offset:47104
    ds_read_b64_tr_b16 a[126:127], v58 offset:48128
    buffer_load_dwordx4 v53, s[24:27], s76 offen offset:1024 nt lds
    s_add_u32 m0, s56, 32768
    v_mfma_f32_32x32x16_bf16 v[96:111], a[24:27], v[248:251], v[96:111]
    buffer_load_dwordx4 v54, s[28:31], s75 offen nt lds
    buffer_load_dwordx4 v54, s[28:31], s75 offen offset:1024 nt lds
    v_exp_f32 v92, v92
    v_mfma_f32_32x32x16_bf16 v[96:111], a[28:31], v[252:255], v[96:111]
    v_exp_f32 v93, v93
    v_cvt_pk_bf16_f32 v133, v90, v91
    v_exp_f32 v94, v94
    v_exp_f32 v95, v95
    v_cvt_pk_bf16_f32 v134, v92, v93
    v_cvt_pk_bf16_f32 v135, v94, v95
    s_waitcnt vmcnt(13) lgkmcnt(0)
    s_barrier
    v_mfma_f32_32x32x16_bf16 v[144:159], a[192:195], v[128:131], v[144:159]
    ds_read_b128 a[0:3], v24 offset:24576
    ds_read_b128 a[4:7], v25 offset:24576
    ds_read_b128 a[8:11], v26 offset:24576
    ds_read_b128 a[12:15], v27 offset:24576
    v_mfma_f32_32x32x16_bf16 v[160:175], a[196:199], v[128:131], v[160:175]
    v_max3_f32 v68, v96, v97, v98
    v_max3_f32 v69, v99, v100, v101
    v_max3_f32 v68, v68, v102, v103
    v_max3_f32 v69, v69, v104, v105
    v_max3_f32 v68, v68, v106, v107
    v_mfma_f32_32x32x16_bf16 v[176:191], a[200:203], v[128:131], v[176:191]
    v_max3_f32 v69, v69, v108, v109
    v_max3_f32 v68, v68, v110, v111
    v_max_f32 v68, v68, v69
    v_cmp_lt_f32 vcc, 0x41000000, v68
    s_cbranch_vccnz L_stubB9
L_backB9:
    v_mfma_f32_32x32x16_bf16 v[192:207], a[204:207], v[128:131], v[192:207]
    v_exp_f32 v96, v96
    v_exp_f32 v97, v97
    v_exp_f32 v98, v98
    v_mfma_f32_16x16x32_bf16 v[208:211], a[240:243], v[128:131], v[208:211]
    v_exp_f32 v99, v99
    v_mfma_f32_32x32x16_bf16 v[144:159], a[208:211], v[132:135], v[144:159]
    ds_read_b128 a[16:19], v28 offset:24576
    v_cvt_pk_bf16_f32 v136, v96, v97
    v_exp_f32 v100, v100
    ds_read_b128 a[20:23], v29 offset:24576
    v_mfma_f32_32x32x16_bf16 v[160:175], a[212:215], v[132:135], v[160:175]
    ds_read_b128 a[24:27], v30 offset:24576
    v_exp_f32 v101, v101
    v_cvt_pk_bf16_f32 v137, v98, v99
    ds_read_b64_tr_b16 a[32:33], v40 offset:0
    v_mfma_f32_32x32x16_bf16 v[176:191], a[216:219], v[132:135], v[176:191]
    ds_read_b128 a[28:31], v31 offset:24576
    v_exp_f32 v102, v102
    v_exp_f32 v103, v103
    v_mfma_f32_32x32x16_bf16 v[192:207], a[220:223], v[132:135], v[192:207]
    ds_read_b64_tr_b16 a[34:35], v40 offset:2048
    v_cvt_pk_bf16_f32 v138, v100, v101
    ds_read_b64_tr_b16 a[36:37], v41 offset:0
    v_exp_f32 v104, v104
    v_mfma_f32_16x16x32_bf16 v[208:211], a[240:243], v[132:135], v[208:211]
    s_waitcnt lgkmcnt(2)
    ds_read_b64_tr_b16 a[38:39], v41 offset:2048
    v_mfma_f32_32x32x16_bf16 v[80:95], a[0:3], v[224:227], v[112:127]
    ds_read_b64_tr_b16 a[40:41], v42 offset:0
    v_exp_f32 v105, v105
    ds_read_b64_tr_b16 a[42:43], v42 offset:2048
    v_cvt_pk_bf16_f32 v139, v102, v103
    v_mfma_f32_32x32x16_bf16 v[80:95], a[4:7], v[228:231], v[80:95]
    ds_read_b64_tr_b16 a[44:45], v43 offset:0
    v_exp_f32 v106, v106
    ds_read_b64_tr_b16 a[46:47], v43 offset:2048
    ds_read_b64_tr_b16 a[48:49], v40 offset:4096
    v_mfma_f32_32x32x16_bf16 v[80:95], a[8:11], v[232:235], v[80:95]
    v_exp_f32 v107, v107
    s_add_u32 m0, s56, 40960
    ds_read_b64_tr_b16 a[50:51], v40 offset:6144
    v_cvt_pk_bf16_f32 v140, v104, v105
    v_mfma_f32_32x32x16_bf16 v[80:95], a[12:15], v[236:239], v[80:95]
    ds_read_b64_tr_b16 a[52:53], v41 offset:4096
    buffer_load_dwordx4 v52, s[24:27], s77 offen nt lds
    ds_read_b64_tr_b16 a[54:55], v41 offset:6144
    ds_read_b64_tr_b16 a[56:57], v42 offset:4096
    v_mfma_f32_32x32x16_bf16 v[80:95], a[16:19], v[240:243], v[80:95]
    buffer_load_dwordx4 v53, s[24:27], s77 offen offset:1024 nt lds
    v_exp_f32 v108, v108
    ds_read_b64_tr_b16 a[58:59], v42 offset:6144
    v_mfma_f32_32x32x16_bf16 v[80:95], a[20:23], v[244:247], v[80:95]
    ds_read_b64_tr_b16 a[60:61], v43 offset:4096
    ds_read_b64_tr_b16 a[62:63], v43 offset:6144
    s_add_u32 m0, s56, 49152
    s_nop 0
    buffer_load_dwordx4 v54, s[28:31], s76 offen nt lds
    v_mfma_f32_32x32x16_bf16 v[80:95], a[24:27], v[248:251], v[80:95]
    buffer_load_dwordx4 v54, s[28:31], s76 offen offset:1024 nt lds
    v_exp_f32 v109, v109
    v_cvt_pk_bf16_f32 v141, v106, v107
    v_mfma_f32_32x32x16_bf16 v[80:95], a[28:31], v[252:255], v[80:95]
    v_exp_f32 v110, v110
    v_exp_f32 v111, v111
    v_cvt_pk_bf16_f32 v142, v108, v109
    v_cvt_pk_bf16_f32 v143, v110, v111
    s_waitcnt vmcnt(9) lgkmcnt(0)
    s_barrier
    v_mfma_f32_32x32x16_bf16 v[144:159], a[32:35], v[136:139], v[144:159]
    ds_read_b128 a[0:3], v16 offset:8192
    ds_read_b128 a[4:7], v17 offset:8192
    ds_read_b128 a[8:11], v18 offset:8192
    ds_read_b128 a[12:15], v19 offset:8192
    ds_read_b128 a[16:19], v20 offset:8192
    v_mfma_f32_32x32x16_bf16 v[160:175], a[36:39], v[136:139], v[160:175]
    v_max3_f32 v68, v80, v81, v82
    v_max3_f32 v69, v83, v84, v85
    v_max3_f32 v68, v68, v86, v87
    v_max3_f32 v69, v69, v88, v89
    v_max3_f32 v68, v68, v90, v91
    s_add_u32 m0, s56, 57344
    v_mfma_f32_32x32x16_bf16 v[176:191], a[40:43], v[136:139], v[176:191]
    v_max3_f32 v69, v69, v92, v93
    ds_read_b64_tr_b16 a[192:193], v40 offset:16384
    v_max3_f32 v68, v68, v94, v95
    ds_read_b64_tr_b16 a[194:195], v40 offset:18432
    v_max_f32 v68, v68, v69
    v_mfma_f32_32x32x16_bf16 v[192:207], a[44:47], v[136:139], v[192:207]
    ds_read_b64_tr_b16 a[196:197], v41 offset:16384
    v_cmp_lt_f32 vcc, 0x41000000, v68
    s_cbranch_vccnz L_stubB10
L_backB10:
    ds_read_b64_tr_b16 a[198:199], v41 offset:18432
    v_exp_f32 v80, v80
    v_mfma_f32_16x16x32_bf16 v[208:211], a[240:243], v[136:139], v[208:211]
    ds_read_b64_tr_b16 a[200:201], v42 offset:16384
    ds_read_b64_tr_b16 a[202:203], v42 offset:18432
    v_mfma_f32_32x32x16_bf16 v[144:159], a[48:51], v[140:143], v[144:159]
    v_exp_f32 v81, v81
    ds_read_b64_tr_b16 a[204:205], v43 offset:16384
    v_exp_f32 v82, v82
    ds_read_b64_tr_b16 a[206:207], v43 offset:18432
    v_mfma_f32_32x32x16_bf16 v[160:175], a[52:55], v[140:143], v[160:175]
    ds_read_b128 a[20:23], v21 offset:8192
    ds_read_b64_tr_b16 a[208:209], v40 offset:20480
    v_exp_f32 v83, v83
    ds_read_b64_tr_b16 a[210:211], v40 offset:22528
    ds_read_b64_tr_b16 a[212:213], v41 offset:20480
    v_mfma_f32_32x32x16_bf16 v[176:191], a[56:59], v[140:143], v[176:191]
    ds_read_b128 a[24:27], v22 offset:8192
    ds_read_b128 a[28:31], v23 offset:8192
    v_cvt_pk_bf16_f32 v128, v80, v81
    ds_read_b64_tr_b16 a[214:215], v41 offset:22528
    v_exp_f32 v84, v84
    v_mfma_f32_32x32x16_bf16 v[192:207], a[60:63], v[140:143], v[192:207]
    ds_read_b64_tr_b16 a[216:217], v42 offset:20480
    ds_read_b64_tr_b16 a[218:219], v42 offset:22528
    v_exp_f32 v85, v85
    ds_read_b64_tr_b16 a[220:221], v43 offset:20480
    v_cvt_pk_bf16_f32 v129, v82, v83
    v_mfma_f32_16x16x32_bf16 v[208:211], a[240:243], v[140:143], v[208:211]
    s_waitcnt lgkmcnt(4)
    ds_read_b64_tr_b16 a[222:223], v43 offset:22528
    v_mfma_f32_32x32x16_bf16 v[96:111], a[0:3], v[224:227], v[112:127]
    ds_read_b64_tr_b16 a[128:129], v59 offset:0
    v_exp_f32 v86, v86
    ds_read_b64_tr_b16 a[130:131], v59 offset:1024
    v_exp_f32 v87, v87
    v_mfma_f32_32x32x16_bf16 v[96:111], a[4:7], v[228:231], v[96:111]
    ds_read_b64_tr_b16 a[132:133], v59 offset:2048
    ds_read_b64_tr_b16 a[134:135], v59 offset:3072
    v_cvt_pk_bf16_f32 v130, v84, v85
    ds_read_b64_tr_b16 a[136:137], v59 offset:4096
    v_exp_f32 v88, v88
    v_mfma_f32_32x32x16_bf16 v[96:111], a[8:11], v[232:235], v[96:111]
    ds_read_b64_tr_b16 a[138:139], v59 offset:5120
    ds_read_b64_tr_b16 a[140:141], v59 offset:6144
    v_exp_f32 v89, v89
    ds_read_b64_tr_b16 a[142:143], v59 offset:7168
    v_cvt_pk_bf16_f32 v131, v86, v87
    v_mfma_f32_32x32x16_bf16 v[96:111], a[12:15], v[236:239], v[96:111]
    ds_read_b64_tr_b16 a[144:145], v59 offset:8192
    ds_read_b64_tr_b16 a[146:147], v59 offset:9216
    v_exp_f32 v90, v90
    ds_read_b64_tr_b16 a[148:149], v59 offset:10240
    ds_read_b64_tr_b16 a[150:151], v59 offset:11264
    v_mfma_f32_32x32x16_bf16 v[96:111], a[16:19], v[240:243], v[96:111]
    buffer_load_dwordx4 v52, s[24:27], s78 offen nt lds
    ds_read_b64_tr_b16 a[152:153], v59 offset:12288
    v_exp_f32 v91, v91
    v_cvt_pk_bf16_f32 v132, v88, v89
    v_mfma_f32_32x32x16_bf16 v[96:111], a[20:23], v[244:247], v[96:111]
    ds_read_b64_tr_b16 a[154:155], v59 offset:13312
    ds_read_b64_tr_b16 a[156:157], v59 offset:14336
    ds_read_b64_tr_b16 a[158:159], v59 offset:15360
    buffer_load_dwordx4 v53, s[24:27], s78 offen offset:1024 nt lds
    s_add_u32 m0, s56, 65536
    v_mfma_f32_32x32x16_bf16 v[96:111], a[24:27], v[248:251], v[96:111]
    buffer_load_dwordx4 v54, s[28:31], s77 offen nt lds
    buffer_load_dwordx4 v54, s[28:31], s77 offen offset:1024 nt lds
    v_exp_f32 v92, v92
    v_mfma_f32_32x32x16_bf16 v[96:111], a[28:31], v[252:255], v[96:111]
    v_exp_f32 v93, v93
    v_cvt_pk_bf16_f32 v133, v90, v91
    v_exp_f32 v94, v94
    v_exp_f32 v95, v95
    v_cvt_pk_bf16_f32 v134, v92, v93
    v_cvt_pk_bf16_f32 v135, v94, v95
    s_waitcnt vmcnt(8) lgkmcnt(0)
    s_barrier
    v_mfma_f32_32x32x16_bf16 v[144:159], a[192:195], v[128:131], v[144:159]
    ds_read_b128 a[0:3], v16 offset:24576
    ds_read_b128 a[4:7], v17 offset:24576
    ds_read_b128 a[8:11], v18 offset:24576
    ds_read_b128 a[12:15], v19 offset:24576
    ds_read_b128 a[16:19], v20 offset:24576
    v_mfma_f32_32x32x16_bf16 v[160:175], a[196:199], v[128:131], v[160:175]
    v_max3_f32 v68, v96, v97, v98
    v_max3_f32 v69, v99, v100, v101
    v_max3_f32 v68, v68, v102, v103
    v_max3_f32 v69, v69, v104, v105
    v_max3_f32 v68, v68, v106, v107
    s_add_u32 m0, s56, 73728
    v_mfma_f32_32x32x16_bf16 v[176:191], a[200:203], v[128:131], v[176:191]
    v_max3_f32 v69, v69, v108, v109
    ds_read_b64_tr_b16 a[32:33], v40 offset:32768
    v_max3_f32 v68, v68, v110, v111
    ds_read_b64_tr_b16 a[34:35], v40 offset:34816
    v_max_f32 v68, v68, v69
    v_mfma_f32_32x32x16_bf16 v[192:207], a[204:207], v[128:131], v[192:207]
    ds_read_b64_tr_b16 a[36:37], v41 offset:32768
    v_cmp_lt_f32 vcc, 0x41000000, v68
    s_cbranch_vccnz L_stubB11
L_backB11:
    ds_read_b64_tr_b16 a[38:39], v41 offset:34816
    v_exp_f32 v96, v96
    v_mfma_f32_16x16x32_bf16 v[208:211], a[240:243], v[128:131], v[208:211]
    ds_read_b64_tr_b16 a[40:41], v42 offset:32768
    ds_read_b64_tr_b16 a[42:43], v42 offset:34816
    v_mfma_f32_32x32x16_bf16 v[144:159], a[208:211], v[132:135], v[144:159]
    v_exp_f32 v97, v97
    ds_read_b64_tr_b16 a[44:45], v43 offset:32768
    v_exp_f32 v98, v98
    ds_read_b64_tr_b16 a[46:47], v43 offset:34816
    v_mfma_f32_32x32x16_bf16 v[160:175], a[212:215], v[132:135], v[160:175]
    ds_read_b128 a[20:23], v21 offset:24576
    ds_read_b64_tr_b16 a[48:49], v40 offset:36864
    v_exp_f32 v99, v99
    ds_read_b64_tr_b16 a[50:51], v40 offset:38912
    ds_read_b64_tr_b16 a[52:53], v41 offset:36864
    v_mfma_f32_32x32x16_bf16 v[176:191], a[216:219], v[132:135], v[176:191]
    ds_read_b128 a[24:27], v22 offset:24576
    ds_read_b128 a[28:31], v23 offset:24576
    v_cvt_pk_bf16_f32 v136, v96, v97
    ds_read_b64_tr_b16 a[54:55], v41 offset:38912
    v_exp_f32 v100, v100
    v_mfma_f32_32x32x16_bf16 v[192:207], a[220:223], v[132:135], v[192:207]
    ds_read_b64_tr_b16 a[56:57], v42 offset:36864
    ds_read_b64_tr_b16 a[58:59], v42 offset:38912
    v_exp_f32 v101, v101
    ds_read_b64_tr_b16 a[60:61], v43 offset:36864
    v_cvt_pk_bf16_f32 v137, v98, v99
    v_mfma_f32_16x16x32_bf16 v[208:211], a[240:243], v[132:135], v[208:211]
    s_waitcnt lgkmcnt(4)
    ds_read_b64_tr_b16 a[62:63], v43 offset:38912
    v_mfma_f32_32x32x16_bf16 v[80:95], a[0:3], v[224:227], v[112:127]
    ds_read_b64_tr_b16 a[160:161], v60 offset:0
    v_exp_f32 v102, v102
    ds_read_b64_tr_b16 a[162:163], v60 offset:1024
    v_exp_f32 v103, v103
    v_mfma_f32_32x32x16_bf16 v[80:95], a[4:7], v[228:231], v[80:95]
    ds_read_b64_tr_b16 a[164:165], v60 offset:2048
    ds_read_b64_tr_b16 a[166:167], v60 offset:3072
    v_cvt_pk_bf16_f32 v138, v100, v101
    ds_read_b64_tr_b16 a[168:169], v60 offset:4096
    v_exp_f32 v104, v104
    v_mfma_f32_32x32x16_bf16 v[80:95], a[8:11], v[232:235], v[80:95]
    ds_read_b64_tr_b16 a[170:171], v60 offset:5120
    ds_read_b64_tr_b16 a[172:173], v60 offset:6144
    v_exp_f32 v105, v105
    ds_read_b64_tr_b16 a[174:175], v60 offset:7168
    v_cvt_pk_bf16_f32 v139, v102, v103
    v_mfma_f32_32x32x16_bf16 v[80:95], a[12:15], v[236:239], v[80:95]
    ds_read_b64_tr_b16 a[176:177], v60 offset:8192
    ds_read_b64_tr_b16 a[178:179], v60 offset:9216
    v_exp_f32 v106, v106
    ds_read_b64_tr_b16 a[180:181], v60 offset:10240
    ds_read_b64_tr_b16 a[182:183], v60 offset:11264
    v_mfma_f32_32x32x16_bf16 v[80:95], a[16:19], v[240:243], v[80:95]
    buffer_load_dwordx4 v52, s[24:27], s79 offen nt lds
    ds_read_b64_tr_b16 a[184:185], v60 offset:12288
    v_exp_f32 v107, v107
    v_cvt_pk_bf16_f32 v140, v104, v105
    v_mfma_f32_32x32x16_bf16 v[80:95], a[20:23], v[244:247], v[80:95]
    ds_read_b64_tr_b16 a[186:187], v60 offset:13312
    ds_read_b64_tr_b16 a[188:189], v60 offset:14336
    ds_read_b64_tr_b16 a[190:191], v60 offset:15360
    buffer_load_dwordx4 v53, s[24:27], s79 offen offset:1024 nt lds
    s_add_u32 m0, s56, 81920
    v_mfma_f32_32x32x16_bf16 v[80:95], a[24:27], v[248:251], v[80:95]
    buffer_load_dwordx4 v54, s[28:31], s78 offen nt lds
    buffer_load_dwordx4 v54, s[28:31], s78 offen offset:1024 nt lds
    v_exp_f32 v108, v108
    v_mfma_f32_32x32x16_bf16 v[80:95], a[28:31], v[252:255], v[80:95]
    v_exp_f32 v109, v109
    v_cvt_pk_bf16_f32 v141, v106, v107
    v_exp_f32 v110, v110
    v_exp_f32 v111, v111
    v_cvt_pk_bf16_f32 v142, v108, v109
    v_cvt_pk_bf16_f32 v143, v110, v111
    s_waitcnt vmcnt(8) lgkmcnt(0)
    s_barrier
    v_mfma_f32_32x32x16_bf16 v[144:159], a[32:35], v[136:139], v[144:159]
    s_add_u32 m0, s56, 90112
    s_nop 0
    buffer_load_dwordx4 v54, s[28:31], s79 offen nt lds
    buffer_load_dwordx4 v54, s[28:31], s79 offen offset:1024 nt lds
    ds_read_b128 a[0:3], v16 offset:40960
    v_mfma_f32_32x32x16_bf16 v[160:175], a[36:39], v[136:139], v[160:175]
    v_max3_f32 v68, v80, v81, v82
    v_max3_f32 v69, v83, v84, v85
    v_max3_f32 v68, v68, v86, v87
    v_max3_f32 v69, v69, v88, v89
    v_max3_f32 v68, v68, v90, v91
    s_add_u32 m0, s57, 98304
    v_mfma_f32_32x32x16_bf16 v[176:191], a[40:43], v[136:139], v[176:191]
    v_max3_f32 v69, v69, v92, v93
    v_max3_f32 v68, v68, v94, v95
    v_max_f32 v68, v68, v69
    v_cmp_lt_f32 vcc, 0x41000000, v68
    s_cbranch_vccnz L_stubB12
L_backB12:
    ds_read_b64_tr_b16 a[192:193], v40 offset:49152
    v_mfma_f32_32x32x16_bf16 v[192:207], a[44:47], v[136:139], v[192:207]
    v_exp_f32 v80, v80
    v_exp_f32 v81, v81
    ds_read_b128 a[4:7], v17 offset:40960
    ds_read_b128 a[8:11], v18 offset:40960
    v_mfma_f32_16x16x32_bf16 v[208:211], a[240:243], v[136:139], v[208:211]
    v_exp_f32 v82, v82
    v_mfma_f32_32x32x16_bf16 v[144:159], a[48:51], v[140:143], v[144:159]
    ds_read_b128 a[12:15], v19 offset:40960
    v_exp_f32 v83, v83
    ds_read_b128 a[16:19], v20 offset:40960
    v_cvt_pk_bf16_f32 v128, v80, v81
    ds_read_b64_tr_b16 a[194:195], v40 offset:51200
    v_mfma_f32_32x32x16_bf16 v[160:175], a[52:55], v[140:143], v[160:175]
    ds_read_b128 a[20:23], v21 offset:40960
    v_exp_f32 v84, v84
    ds_read_b128 a[24:27], v22 offset:40960
    v_exp_f32 v85, v85
    v_mfma_f32_32x32x16_bf16 v[176:191], a[56:59], v[140:143], v[176:191]
    ds_read_b128 a[28:31], v23 offset:40960
    v_cvt_pk_bf16_f32 v129, v82, v83
    buffer_load_dwordx4 v63, s[36:39], s54 offen lds
    v_exp_f32 v86, v86
    v_mfma_f32_32x32x16_bf16 v[192:207], a[60:63], v[140:143], v[192:207]
    buffer_load_dwordx4 v64, s[36:39], s54 offen offset:1024 lds
    v_exp_f32 v87, v87
    v_cvt_pk_bf16_f32 v130, v84, v85
    ds_read_b64_tr_b16 a[196:197], v41 offset:49152
    v_mfma_f32_16x16x32_bf16 v[208:211], a[240:243], v[140:143], v[208:211]
    s_waitcnt lgkmcnt(1)
    ds_read_b64_tr_b16 a[198:199], v41 offset:51200
    v_mfma_f32_32x32x16_bf16 v[96:111], a[0:3], v[224:227], v[112:127]
    buffer_load_dwordx4 v65, s[36:39], s54 offen offset:2048 lds
    v_exp_f32 v88, v88
    ds_read_b64_tr_b16 a[200:201], v42 offset:49152
    ds_read_b64_tr_b16 a[202:203], v42 offset:51200
    v_mfma_f32_32x32x16_bf16 v[96:111], a[4:7], v[228:231], v[96:111]
    buffer_load_dwordx4 v66, s[36:39], s54 offen offset:3072 lds
    v_exp_f32 v89, v89
    ds_read_b64_tr_b16 a[204:205], v43 offset:49152
    s_add_u32 m0, s57, 102400
    v_mfma_f32_32x32x16_bf16 v[96:111], a[8:11], v[232:235], v[96:111]
    ds_read_b64_tr_b16 a[206:207], v43 offset:51200
    v_cvt_pk_bf16_f32 v131, v86, v87
    s_add_u32 s48, s54, 36864
    v_exp_f32 v90, v90
    ds_read_b64_tr_b16 a[208:209], v40 offset:53248
    v_mfma_f32_32x32x16_bf16 v[96:111], a[12:15], v[236:239], v[96:111]
    buffer_load_dwordx4 v63, s[36:39], s48 offen lds
    ds_read_b64_tr_b16 a[210:211], v40 offset:55296
    ds_read_b64_tr_b16 a[212:213], v41 offset:53248
    v_exp_f32 v91, v91
    v_mfma_f32_32x32x16_bf16 v[96:111], a[16:19], v[240:243], v[96:111]
    ds_read_b64_tr_b16 a[214:215], v41 offset:55296
    buffer_load_dwordx4 v64, s[36:39], s48 offen offset:1024 lds
    ds_read_b64_tr_b16 a[216:217], v42 offset:53248
    v_cvt_pk_bf16_f32 v132, v88, v89
    ds_read_b64_tr_b16 a[218:219], v42 offset:55296
    v_mfma_f32_32x32x16_bf16 v[96:111], a[20:23], v[244:247], v[96:111]
    ds_read_b64_tr_b16 a[220:221], v43 offset:53248
    ds_read_b64_tr_b16 a[222:223], v43 offset:55296
    buffer_load_dwordx4 v65, s[36:39], s48 offen offset:2048 lds
    v_exp_f32 v92, v92
    v_mfma_f32_32x32x16_bf16 v[96:111], a[24:27], v[248:251], v[96:111]
    buffer_load_dwordx4 v66, s[36:39], s48 offen offset:3072 lds
    s_add_u32 s54, s54, 128
    s_sub_u32 s49, s54, 1152
    s_cselect_b32 s54, s54, s49
    v_mfma_f32_32x32x16_bf16 v[96:111], a[28:31], v[252:255], v[96:111]
    v_exp_f32 v93, v93
    v_cvt_pk_bf16_f32 v133, v90, v91
    v_exp_f32 v94, v94
    v_exp_f32 v95, v95
    v_cvt_pk_bf16_f32 v134, v92, v93
    v_cvt_pk_bf16_f32 v135, v94, v95
    s_waitcnt vmcnt(14) lgkmcnt(0)
    s_barrier
    v_mfma_f32_32x32x16_bf16 v[144:159], a[192:195], v[128:131], v[144:159]
    ds_read_b128 a[0:3], v16 offset:57344
    s_add_u32 m0, s57, 131072
    s_nop 0
    buffer_load_dwordx4 v63, s[36:39], s54 offen lds
    ds_read_b128 a[4:7], v17 offset:57344
    v_mfma_f32_32x32x16_bf16 v[160:175], a[196:199], v[128:131], v[160:175]
    v_max3_f32 v68, v96, v97, v98
    v_max3_f32 v69, v99, v100, v101
    v_max3_f32 v68, v68, v102, v103
    v_max3_f32 v69, v69, v104, v105
    v_max3_f32 v68, v68, v106, v107
    v_mfma_f32_32x32x16_bf16 v[176:191], a[200:203], v[128:131], v[176:191]
    v_max3_f32 v69, v69, v108, v109
    v_max3_f32 v68, v68, v110, v111
    v_max_f32 v68, v68, v69
    v_cmp_lt_f32 vcc, 0x41000000, v68
    s_cbranch_vccnz L_stubB13
L_backB13:
    ds_read_b128 a[8:11], v18 offset:57344
    v_mfma_f32_32x32x16_bf16 v[192:207], a[204:207], v[128:131], v[192:207]
    v_exp_f32 v96, v96
    v_exp_f32 v97, v97
    v_exp_f32 v98, v98
    v_mfma_f32_16x16x32_bf16 v[208:211], a[240:243], v[128:131], v[208:211]
    v_exp_f32 v99, v99
    v_mfma_f32_32x32x16_bf16 v[144:159], a[208:211], v[132:135], v[144:159]
    ds_read_b128 a[12:15], v19 offset:57344
    ds_read_b128 a[16:19], v20 offset:57344
    v_cvt_pk_bf16_f32 v136, v96, v97
    v_exp_f32 v100, v100
    v_mfma_f32_32x32x16_bf16 v[160:175], a[212:215], v[132:135], v[160:175]
    ds_read_b128 a[20:23], v21 offset:57344
    ds_read_b128 a[24:27], v22 offset:57344
    v_exp_f32 v101, v101
    v_cvt_pk_bf16_f32 v137, v98, v99
    v_mfma_f32_32x32x16_bf16 v[176:191], a[216:219], v[132:135], v[176:191]
    ds_read_b128 a[28:31], v23 offset:57344
    v_exp_f32 v102, v102
    v_exp_f32 v103, v103
    ds_read_b64_tr_b16 a[32:33], v44 offset:0
    v_mfma_f32_32x32x16_bf16 v[192:207], a[220:223], v[132:135], v[192:207]
    buffer_load_dwordx4 v64, s[36:39], s54 offen offset:1024 lds
    ds_read_b64_tr_b16 a[34:35], v44 offset:2048
    v_cvt_pk_bf16_f32 v138, v100, v101
    ds_read_b64_tr_b16 a[36:37], v45 offset:0
    v_mfma_f32_16x16x32_bf16 v[208:211], a[240:243], v[132:135], v[208:211]
    s_waitcnt lgkmcnt(3)
    ds_read_b64_tr_b16 a[38:39], v45 offset:2048
    v_mfma_f32_32x32x16_bf16 v[80:95], a[0:3], v[224:227], v[112:127]
    buffer_load_dwordx4 v65, s[36:39], s54 offen offset:2048 lds
    v_exp_f32 v104, v104
    ds_read_b64_tr_b16 a[40:41], v46 offset:0
    ds_read_b64_tr_b16 a[42:43], v46 offset:2048
    v_mfma_f32_32x32x16_bf16 v[80:95], a[4:7], v[228:231], v[80:95]
    buffer_load_dwordx4 v66, s[36:39], s54 offen offset:3072 lds
    v_exp_f32 v105, v105
    ds_read_b64_tr_b16 a[44:45], v47 offset:0
    s_add_u32 m0, s57, 135168
    v_mfma_f32_32x32x16_bf16 v[80:95], a[8:11], v[232:235], v[80:95]
    ds_read_b64_tr_b16 a[46:47], v47 offset:2048
    v_cvt_pk_bf16_f32 v139, v102, v103
    s_add_u32 s48, s54, 36864
    v_exp_f32 v106, v106
    ds_read_b64_tr_b16 a[48:49], v44 offset:4096
    v_mfma_f32_32x32x16_bf16 v[80:95], a[12:15], v[236:239], v[80:95]
    buffer_load_dwordx4 v63, s[36:39], s48 offen lds
    ds_read_b64_tr_b16 a[50:51], v44 offset:6144
    ds_read_b64_tr_b16 a[52:53], v45 offset:4096
    v_exp_f32 v107, v107
    v_mfma_f32_32x32x16_bf16 v[80:95], a[16:19], v[240:243], v[80:95]
    ds_read_b64_tr_b16 a[54:55], v45 offset:6144
    buffer_load_dwordx4 v64, s[36:39], s48 offen offset:1024 lds
    ds_read_b64_tr_b16 a[56:57], v46 offset:4096
    v_cvt_pk_bf16_f32 v140, v104, v105
    v_mfma_f32_32x32x16_bf16 v[80:95], a[20:23], v[244:247], v[80:95]
    ds_read_b64_tr_b16 a[58:59], v46 offset:6144
    ds_read_b64_tr_b16 a[60:61], v47 offset:4096
    ds_read_b64_tr_b16 a[62:63], v47 offset:6144
    buffer_load_dwordx4 v65, s[36:39], s48 offen offset:2048 lds
    v_mfma_f32_32x32x16_bf16 v[80:95], a[24:27], v[248:251], v[80:95]
    buffer_load_dwordx4 v66, s[36:39], s48 offen offset:3072 lds
    s_add_u32 s54, s54, 128
    s_sub_u32 s49, s54, 1152
    s_cselect_b32 s54, s54, s49
    v_mfma_f32_32x32x16_bf16 v[80:95], a[28:31], v[252:255], v[80:95]
    v_exp_f32 v108, v108
    v_exp_f32 v109, v109
    v_cvt_pk_bf16_f32 v141, v106, v107
    v_exp_f32 v110, v110
    v_exp_f32 v111, v111
    v_cvt_pk_bf16_f32 v142, v108, v109
    v_cvt_pk_bf16_f32 v143, v110, v111
    s_waitcnt vmcnt(16) lgkmcnt(0)
    s_barrier
    v_mfma_f32_32x32x16_bf16 v[144:159], a[32:35], v[136:139], v[144:159]
    ds_read_b128 a[0:3], v24 offset:8192
    ds_read_b128 a[4:7], v25 offset:8192
    ds_read_b128 a[8:11], v26 offset:8192
    ds_read_b128 a[12:15], v27 offset:8192
    v_mfma_f32_32x32x16_bf16 v[160:175], a[36:39], v[136:139], v[160:175]
    v_max3_f32 v68, v80, v81, v82
    v_max3_f32 v69, v83, v84, v85
    v_max3_f32 v68, v68, v86, v87
    v_max3_f32 v69, v69, v88, v89
    v_max3_f32 v68, v68, v90, v91
    v_mfma_f32_32x32x16_bf16 v[176:191], a[40:43], v[136:139], v[176:191]
    v_max3_f32 v69, v69, v92, v93
    v_max3_f32 v68, v68, v94, v95
    v_max_f32 v68, v68, v69
    v_cmp_lt_f32 vcc, 0x41000000, v68
    s_cbranch_vccnz L_stubB14
L_backB14:
    v_mfma_f32_32x32x16_bf16 v[192:207], a[44:47], v[136:139], v[192:207]
    v_exp_f32 v80, v80
    v_exp_f32 v81, v81
    v_exp_f32 v82, v82
    v_mfma_f32_16x16x32_bf16 v[208:211], a[240:243], v[136:139], v[208:211]
    v_exp_f32 v83, v83
    v_mfma_f32_32x32x16_bf16 v[144:159], a[48:51], v[140:143], v[144:159]
    ds_read_b128 a[16:19], v28 offset:8192
    v_cvt_pk_bf16_f32 v128, v80, v81
    v_exp_f32 v84, v84
    v_exp_f32 v85, v85
    v_mfma_f32_32x32x16_bf16 v[160:175], a[52:55], v[140:143], v[160:175]
    ds_read_b128 a[20:23], v29 offset:8192
    ds_read_b128 a[24:27], v30 offset:8192
    v_cvt_pk_bf16_f32 v129, v82, v83
    v_exp_f32 v86, v86
    v_mfma_f32_32x32x16_bf16 v[176:191], a[56:59], v[140:143], v[176:191]
    ds_read_b128 a[28:31], v31 offset:8192
    v_exp_f32 v87, v87
    ds_read_b64_tr_b16 a[192:193], v44 offset:16384
    ds_read_b64_tr_b16 a[194:195], v44 offset:18432
    v_mfma_f32_32x32x16_bf16 v[192:207], a[60:63], v[140:143], v[192:207]
    v_cvt_pk_bf16_f32 v130, v84, v85
    ds_read_b64_tr_b16 a[196:197], v45 offset:16384
    v_exp_f32 v88, v88
    ds_read_b64_tr_b16 a[198:199], v45 offset:18432
    v_mfma_f32_16x16x32_bf16 v[208:211], a[240:243], v[140:143], v[208:211]
    s_waitcnt lgkmcnt(4)
    ds_read_b64_tr_b16 a[200:201], v46 offset:16384
    v_mfma_f32_32x32x16_bf16 v[96:111], a[0:3], v[224:227], v[112:127]
    ds_read_b64_tr_b16 a[32:33], v44 offset:24576
    ds_read_b64_tr_b16 a[34:35], v44 offset:26624
    ds_read_b64_tr_b16 a[36:37], v45 offset:24576
    v_exp_f32 v89, v89
    v_mfma_f32_32x32x16_bf16 v[96:111], a[4:7], v[228:231], v[96:111]
    ds_read_b64_tr_b16 a[202:203], v46 offset:18432
    ds_read_b64_tr_b16 a[38:39], v45 offset:26624
    ds_read_b64_tr_b16 a[204:205], v47 offset:16384
    v_cvt_pk_bf16_f32 v131, v86, v87
    ds_read_b64_tr_b16 a[40:41], v46 offset:24576
    v_mfma_f32_32x32x16_bf16 v[96:111], a[8:11], v[232:235], v[96:111]
    ds_read_b64_tr_b16 a[206:207], v47 offset:18432
    ds_read_b64_tr_b16 a[42:43], v46 offset:26624
    v_exp_f32 v90, v90
    ds_read_b64_tr_b16 a[208:209], v44 offset:20480
    v_mfma_f32_32x32x16_bf16 v[96:111], a[12:15], v[236:239], v[96:111]
    ds_read_b64_tr_b16 a[210:211], v44 offset:22528
    ds_read_b64_tr_b16 a[44:45], v47 offset:24576
    ds_read_b64_tr_b16 a[212:213], v45 offset:20480
    v_exp_f32 v91, v91
    v_mfma_f32_32x32x16_bf16 v[96:111], a[16:19], v[240:243], v[96:111]
    ds_read_b64_tr_b16 a[214:215], v45 offset:22528
    ds_read_b64_tr_b16 a[46:47], v47 offset:26624
    ds_read_b64_tr_b16 a[216:217], v46 offset:20480
    ds_read_b64_tr_b16 a[48:49], v44 offset:28672
    ds_read_b64_tr_b16 a[50:51], v44 offset:30720
    v_mfma_f32_32x32x16_bf16 v[96:111], a[20:23], v[244:247], v[96:111]
    ds_read_b64_tr_b16 a[218:219], v46 offset:22528
    ds_read_b64_tr_b16 a[220:221], v47 offset:20480
    ds_read_b64_tr_b16 a[222:223], v47 offset:22528
    ds_read_b64_tr_b16 a[52:53], v45 offset:28672
    v_cvt_pk_bf16_f32 v132, v88, v89
    v_mfma_f32_32x32x16_bf16 v[96:111], a[24:27], v[248:251], v[96:111]
    ds_read_b64_tr_b16 a[54:55], v45 offset:30720
    ds_read_b64_tr_b16 a[56:57], v46 offset:28672
    ds_read_b64_tr_b16 a[58:59], v46 offset:30720
    ds_read_b64_tr_b16 a[60:61], v47 offset:28672
    ds_read_b64_tr_b16 a[62:63], v47 offset:30720
    v_mfma_f32_32x32x16_bf16 v[96:111], a[28:31], v[252:255], v[96:111]
    v_exp_f32 v92, v92
    v_exp_f32 v93, v93
    v_cvt_pk_bf16_f32 v133, v90, v91
    v_exp_f32 v94, v94
    v_exp_f32 v95, v95
    v_cvt_pk_bf16_f32 v134, v92, v93
    v_cvt_pk_bf16_f32 v135, v94, v95
    s_waitcnt vmcnt(16) lgkmcnt(0)
    s_barrier
    v_mfma_f32_32x32x16_bf16 v[144:159], a[192:195], v[128:131], v[144:159]
    s_add_u32 m0, s57, 0
    s_nop 0
    buffer_load_dwordx4 v63, s[36:39], s54 offen lds
    buffer_load_dwordx4 v64, s[36:39], s54 offen offset:1024 lds
    buffer_load_dwordx4 v65, s[36:39], s54 offen offset:2048 lds
    v_mfma_f32_32x32x16_bf16 v[160:175], a[196:199], v[128:131], v[160:175]
    v_max3_f32 v68, v96, v97, v98
    v_max3_f32 v69, v99, v100, v101
    v_max3_f32 v68, v68, v102, v103
    v_max3_f32 v69, v69, v104, v105
    v_max3_f32 v68, v68, v106, v107
    v_max3_f32 v69, v69, v108, v109
    v_max3_f32 v68, v68, v110, v111
    v_max_f32 v68, v68, v69
    v_mfma_f32_32x32x16_bf16 v[176:191], a[200:203], v[128:131], v[176:191]
    v_cmp_lt_f32 vcc, 0x41000000, v68
    s_cbranch_vccnz L_stubB15
L_backB15:
    v_exp_f32 v96, v96
    v_exp_f32 v97, v97
    v_exp_f32 v98, v98
    v_mfma_f32_32x32x16_bf16 v[192:207], a[204:207], v[128:131], v[192:207]
    v_exp_f32 v99, v99
    v_cvt_pk_bf16_f32 v136, v96, v97
    v_exp_f32 v100, v100
    v_exp_f32 v101, v101
    v_cvt_pk_bf16_f32 v137, v98, v99
    v_mfma_f32_16x16x32_bf16 v[208:211], a[240:243], v[128:131], v[208:211]
    v_exp_f32 v102, v102
    v_mfma_f32_32x32x16_bf16 v[144:159], a[208:211], v[132:135], v[144:159]
    v_exp_f32 v103, v103
    v_cvt_pk_bf16_f32 v138, v100, v101
    v_exp_f32 v104, v104
    v_exp_f32 v105, v105
    v_cvt_pk_bf16_f32 v139, v102, v103
    v_mfma_f32_32x32x16_bf16 v[160:175], a[212:215], v[132:135], v[160:175]
    buffer_load_dwordx4 v66, s[36:39], s54 offen offset:3072 lds
    v_exp_f32 v106, v106
    s_add_u32 m0, s57, 4096
    v_exp_f32 v107, v107
    s_add_u32 s48, s54, 36864
    v_cvt_pk_bf16_f32 v140, v104, v105
    v_mfma_f32_32x32x16_bf16 v[176:191], a[216:219], v[132:135], v[176:191]
    buffer_load_dwordx4 v63, s[36:39], s48 offen lds
    v_exp_f32 v108, v108
    buffer_load_dwordx4 v64, s[36:39], s48 offen offset:1024 lds
    v_exp_f32 v109, v109
    v_mfma_f32_32x32x16_bf16 v[192:207], a[220:223], v[132:135], v[192:207]
    buffer_load_dwordx4 v65, s[36:39], s48 offen offset:2048 lds
    v_cvt_pk_bf16_f32 v141, v106, v107
    v_exp_f32 v110, v110
    buffer_load_dwordx4 v66, s[36:39], s48 offen offset:3072 lds
    s_add_u32 s54, s54, 128
    v_mfma_f32_16x16x32_bf16 v[208:211], a[240:243], v[132:135], v[208:211]
    v_exp_f32 v111, v111
    v_cvt_pk_bf16_f32 v142, v108, v109
    v_cvt_pk_bf16_f32 v143, v110, v111
    s_sub_u32 s49, s54, 1152
    s_cselect_b32 s54, s54, s49
    s_branch L_common
L_grpA:
    s_add_u32 m0, s56, 106496
    s_nop 0
    buffer_load_dwordx4 v96, s[20:23], s60 offen lds
    buffer_load_dwordx4 v97, s[20:23], s60 offen offset:1024 lds
    s_add_u32 s60, s60, 128
    s_sub_u32 s49, s60, 1152
    s_cselect_b32 s60, s60, s49
    s_add_u32 m0, s56, 32768
    s_nop 0
    buffer_load_dwordx4 v52, s[24:27], s64 offen nt lds
    buffer_load_dwordx4 v53, s[24:27], s64 offen offset:1024 nt lds
    s_add_u32 m0, s56, 40960
    s_nop 0
    buffer_load_dwordx4 v52, s[24:27], s65 offen nt lds
    buffer_load_dwordx4 v53, s[24:27], s65 offen offset:1024 nt lds
    s_waitcnt vmcnt(10) lgkmcnt(0)
    s_barrier
    ds_read_b128 a[48:51], v80 offset:0
    ds_read_b128 a[52:55], v81 offset:0
    ds_read_b128 a[56:59], v82 offset:0
    v_mfma_f32_32x32x16_bf16 v[144:159], a[176:179], a[8:11], v[144:159]
    ds_read_b128 a[60:63], v83 offset:0
    ds_read_b128 a[64:67], v80 offset:8192
    v_mfma_f32_32x32x16_bf16 v[160:175], a[180:183], a[8:11], v[160:175]
    ds_read_b128 a[68:71], v81 offset:8192
    ds_read_b128 a[72:75], v82 offset:8192
    ds_read_b128 a[76:79], v83 offset:8192
    v_mfma_f32_32x32x16_bf16 v[176:191], a[184:187], a[8:11], v[176:191]
    ds_read_b128 a[80:83], v80 offset:16384
    ds_read_b128 a[84:87], v81 offset:16384
    v_mfma_f32_32x32x16_bf16 v[192:207], a[188:191], a[8:11], v[192:207]
    ds_read_b128 a[88:91], v82 offset:16384
    ds_read_b128 a[92:95], v83 offset:16384
    v_mfma_f32_32x32x16_bf16 v[144:159], a[192:195], a[12:15], v[144:159]
    v_mfma_f32_32x32x16_bf16 v[160:175], a[196:199], a[12:15], v[160:175]
    v_mfma_f32_32x32x16_bf16 v[176:191], a[200:203], a[12:15], v[176:191]
    v_mfma_f32_32x32x16_bf16 v[192:207], a[204:207], a[12:15], v[192:207]
    s_add_u32 m0, s56, 49152
    s_nop 0
    buffer_load_dwordx4 v54, s[28:31], s64 offen nt lds
    buffer_load_dwordx4 v54, s[28:31], s64 offen offset:1024 nt lds
    s_add_u32 m0, s56, 57344
    s_nop 0
    buffer_load_dwordx4 v52, s[24:27], s66 offen nt lds
    buffer_load_dwordx4 v53, s[24:27], s66 offen offset:1024 nt lds
    s_add_u32 m0, s56, 65536
    s_nop 0
    buffer_load_dwordx4 v54, s[28:31], s65 offen nt lds
    buffer_load_dwordx4 v54, s[28:31], s65 offen offset:1024 nt lds
    s_waitcnt vmcnt(10) lgkmcnt(0)
    s_barrier
    ds_read_b128 a[96:99], v80 offset:24576
    ds_read_b128 a[100:103], v81 offset:24576
    ds_read_b128 a[104:107], v82 offset:24576
    ds_read_b128 a[108:111], v83 offset:24576
    ds_read_b128 a[112:115], v84 offset:32768
    ds_read_b128 a[116:119], v85 offset:32768
    ds_read_b128 a[120:123], v86 offset:32768
    ds_read_b128 a[124:127], v87 offset:32768
    ds_read_b128 a[128:131], v84 offset:40960
    ds_read_b128 a[132:135], v85 offset:40960
    ds_read_b128 a[136:139], v86 offset:40960
    ds_read_b128 a[140:143], v87 offset:40960
    s_add_u32 m0, s56, 73728
    s_nop 0
    buffer_load_dwordx4 v52, s[24:27], s67 offen nt lds
    buffer_load_dwordx4 v53, s[24:27], s67 offen offset:1024 nt lds
    s_add_u32 m0, s56, 81920
    s_nop 0
    buffer_load_dwordx4 v54, s[28:31], s66 offen nt lds
    buffer_load_dwordx4 v54, s[28:31], s66 offen offset:1024 nt lds
    s_add_u32 m0, s56, 90112
    s_nop 0
    buffer_load_dwordx4 v52, s[24:27], s68 offen nt lds
    buffer_load_dwordx4 v53, s[24:27], s68 offen offset:1024 nt lds
    s_add_u32 m0, s56, 0
    s_nop 0
    buffer_load_dwordx4 v54, s[28:31], s67 offen nt lds
    buffer_load_dwordx4 v54, s[28:31], s67 offen offset:1024 nt lds
    s_add_u32 m0, s56, 8192
    s_nop 0
    buffer_load_dwordx4 v52, s[24:27], s69 offen nt lds
    buffer_load_dwordx4 v53, s[24:27], s69 offen offset:1024 nt lds
    s_add_u32 m0, s56, 16384
    s_nop 0
    buffer_load_dwordx4 v54, s[28:31], s68 offen nt lds
    buffer_load_dwordx4 v54, s[28:31], s68 offen offset:1024 nt lds
    s_waitcnt lgkmcnt(0)
    s_barrier
    s_add_u32 m0, s56, 24576
    s_nop 0
    buffer_load_dwordx4 v52, s[24:27], s70 offen nt lds
    buffer_load_dwordx4 v53, s[24:27], s70 offen offset:1024 nt lds
    s_add_u32 m0, s56, 98304
    s_nop 0
    buffer_load_dwordx4 v54, s[28:31], s69 offen nt lds
    buffer_load_dwordx4 v54, s[28:31], s69 offen offset:1024 nt lds
    s_add_u32 m0, s56, 106496
    s_nop 0
    buffer_load_dwordx4 v52, s[24:27], s71 offen nt lds
    buffer_load_dwordx4 v53, s[24:27], s71 offen offset:1024 nt lds
    s_add_u32 m0, s62, 147456
    s_nop 0
    buffer_load_dwordx4 v100, s[32:35], s53 offen lds
    buffer_load_dwordx4 v101, s[32:35], s53 offen offset:1024 lds
    buffer_load_dwordx4 v102, s[32:35], s53 offen offset:2048 lds
    buffer_load_dwordx4 v103, s[32:35], s53 offen offset:3072 lds
    s_add_u32 s53, s53, 262144
    s_sub_u32 s49, s53, 4718592
    s_cselect_b32 s53, s53, s49
    s_add_u32 m0, s62, 114688
    s_nop 0
    buffer_load_dwordx4 v100, s[32:35], s53 offen lds
    buffer_load_dwordx4 v101, s[32:35], s53 offen offset:1024 lds
    buffer_load_dwordx4 v102, s[32:35], s53 offen offset:2048 lds
    buffer_load_dwordx4 v103, s[32:35], s53 offen offset:3072 lds
    s_add_u32 s53, s53, 262144
    s_sub_u32 s49, s53, 4718592
    s_cselect_b32 s53, s53, s49
    s_add_u32 m0, s62, 131072
    s_nop 0
    buffer_load_dwordx4 v100, s[32:35], s53 offen lds
    buffer_load_dwordx4 v101, s[32:35], s53 offen offset:1024 lds
    buffer_load_dwordx4 v102, s[32:35], s53 offen offset:2048 lds
    buffer_load_dwordx4 v103, s[32:35], s53 offen offset:3072 lds
    s_add_u32 s53, s53, 262144
    s_sub_u32 s49, s53, 4718592
    s_cselect_b32 s53, s53, s49
    s_waitcnt vmcnt(8)
    s_barrier
    ds_read_b64_tr_b16 a[144:145], v92 offset:16384
    ds_read_b64_tr_b16 a[146:147], v92 offset:17408
    ds_read_b64_tr_b16 a[148:149], v93 offset:16384
    ds_read_b64_tr_b16 a[150:151], v93 offset:17408
    ds_read_b64_tr_b16 a[152:153], v94 offset:16384
    ds_read_b64_tr_b16 a[154:155], v94 offset:17408
    ds_read_b64_tr_b16 a[156:157], v95 offset:16384
    ds_read_b64_tr_b16 a[158:159], v95 offset:17408
    ds_read_b64_tr_b16 a[160:161], v92 offset:24576
    ds_read_b64_tr_b16 a[162:163], v92 offset:25600
    ds_read_b64_tr_b16 a[164:165], v93 offset:24576
    ds_read_b64_tr_b16 a[166:167], v93 offset:25600
    ds_read_b64_tr_b16 a[168:169], v94 offset:24576
    ds_read_b64_tr_b16 a[170:171], v94 offset:25600
    ds_read_b64_tr_b16 a[172:173], v95 offset:24576
    ds_read_b64_tr_b16 a[174:175], v95 offset:25600
    s_waitcnt vmcnt(4) lgkmcnt(0)
    s_barrier
    ds_read_b64_tr_b16 a[176:177], v88 offset:49152
    ds_read_b64_tr_b16 a[178:179], v88 offset:50176
    ds_read_b64_tr_b16 a[180:181], v89 offset:49152
    v_mfma_f32_32x32x16_bf16 v[144:159], a[144:147], a[16:19], v[144:159]
    ds_read_b64_tr_b16 a[182:183], v89 offset:50176
    ds_read_b64_tr_b16 a[184:185], v90 offset:49152
    s_add_u32 m0, s62, 147456
    v_mfma_f32_32x32x16_bf16 v[160:175], a[148:151], a[16:19], v[160:175]
    ds_read_b64_tr_b16 a[186:187], v90 offset:50176
    ds_read_b64_tr_b16 a[188:189], v91 offset:49152
    buffer_load_dwordx4 v100, s[32:35], s53 offen lds
    v_mfma_f32_32x32x16_bf16 v[176:191], a[152:155], a[16:19], v[176:191]
    ds_read_b64_tr_b16 a[190:191], v91 offset:50176
    ds_read_b64_tr_b16 a[192:193], v88 offset:57344
    ds_read_b64_tr_b16 a[194:195], v88 offset:58368
    buffer_load_dwordx4 v101, s[32:35], s53 offen offset:1024 lds
    v_mfma_f32_32x32x16_bf16 v[192:207], a[156:159], a[16:19], v[192:207]
    ds_read_b64_tr_b16 a[196:197], v89 offset:57344
    ds_read_b64_tr_b16 a[198:199], v89 offset:58368
    buffer_load_dwordx4 v102, s[32:35], s53 offen offset:2048 lds
    v_mfma_f32_32x32x16_bf16 v[144:159], a[160:163], a[20:23], v[144:159]
    ds_read_b64_tr_b16 a[200:201], v90 offset:57344
    ds_read_b64_tr_b16 a[202:203], v90 offset:58368
    buffer_load_dwordx4 v103, s[32:35], s53 offen offset:3072 lds
    v_mfma_f32_32x32x16_bf16 v[160:175], a[164:167], a[20:23], v[160:175]
    ds_read_b64_tr_b16 a[204:205], v91 offset:57344
    ds_read_b64_tr_b16 a[206:207], v91 offset:58368
    s_add_u32 s53, s53, 262144
    v_mfma_f32_32x32x16_bf16 v[176:191], a[168:171], a[20:23], v[176:191]
    s_sub_u32 s49, s53, 4718592
    s_cselect_b32 s53, s53, s49
    v_mfma_f32_32x32x16_bf16 v[192:207], a[172:175], a[20:23], v[192:207]
    s_waitcnt vmcnt(4) lgkmcnt(0)
    s_barrier
    ds_read_b64_tr_b16 a[144:145], v92 offset:0
    ds_read_b64_tr_b16 a[146:147], v92 offset:1024
    ds_read_b64_tr_b16 a[148:149], v93 offset:0
    v_mfma_f32_32x32x16_bf16 v[144:159], a[176:179], a[24:27], v[144:159]
    ds_read_b64_tr_b16 a[150:151], v93 offset:1024
    ds_read_b64_tr_b16 a[152:153], v94 offset:0
    s_add_u32 m0, s62, 114688
    v_mfma_f32_32x32x16_bf16 v[160:175], a[180:183], a[24:27], v[160:175]
    ds_read_b64_tr_b16 a[154:155], v94 offset:1024
    ds_read_b64_tr_b16 a[156:157], v95 offset:0
    buffer_load_dwordx4 v100, s[32:35], s53 offen lds
    v_mfma_f32_32x32x16_bf16 v[176:191], a[184:187], a[24:27], v[176:191]
    ds_read_b64_tr_b16 a[158:159], v95 offset:1024
    ds_read_b64_tr_b16 a[160:161], v92 offset:8192
    ds_read_b64_tr_b16 a[162:163], v92 offset:9216
    buffer_load_dwordx4 v101, s[32:35], s53 offen offset:1024 lds
    v_mfma_f32_32x32x16_bf16 v[192:207], a[188:191], a[24:27], v[192:207]
    ds_read_b64_tr_b16 a[164:165], v93 offset:8192
    ds_read_b64_tr_b16 a[166:167], v93 offset:9216
    buffer_load_dwordx4 v102, s[32:35], s53 offen offset:2048 lds
    v_mfma_f32_32x32x16_bf16 v[144:159], a[192:195], a[28:31], v[144:159]
    ds_read_b64_tr_b16 a[168:169], v94 offset:8192
    ds_read_b64_tr_b16 a[170:171], v94 offset:9216
    buffer_load_dwordx4 v103, s[32:35], s53 offen offset:3072 lds
    v_mfma_f32_32x32x16_bf16 v[160:175], a[196:199], a[28:31], v[160:175]
    ds_read_b64_tr_b16 a[172:173], v95 offset:8192
    ds_read_b64_tr_b16 a[174:175], v95 offset:9216
    s_add_u32 s53, s53, 262144
    v_mfma_f32_32x32x16_bf16 v[176:191], a[200:203], a[28:31], v[176:191]
    s_sub_u32 s49, s53, 4718592
    s_cselect_b32 s53, s53, s49
    v_mfma_f32_32x32x16_bf16 v[192:207], a[204:207], a[28:31], v[192:207]
    s_waitcnt vmcnt(4) lgkmcnt(0)
    s_barrier
    ds_read_b64_tr_b16 a[176:177], v92 offset:16384
    ds_read_b64_tr_b16 a[178:179], v92 offset:17408
    ds_read_b64_tr_b16 a[180:181], v93 offset:16384
    v_mfma_f32_32x32x16_bf16 v[144:159], a[144:147], a[32:35], v[144:159]
    ds_read_b64_tr_b16 a[182:183], v93 offset:17408
    ds_read_b64_tr_b16 a[184:185], v94 offset:16384
    s_add_u32 m0, s62, 131072
    v_mfma_f32_32x32x16_bf16 v[160:175], a[148:151], a[32:35], v[160:175]
    ds_read_b64_tr_b16 a[186:187], v94 offset:17408
    ds_read_b64_tr_b16 a[188:189], v95 offset:16384
    buffer_load_dwordx4 v100, s[32:35], s53 offen lds
    v_mfma_f32_32x32x16_bf16 v[176:191], a[152:155], a[32:35], v[176:191]
    ds_read_b64_tr_b16 a[190:191], v95 offset:17408
    ds_read_b64_tr_b16 a[192:193], v92 offset:24576
    ds_read_b64_tr_b16 a[194:195], v92 offset:25600
    buffer_load_dwordx4 v101, s[32:35], s53 offen offset:1024 lds
    v_mfma_f32_32x32x16_bf16 v[192:207], a[156:159], a[32:35], v[192:207]
    ds_read_b64_tr_b16 a[196:197], v93 offset:24576
    ds_read_b64_tr_b16 a[198:199], v93 offset:25600
    buffer_load_dwordx4 v102, s[32:35], s53 offen offset:2048 lds
    v_mfma_f32_32x32x16_bf16 v[144:159], a[160:163], a[36:39], v[144:159]
    ds_read_b64_tr_b16 a[200:201], v94 offset:24576
    ds_read_b64_tr_b16 a[202:203], v94 offset:25600
    buffer_load_dwordx4 v103, s[32:35], s53 offen offset:3072 lds
    v_mfma_f32_32x32x16_bf16 v[160:175], a[164:167], a[36:39], v[160:175]
    ds_read_b64_tr_b16 a[204:205], v95 offset:24576
    ds_read_b64_tr_b16 a[206:207], v95 offset:25600
    s_add_u32 s53, s53, 262144
    v_mfma_f32_32x32x16_bf16 v[176:191], a[168:171], a[36:39], v[176:191]
    s_sub_u32 s49, s53, 4718592
    s_cselect_b32 s53, s53, s49
    v_mfma_f32_32x32x16_bf16 v[192:207], a[172:175], a[36:39], v[192:207]
    s_waitcnt vmcnt(4) lgkmcnt(0)
    s_barrier
    ds_read_b64_tr_b16 a[144:145], v88 offset:49152
    ds_read_b64_tr_b16 a[146:147], v88 offset:50176
    ds_read_b64_tr_b16 a[148:149], v89 offset:49152
    v_mfma_f32_32x32x16_bf16 v[144:159], a[176:179], a[40:43], v[144:159]
    ds_read_b64_tr_b16 a[150:151], v89 offset:50176
    ds_read_b64_tr_b16 a[152:153], v90 offset:49152
    s_add_u32 m0, s62, 147456
    v_mfma_f32_32x32x16_bf16 v[160:175], a[180:183], a[40:43], v[160:175]
    ds_read_b64_tr_b16 a[154:155], v90 offset:50176
    ds_read_b64_tr_b16 a[156:157], v91 offset:49152
    buffer_load_dwordx4 v100, s[32:35], s53 offen lds
    v_mfma_f32_32x32x16_bf16 v[176:191], a[184:187], a[40:43], v[176:191]
    ds_read_b64_tr_b16 a[158:159], v91 offset:50176
    ds_read_b64_tr_b16 a[160:161], v88 offset:57344
    ds_read_b64_tr_b16 a[162:163], v88 offset:58368
    buffer_load_dwordx4 v101, s[32:35], s53 offen offset:1024 lds
    v_mfma_f32_32x32x16_bf16 v[192:207], a[188:191], a[40:43], v[192:207]
    ds_read_b64_tr_b16 a[164:165], v89 offset:57344
    ds_read_b64_tr_b16 a[166:167], v89 offset:58368
    buffer_load_dwordx4 v102, s[32:35], s53 offen offset:2048 lds
    v_mfma_f32_32x32x16_bf16 v[144:159], a[192:195], a[44:47], v[144:159]
    ds_read_b64_tr_b16 a[168:169], v90 offset:57344
    ds_read_b64_tr_b16 a[170:171], v90 offset:58368
    buffer_load_dwordx4 v103, s[32:35], s53 offen offset:3072 lds
    v_mfma_f32_32x32x16_bf16 v[160:175], a[196:199], a[44:47], v[160:175]
    ds_read_b64_tr_b16 a[172:173], v91 offset:57344
    ds_read_b64_tr_b16 a[174:175], v91 offset:58368
    s_add_u32 s53, s53, 262144
    v_mfma_f32_32x32x16_bf16 v[176:191], a[200:203], a[44:47], v[176:191]
    s_sub_u32 s49, s53, 4718592
    s_cselect_b32 s53, s53, s49
    v_mfma_f32_32x32x16_bf16 v[192:207], a[204:207], a[44:47], v[192:207]
    s_waitcnt vmcnt(4) lgkmcnt(0)
    s_barrier
    ds_read_b64_tr_b16 a[176:177], v92 offset:0
    ds_read_b64_tr_b16 a[178:179], v92 offset:1024
    ds_read_b64_tr_b16 a[180:181], v93 offset:0
    v_mfma_f32_32x32x16_bf16 v[144:159], a[144:147], a[48:51], v[144:159]
    ds_read_b64_tr_b16 a[182:183], v93 offset:1024
    ds_read_b64_tr_b16 a[184:185], v94 offset:0
    s_add_u32 m0, s62, 114688
    v_mfma_f32_32x32x16_bf16 v[160:175], a[148:151], a[48:51], v[160:175]
    ds_read_b64_tr_b16 a[186:187], v94 offset:1024
    ds_read_b64_tr_b16 a[188:189], v95 offset:0
    buffer_load_dwordx4 v100, s[32:35], s53 offen lds
    v_mfma_f32_32x32x16_bf16 v[176:191], a[152:155], a[48:51], v[176:191]
    ds_read_b64_tr_b16 a[190:191], v95 offset:1024
    ds_read_b64_tr_b16 a[192:193], v92 offset:8192
    ds_read_b64_tr_b16 a[194:195], v92 offset:9216
    buffer_load_dwordx4 v101, s[32:35], s53 offen offset:1024 lds
    v_mfma_f32_32x32x16_bf16 v[192:207], a[156:159], a[48:51], v[192:207]
    ds_read_b64_tr_b16 a[196:197], v93 offset:8192
    ds_read_b64_tr_b16 a[198:199], v93 offset:9216
    buffer_load_dwordx4 v102, s[32:35], s53 offen offset:2048 lds
    v_mfma_f32_32x32x16_bf16 v[144:159], a[160:163], a[52:55], v[144:159]
    ds_read_b64_tr_b16 a[200:201], v94 offset:8192
    ds_read_b64_tr_b16 a[202:203], v94 offset:9216
    buffer_load_dwordx4 v103, s[32:35], s53 offen offset:3072 lds
    v_mfma_f32_32x32x16_bf16 v[160:175], a[164:167], a[52:55], v[160:175]
    ds_read_b64_tr_b16 a[204:205], v95 offset:8192
    ds_read_b64_tr_b16 a[206:207], v95 offset:9216
    s_add_u32 s53, s53, 262144
    v_mfma_f32_32x32x16_bf16 v[176:191], a[168:171], a[52:55], v[176:191]
    s_sub_u32 s49, s53, 4718592
    s_cselect_b32 s53, s53, s49
    v_mfma_f32_32x32x16_bf16 v[192:207], a[172:175], a[52:55], v[192:207]
    s_waitcnt vmcnt(4) lgkmcnt(0)
    s_barrier
    ds_read_b64_tr_b16 a[144:145], v92 offset:16384
    ds_read_b64_tr_b16 a[146:147], v92 offset:17408
    ds_read_b64_tr_b16 a[148:149], v93 offset:16384
    v_mfma_f32_32x32x16_bf16 v[144:159], a[176:179], a[56:59], v[144:159]
    ds_read_b64_tr_b16 a[150:151], v93 offset:17408
    ds_read_b64_tr_b16 a[152:153], v94 offset:16384
    s_add_u32 m0, s62, 131072
    v_mfma_f32_32x32x16_bf16 v[160:175], a[180:183], a[56:59], v[160:175]
    ds_read_b64_tr_b16 a[154:155], v94 offset:17408
    ds_read_b64_tr_b16 a[156:157], v95 offset:16384
    buffer_load_dwordx4 v100, s[32:35], s53 offen lds
    v_mfma_f32_32x32x16_bf16 v[176:191], a[184:187], a[56:59], v[176:191]
    ds_read_b64_tr_b16 a[158:159], v95 offset:17408
    ds_read_b64_tr_b16 a[160:161], v92 offset:24576
    ds_read_b64_tr_b16 a[162:163], v92 offset:25600
    buffer_load_dwordx4 v101, s[32:35], s53 offen offset:1024 lds
    v_mfma_f32_32x32x16_bf16 v[192:207], a[188:191], a[56:59], v[192:207]
    ds_read_b64_tr_b16 a[164:165], v93 offset:24576
    ds_read_b64_tr_b16 a[166:167], v93 offset:25600
    buffer_load_dwordx4 v102, s[32:35], s53 offen offset:2048 lds
    v_mfma_f32_32x32x16_bf16 v[144:159], a[192:195], a[60:63], v[144:159]
    ds_read_b64_tr_b16 a[168:169], v94 offset:24576
    ds_read_b64_tr_b16 a[170:171], v94 offset:25600
    buffer_load_dwordx4 v103, s[32:35], s53 offen offset:3072 lds
    v_mfma_f32_32x32x16_bf16 v[160:175], a[196:199], a[60:63], v[160:175]
    ds_read_b64_tr_b16 a[172:173], v95 offset:24576
    ds_read_b64_tr_b16 a[174:175], v95 offset:25600
    s_add_u32 s53, s53, 262144
    v_mfma_f32_32x32x16_bf16 v[176:191], a[200:203], a[60:63], v[176:191]
    s_sub_u32 s49, s53, 4718592
    s_cselect_b32 s53, s53, s49
    v_mfma_f32_32x32x16_bf16 v[192:207], a[204:207], a[60:63], v[192:207]
    s_waitcnt vmcnt(4) lgkmcnt(0)
    s_barrier
    ds_read_b64_tr_b16 a[176:177], v88 offset:49152
    ds_read_b64_tr_b16 a[178:179], v88 offset:50176
    ds_read_b64_tr_b16 a[180:181], v89 offset:49152
    v_mfma_f32_32x32x16_bf16 v[144:159], a[144:147], a[64:67], v[144:159]
    ds_read_b64_tr_b16 a[182:183], v89 offset:50176
    ds_read_b64_tr_b16 a[184:185], v90 offset:49152
    s_add_u32 m0, s62, 147456
    v_mfma_f32_32x32x16_bf16 v[160:175], a[148:151], a[64:67], v[160:175]
    ds_read_b64_tr_b16 a[186:187], v90 offset:50176
    ds_read_b64_tr_b16 a[188:189], v91 offset:49152
    buffer_load_dwordx4 v100, s[32:35], s53 offen lds
    v_mfma_f32_32x32x16_bf16 v[176:191], a[152:155], a[64:67], v[176:191]
    ds_read_b64_tr_b16 a[190:191], v91 offset:50176
    ds_read_b64_tr_b16 a[192:193], v88 offset:57344
    ds_read_b64_tr_b16 a[194:195], v88 offset:58368
    buffer_load_dwordx4 v101, s[32:35], s53 offen offset:1024 lds
    v_mfma_f32_32x32x16_bf16 v[192:207], a[156:159], a[64:67], v[192:207]
    ds_read_b64_tr_b16 a[196:197], v89 offset:57344
    ds_read_b64_tr_b16 a[198:199], v89 offset:58368
    buffer_load_dwordx4 v102, s[32:35], s53 offen offset:2048 lds
    v_mfma_f32_32x32x16_bf16 v[144:159], a[160:163], a[68:71], v[144:159]
    ds_read_b64_tr_b16 a[200:201], v90 offset:57344
    ds_read_b64_tr_b16 a[202:203], v90 offset:58368
    buffer_load_dwordx4 v103, s[32:35], s53 offen offset:3072 lds
    v_mfma_f32_32x32x16_bf16 v[160:175], a[164:167], a[68:71], v[160:175]
    ds_read_b64_tr_b16 a[204:205], v91 offset:57344
    ds_read_b64_tr_b16 a[206:207], v91 offset:58368
    s_add_u32 s53, s53, 262144
    v_mfma_f32_32x32x16_bf16 v[176:191], a[168:171], a[68:71], v[176:191]
    s_sub_u32 s49, s53, 4718592
    s_cselect_b32 s53, s53, s49
    v_mfma_f32_32x32x16_bf16 v[192:207], a[172:175], a[68:71], v[192:207]
    s_waitcnt vmcnt(4) lgkmcnt(0)
    s_barrier
    ds_read_b64_tr_b16 a[144:145], v92 offset:0
    ds_read_b64_tr_b16 a[146:147], v92 offset:1024
    ds_read_b64_tr_b16 a[148:149], v93 offset:0
    v_mfma_f32_32x32x16_bf16 v[144:159], a[176:179], a[72:75], v[144:159]
    ds_read_b64_tr_b16 a[150:151], v93 offset:1024
    ds_read_b64_tr_b16 a[152:153], v94 offset:0
    s_add_u32 m0, s62, 114688
    v_mfma_f32_32x32x16_bf16 v[160:175], a[180:183], a[72:75], v[160:175]
    ds_read_b64_tr_b16 a[154:155], v94 offset:1024
    ds_read_b64_tr_b16 a[156:157], v95 offset:0
    buffer_load_dwordx4 v100, s[32:35], s53 offen lds
    v_mfma_f32_32x32x16_bf16 v[176:191], a[184:187], a[72:75], v[176:191]
    ds_read_b64_tr_b16 a[158:159], v95 offset:1024
    ds_read_b64_tr_b16 a[160:161], v92 offset:8192
    ds_read_b64_tr_b16 a[162:163], v92 offset:9216
    buffer_load_dwordx4 v101, s[32:35], s53 offen offset:1024 lds
    v_mfma_f32_32x32x16_bf16 v[192:207], a[188:191], a[72:75], v[192:207]
    ds_read_b64_tr_b16 a[164:165], v93 offset:8192
    ds_read_b64_tr_b16 a[166:167], v93 offset:9216
    buffer_load_dwordx4 v102, s[32:35], s53 offen offset:2048 lds
    v_mfma_f32_32x32x16_bf16 v[144:159], a[192:195], a[76:79], v[144:159]
    ds_read_b64_tr_b16 a[168:169], v94 offset:8192
    ds_read_b64_tr_b16 a[170:171], v94 offset:9216
    buffer_load_dwordx4 v103, s[32:35], s53 offen offset:3072 lds
    v_mfma_f32_32x32x16_bf16 v[160:175], a[196:199], a[76:79], v[160:175]
    ds_read_b64_tr_b16 a[172:173], v95 offset:8192
    ds_read_b64_tr_b16 a[174:175], v95 offset:9216
    s_add_u32 s53, s53, 262144
    v_mfma_f32_32x32x16_bf16 v[176:191], a[200:203], a[76:79], v[176:191]
    s_sub_u32 s49, s53, 4718592
    s_cselect_b32 s53, s53, s49
    v_mfma_f32_32x32x16_bf16 v[192:207], a[204:207], a[76:79], v[192:207]
    s_waitcnt vmcnt(4) lgkmcnt(0)
    s_barrier
    ds_read_b64_tr_b16 a[176:177], v92 offset:16384
    ds_read_b64_tr_b16 a[178:179], v92 offset:17408
    ds_read_b64_tr_b16 a[180:181], v93 offset:16384
    v_mfma_f32_32x32x16_bf16 v[144:159], a[144:147], a[80:83], v[144:159]
    ds_read_b64_tr_b16 a[182:183], v93 offset:17408
    ds_read_b64_tr_b16 a[184:185], v94 offset:16384
    s_add_u32 m0, s62, 131072
    v_mfma_f32_32x32x16_bf16 v[160:175], a[148:151], a[80:83], v[160:175]
    ds_read_b64_tr_b16 a[186:187], v94 offset:17408
    ds_read_b64_tr_b16 a[188:189], v95 offset:16384
    buffer_load_dwordx4 v100, s[32:35], s53 offen lds
    v_mfma_f32_32x32x16_bf16 v[176:191], a[152:155], a[80:83], v[176:191]
    ds_read_b64_tr_b16 a[190:191], v95 offset:17408
    ds_read_b64_tr_b16 a[192:193], v92 offset:24576
    ds_read_b64_tr_b16 a[194:195], v92 offset:25600
    buffer_load_dwordx4 v101, s[32:35], s53 offen offset:1024 lds
    v_mfma_f32_32x32x16_bf16 v[192:207], a[156:159], a[80:83], v[192:207]
    ds_read_b64_tr_b16 a[196:197], v93 offset:24576
    ds_read_b64_tr_b16 a[198:199], v93 offset:25600
    buffer_load_dwordx4 v102, s[32:35], s53 offen offset:2048 lds
    v_mfma_f32_32x32x16_bf16 v[144:159], a[160:163], a[84:87], v[144:159]
    ds_read_b64_tr_b16 a[200:201], v94 offset:24576
    ds_read_b64_tr_b16 a[202:203], v94 offset:25600
    buffer_load_dwordx4 v103, s[32:35], s53 offen offset:3072 lds
    v_mfma_f32_32x32x16_bf16 v[160:175], a[164:167], a[84:87], v[160:175]
    ds_read_b64_tr_b16 a[204:205], v95 offset:24576
    ds_read_b64_tr_b16 a[206:207], v95 offset:25600
    s_add_u32 s53, s53, 262144
    v_mfma_f32_32x32x16_bf16 v[176:191], a[168:171], a[84:87], v[176:191]
    s_sub_u32 s49, s53, 4718592
    s_cselect_b32 s53, s53, s49
    v_mfma_f32_32x32x16_bf16 v[192:207], a[172:175], a[84:87], v[192:207]
    s_waitcnt vmcnt(4) lgkmcnt(0)
    s_barrier
    ds_read_b64_tr_b16 a[144:145], v88 offset:49152
    ds_read_b64_tr_b16 a[146:147], v88 offset:50176
    ds_read_b64_tr_b16 a[148:149], v89 offset:49152
    v_mfma_f32_32x32x16_bf16 v[144:159], a[176:179], a[88:91], v[144:159]
    ds_read_b64_tr_b16 a[150:151], v89 offset:50176
    ds_read_b64_tr_b16 a[152:153], v90 offset:49152
    s_add_u32 m0, s62, 147456
    v_mfma_f32_32x32x16_bf16 v[160:175], a[180:183], a[88:91], v[160:175]
    ds_read_b64_tr_b16 a[154:155], v90 offset:50176
    ds_read_b64_tr_b16 a[156:157], v91 offset:49152
    buffer_load_dwordx4 v100, s[32:35], s53 offen lds
    v_mfma_f32_32x32x16_bf16 v[176:191], a[184:187], a[88:91], v[176:191]
    ds_read_b64_tr_b16 a[158:159], v91 offset:50176
    ds_read_b64_tr_b16 a[160:161], v88 offset:57344
    ds_read_b64_tr_b16 a[162:163], v88 offset:58368
    buffer_load_dwordx4 v101, s[32:35], s53 offen offset:1024 lds
    v_mfma_f32_32x32x16_bf16 v[192:207], a[188:191], a[88:91], v[192:207]
    ds_read_b64_tr_b16 a[164:165], v89 offset:57344
    ds_read_b64_tr_b16 a[166:167], v89 offset:58368
    buffer_load_dwordx4 v102, s[32:35], s53 offen offset:2048 lds
    v_mfma_f32_32x32x16_bf16 v[144:159], a[192:195], a[92:95], v[144:159]
    ds_read_b64_tr_b16 a[168:169], v90 offset:57344
    ds_read_b64_tr_b16 a[170:171], v90 offset:58368
    buffer_load_dwordx4 v103, s[32:35], s53 offen offset:3072 lds
    v_mfma_f32_32x32x16_bf16 v[160:175], a[196:199], a[92:95], v[160:175]
    ds_read_b64_tr_b16 a[172:173], v91 offset:57344
    ds_read_b64_tr_b16 a[174:175], v91 offset:58368
    s_add_u32 s53, s53, 262144
    v_mfma_f32_32x32x16_bf16 v[176:191], a[200:203], a[92:95], v[176:191]
    s_sub_u32 s49, s53, 4718592
    s_cselect_b32 s53, s53, s49
    v_mfma_f32_32x32x16_bf16 v[192:207], a[204:207], a[92:95], v[192:207]
    s_waitcnt vmcnt(4) lgkmcnt(0)
    s_barrier
    ds_read_b64_tr_b16 a[176:177], v92 offset:0
    ds_read_b64_tr_b16 a[178:179], v92 offset:1024
    ds_read_b64_tr_b16 a[180:181], v93 offset:0
    v_mfma_f32_32x32x16_bf16 v[144:159], a[144:147], a[96:99], v[144:159]
    ds_read_b64_tr_b16 a[182:183], v93 offset:1024
    ds_read_b64_tr_b16 a[184:185], v94 offset:0
    s_add_u32 m0, s62, 114688
    v_mfma_f32_32x32x16_bf16 v[160:175], a[148:151], a[96:99], v[160:175]
    ds_read_b64_tr_b16 a[186:187], v94 offset:1024
    ds_read_b64_tr_b16 a[188:189], v95 offset:0
    buffer_load_dwordx4 v100, s[32:35], s53 offen lds
    v_mfma_f32_32x32x16_bf16 v[176:191], a[152:155], a[96:99], v[176:191]
    ds_read_b64_tr_b16 a[190:191], v95 offset:1024
    ds_read_b64_tr_b16 a[192:193], v92 offset:8192
    ds_read_b64_tr_b16 a[194:195], v92 offset:9216
    buffer_load_dwordx4 v101, s[32:35], s53 offen offset:1024 lds
    v_mfma_f32_32x32x16_bf16 v[192:207], a[156:159], a[96:99], v[192:207]
    ds_read_b64_tr_b16 a[196:197], v93 offset:8192
    ds_read_b64_tr_b16 a[198:199], v93 offset:9216
    buffer_load_dwordx4 v102, s[32:35], s53 offen offset:2048 lds
    v_mfma_f32_32x32x16_bf16 v[144:159], a[160:163], a[100:103], v[144:159]
    ds_read_b64_tr_b16 a[200:201], v94 offset:8192
    ds_read_b64_tr_b16 a[202:203], v94 offset:9216
    buffer_load_dwordx4 v103, s[32:35], s53 offen offset:3072 lds
    v_mfma_f32_32x32x16_bf16 v[160:175], a[164:167], a[100:103], v[160:175]
    ds_read_b64_tr_b16 a[204:205], v95 offset:8192
    ds_read_b64_tr_b16 a[206:207], v95 offset:9216
    s_add_u32 s53, s53, 262144
    v_mfma_f32_32x32x16_bf16 v[176:191], a[168:171], a[100:103], v[176:191]
    s_sub_u32 s49, s53, 4718592
    s_cselect_b32 s53, s53, s49
    v_mfma_f32_32x32x16_bf16 v[192:207], a[172:175], a[100:103], v[192:207]
    s_waitcnt vmcnt(4) lgkmcnt(0)
    s_barrier
    ds_read_b64_tr_b16 a[144:145], v92 offset:16384
    ds_read_b64_tr_b16 a[146:147], v92 offset:17408
    ds_read_b64_tr_b16 a[148:149], v93 offset:16384
    v_mfma_f32_32x32x16_bf16 v[144:159], a[176:179], a[104:107], v[144:159]
    ds_read_b64_tr_b16 a[150:151], v93 offset:17408
    ds_read_b64_tr_b16 a[152:153], v94 offset:16384
    s_add_u32 m0, s62, 131072
    v_mfma_f32_32x32x16_bf16 v[160:175], a[180:183], a[104:107], v[160:175]
    ds_read_b64_tr_b16 a[154:155], v94 offset:17408
    ds_read_b64_tr_b16 a[156:157], v95 offset:16384
    buffer_load_dwordx4 v100, s[32:35], s53 offen lds
    v_mfma_f32_32x32x16_bf16 v[176:191], a[184:187], a[104:107], v[176:191]
    ds_read_b64_tr_b16 a[158:159], v95 offset:17408
    ds_read_b64_tr_b16 a[160:161], v92 offset:24576
    ds_read_b64_tr_b16 a[162:163], v92 offset:25600
    buffer_load_dwordx4 v101, s[32:35], s53 offen offset:1024 lds
    v_mfma_f32_32x32x16_bf16 v[192:207], a[188:191], a[104:107], v[192:207]
    ds_read_b64_tr_b16 a[164:165], v93 offset:24576
    ds_read_b64_tr_b16 a[166:167], v93 offset:25600
    buffer_load_dwordx4 v102, s[32:35], s53 offen offset:2048 lds
    v_mfma_f32_32x32x16_bf16 v[144:159], a[192:195], a[108:111], v[144:159]
    ds_read_b64_tr_b16 a[168:169], v94 offset:24576
    ds_read_b64_tr_b16 a[170:171], v94 offset:25600
    buffer_load_dwordx4 v103, s[32:35], s53 offen offset:3072 lds
    v_mfma_f32_32x32x16_bf16 v[160:175], a[196:199], a[108:111], v[160:175]
    ds_read_b64_tr_b16 a[172:173], v95 offset:24576
    ds_read_b64_tr_b16 a[174:175], v95 offset:25600
    s_add_u32 s53, s53, 262144
    v_mfma_f32_32x32x16_bf16 v[176:191], a[200:203], a[108:111], v[176:191]
    s_sub_u32 s49, s53, 4718592
    s_cselect_b32 s53, s53, s49
    v_mfma_f32_32x32x16_bf16 v[192:207], a[204:207], a[108:111], v[192:207]
    s_waitcnt vmcnt(4) lgkmcnt(0)
    s_barrier
    ds_read_b64_tr_b16 a[176:177], v88 offset:49152
    ds_read_b64_tr_b16 a[178:179], v88 offset:50176
    ds_read_b64_tr_b16 a[180:181], v89 offset:49152
    ds_read_b64_tr_b16 a[182:183], v89 offset:50176
    v_mfma_f32_32x32x16_bf16 v[144:159], a[144:147], a[112:115], v[144:159]
    ds_read_b64_tr_b16 a[184:185], v90 offset:49152
    ds_read_b64_tr_b16 a[186:187], v90 offset:50176
    ds_read_b64_tr_b16 a[188:189], v91 offset:49152
    s_add_u32 m0, s62, 147456
    v_mfma_f32_32x32x16_bf16 v[160:175], a[148:151], a[112:115], v[160:175]
    ds_read_b64_tr_b16 a[190:191], v91 offset:50176
    ds_read_b64_tr_b16 a[192:193], v88 offset:57344
    ds_read_b64_tr_b16 a[194:195], v88 offset:58368
    ds_read_b64_tr_b16 a[196:197], v89 offset:57344
    buffer_load_dwordx4 v100, s[32:35], s53 offen lds
    v_mfma_f32_32x32x16_bf16 v[176:191], a[152:155], a[112:115], v[176:191]
    ds_read_b64_tr_b16 a[198:199], v89 offset:58368
    ds_read_b64_tr_b16 a[200:201], v90 offset:57344
    ds_read_b64_tr_b16 a[202:203], v90 offset:58368
    buffer_load_dwordx4 v101, s[32:35], s53 offen offset:1024 lds
    v_mfma_f32_32x32x16_bf16 v[192:207], a[156:159], a[112:115], v[192:207]
    ds_read_b64_tr_b16 a[204:205], v91 offset:57344
    ds_read_b64_tr_b16 a[206:207], v91 offset:58368
    ds_read_b128 a[0:3], v16 offset:32768
    ds_read_b128 a[4:7], v17 offset:32768
    buffer_load_dwordx4 v102, s[32:35], s53 offen offset:2048 lds
    v_mfma_f32_32x32x16_bf16 v[144:159], a[160:163], a[116:119], v[144:159]
    ds_read_b128 a[8:11], v18 offset:32768
    ds_read_b128 a[12:15], v19 offset:32768
    ds_read_b128 a[16:19], v20 offset:32768
    buffer_load_dwordx4 v103, s[32:35], s53 offen offset:3072 lds
    v_mfma_f32_32x32x16_bf16 v[160:175], a[164:167], a[116:119], v[160:175]
    ds_read_b128 a[20:23], v21 offset:32768
    ds_read_b128 a[24:27], v22 offset:32768
    ds_read_b128 a[28:31], v23 offset:32768
    s_add_u32 s53, s53, 262144
    v_mfma_f32_32x32x16_bf16 v[176:191], a[168:171], a[116:119], v[176:191]
    s_sub_u32 s49, s53, 4718592
    s_cselect_b32 s53, s53, s49
    v_mfma_f32_32x32x16_bf16 v[192:207], a[172:175], a[116:119], v[192:207]
    s_waitcnt vmcnt(4) lgkmcnt(0)
    s_barrier
    ds_read_b64_tr_b16 a[144:145], v92 offset:0
    ds_read_b64_tr_b16 a[146:147], v92 offset:1024
    ds_read_b64_tr_b16 a[148:149], v93 offset:0
    ds_read_b64_tr_b16 a[150:151], v93 offset:1024
    v_mfma_f32_32x32x16_bf16 v[144:159], a[176:179], a[120:123], v[144:159]
    ds_read_b64_tr_b16 a[152:153], v94 offset:0
    ds_read_b64_tr_b16 a[154:155], v94 offset:1024
    ds_read_b64_tr_b16 a[156:157], v95 offset:0
    v_mfma_f32_32x32x16_bf16 v[160:175], a[180:183], a[120:123], v[160:175]
    ds_read_b64_tr_b16 a[158:159], v95 offset:1024
    ds_read_b64_tr_b16 a[160:161], v92 offset:8192
    ds_read_b64_tr_b16 a[162:163], v92 offset:9216
    ds_read_b64_tr_b16 a[164:165], v93 offset:8192
    v_mfma_f32_32x32x16_bf16 v[176:191], a[184:187], a[120:123], v[176:191]
    ds_read_b64_tr_b16 a[166:167], v93 offset:9216
    ds_read_b64_tr_b16 a[168:169], v94 offset:8192
    ds_read_b64_tr_b16 a[170:171], v94 offset:9216
    v_mfma_f32_32x32x16_bf16 v[192:207], a[188:191], a[120:123], v[192:207]
    ds_read_b64_tr_b16 a[172:173], v95 offset:8192
    ds_read_b64_tr_b16 a[174:175], v95 offset:9216
    ds_read_b128 a[32:35], v16 offset:40960
    ds_read_b128 a[36:39], v17 offset:40960
    v_mfma_f32_32x32x16_bf16 v[144:159], a[192:195], a[124:127], v[144:159]
    ds_read_b128 a[40:43], v18 offset:40960
    ds_read_b128 a[44:47], v19 offset:40960
    ds_read_b128 a[48:51], v20 offset:40960
    v_mfma_f32_32x32x16_bf16 v[160:175], a[196:199], a[124:127], v[160:175]
    ds_read_b128 a[52:55], v21 offset:40960
    ds_read_b128 a[56:59], v22 offset:40960
    ds_read_b128 a[60:63], v23 offset:40960
    v_mfma_f32_32x32x16_bf16 v[176:191], a[200:203], a[124:127], v[176:191]
    v_mfma_f32_32x32x16_bf16 v[192:207], a[204:207], a[124:127], v[192:207]
    s_waitcnt vmcnt(0) lgkmcnt(0)
    s_barrier
    ds_read_b64_tr_b16 a[176:177], v92 offset:16384
    ds_read_b64_tr_b16 a[178:179], v92 offset:17408
    ds_read_b64_tr_b16 a[192:193], v92 offset:24576
    v_mfma_f32_32x32x16_bf16 v[144:159], a[144:147], a[128:131], v[144:159]
    ds_read_b64_tr_b16 a[194:195], v92 offset:25600
    ds_read_b64_tr_b16 a[180:181], v93 offset:16384
    v_mfma_f32_32x32x16_bf16 v[144:159], a[160:163], a[132:135], v[144:159]
    ds_read_b64_tr_b16 a[182:183], v93 offset:17408
    ds_read_b64_tr_b16 a[196:197], v93 offset:24576
    v_mfma_f32_32x32x16_bf16 v[160:175], a[148:151], a[128:131], v[160:175]
    ds_read_b64_tr_b16 a[198:199], v93 offset:25600
    ds_read_b64_tr_b16 a[184:185], v94 offset:16384
    ds_read_b64_tr_b16 a[186:187], v94 offset:17408
    v_mfma_f32_32x32x16_bf16 v[160:175], a[164:167], a[132:135], v[160:175]
    ds_read_b64_tr_b16 a[200:201], v94 offset:24576
    ds_read_b64_tr_b16 a[202:203], v94 offset:25600
    s_waitcnt lgkmcnt(10)
    v_mfma_f32_32x32x16_bf16 v[144:159], a[176:179], a[136:139], v[144:159]
    ds_read_b64_tr_b16 a[188:189], v95 offset:16384
    ds_read_b64_tr_b16 a[190:191], v95 offset:17408
    s_waitcnt lgkmcnt(10)
    v_mfma_f32_32x32x16_bf16 v[144:159], a[192:195], a[140:143], v[144:159]
    ds_read_b64_tr_b16 a[204:205], v95 offset:24576
    ds_read_b64_tr_b16 a[206:207], v95 offset:25600
    s_waitcnt lgkmcnt(10)
    v_mfma_f32_32x32x16_bf16 v[160:175], a[180:183], a[136:139], v[160:175]
    s_nop 7
    v_mul_f32 v144, s58, v144
    v_mul_f32 v145, s58, v145
    v_mul_f32 v146, s58, v146
    v_mul_f32 v147, s58, v147
    v_mul_f32 v148, s58, v148
    v_mul_f32 v149, s58, v149
    s_waitcnt lgkmcnt(8)
    v_mfma_f32_32x32x16_bf16 v[160:175], a[196:199], a[140:143], v[160:175]
    v_mul_f32 v150, s58, v150
    v_mul_f32 v151, s58, v151
    v_mul_f32 v152, s58, v152
    v_mul_f32 v153, s58, v153
    v_mul_f32 v154, s58, v154
    v_mul_f32 v155, s58, v155
    v_mfma_f32_32x32x16_bf16 v[176:191], a[152:155], a[128:131], v[176:191]
    v_mul_f32 v156, s58, v156
    v_mul_f32 v157, s58, v157
    v_mul_f32 v158, s58, v158
    v_mul_f32 v159, s58, v159
    v_cvt_pk_bf16_f32 v224, v144, v145
    v_cvt_pk_bf16_f32 v225, v146, v147
    v_mfma_f32_32x32x16_bf16 v[176:191], a[168:171], a[132:135], v[176:191]
    v_cvt_pk_bf16_f32 v226, v148, v149
    v_cvt_pk_bf16_f32 v227, v150, v151
    v_cvt_pk_bf16_f32 v228, v152, v153
    v_cvt_pk_bf16_f32 v229, v154, v155
    v_cvt_pk_bf16_f32 v230, v156, v157
    v_cvt_pk_bf16_f32 v231, v158, v159
    s_waitcnt lgkmcnt(6)
    v_mfma_f32_32x32x16_bf16 v[176:191], a[184:187], a[136:139], v[176:191]
    v_mul_f32 v160, s58, v160
    v_mul_f32 v161, s58, v161
    v_mul_f32 v162, s58, v162
    v_mul_f32 v163, s58, v163
    v_mul_f32 v164, s58, v164
    v_mul_f32 v165, s58, v165
    s_waitcnt lgkmcnt(4)
    v_mfma_f32_32x32x16_bf16 v[176:191], a[200:203], a[140:143], v[176:191]
    v_mul_f32 v166, s58, v166
    v_mul_f32 v167, s58, v167
    v_mul_f32 v168, s58, v168
    v_mul_f32 v169, s58, v169
    v_mul_f32 v170, s58, v170
    v_mul_f32 v171, s58, v171
    v_mfma_f32_32x32x16_bf16 v[192:207], a[156:159], a[128:131], v[192:207]
    v_mul_f32 v172, s58, v172
    v_mul_f32 v173, s58, v173
    v_mul_f32 v174, s58, v174
    v_mul_f32 v175, s58, v175
    v_cvt_pk_bf16_f32 v232, v160, v161
    v_cvt_pk_bf16_f32 v233, v162, v163
    v_mfma_f32_32x32x16_bf16 v[192:207], a[172:175], a[132:135], v[192:207]
    v_cvt_pk_bf16_f32 v234, v164, v165
    v_cvt_pk_bf16_f32 v235, v166, v167
    v_cvt_pk_bf16_f32 v236, v168, v169
    v_cvt_pk_bf16_f32 v237, v170, v171
    v_cvt_pk_bf16_f32 v238, v172, v173
    v_cvt_pk_bf16_f32 v239, v174, v175
    s_waitcnt lgkmcnt(2)
    v_mfma_f32_32x32x16_bf16 v[192:207], a[188:191], a[136:139], v[192:207]
    v_mul_f32 v176, s58, v176
    v_mul_f32 v177, s58, v177
    v_mul_f32 v178, s58, v178
    v_mul_f32 v179, s58, v179
    v_mul_f32 v180, s58, v180
    v_mul_f32 v181, s58, v181
    s_waitcnt lgkmcnt(0)
    v_mfma_f32_32x32x16_bf16 v[192:207], a[204:207], a[140:143], v[192:207]
    v_mul_f32 v182, s58, v182
    v_mul_f32 v183, s58, v183
    v_mul_f32 v184, s58, v184
    v_mul_f32 v185, s58, v185
    v_mul_f32 v186, s58, v186
    v_mul_f32 v187, s58, v187
    v_mfma_f32_32x32x16_bf16 v[80:95], a[0:3], v[224:227], 0
    v_mul_f32 v188, s58, v188
    v_mul_f32 v189, s58, v189
    v_mul_f32 v190, s58, v190
    v_mul_f32 v191, s58, v191
    v_cvt_pk_bf16_f32 v240, v176, v177
    v_cvt_pk_bf16_f32 v241, v178, v179
    v_mfma_f32_32x32x16_bf16 v[80:95], a[4:7], v[228:231], v[80:95]
    v_cvt_pk_bf16_f32 v242, v180, v181
    v_cvt_pk_bf16_f32 v243, v182, v183
    v_cvt_pk_bf16_f32 v244, v184, v185
    v_cvt_pk_bf16_f32 v245, v186, v187
    v_cvt_pk_bf16_f32 v246, v188, v189
    v_cvt_pk_bf16_f32 v247, v190, v191
    v_mfma_f32_32x32x16_bf16 v[80:95], a[8:11], v[232:235], v[80:95]
    v_mul_f32 v192, s58, v192
    v_mul_f32 v193, s58, v193
    v_mul_f32 v194, s58, v194
    v_mul_f32 v195, s58, v195
    v_mul_f32 v196, s58, v196
    v_mul_f32 v197, s58, v197
    v_mfma_f32_32x32x16_bf16 v[80:95], a[12:15], v[236:239], v[80:95]
    v_mul_f32 v198, s58, v198
    v_mul_f32 v199, s58, v199
    v_mul_f32 v200, s58, v200
    v_mul_f32 v201, s58, v201
    v_mul_f32 v202, s58, v202
    v_mul_f32 v203, s58, v203
    v_mfma_f32_32x32x16_bf16 v[80:95], a[16:19], v[240:243], v[80:95]
    v_mul_f32 v204, s58, v204
    v_mul_f32 v205, s58, v205
    v_mul_f32 v206, s58, v206
    v_mul_f32 v207, s58, v207
    v_cvt_pk_bf16_f32 v248, v192, v193
    v_cvt_pk_bf16_f32 v249, v194, v195
    v_mfma_f32_32x32x16_bf16 v[80:95], a[20:23], v[244:247], v[80:95]
    v_cvt_pk_bf16_f32 v250, v196, v197
    v_cvt_pk_bf16_f32 v251, v198, v199
    v_cvt_pk_bf16_f32 v252, v200, v201
    v_cvt_pk_bf16_f32 v253, v202, v203
    v_cvt_pk_bf16_f32 v254, v204, v205
    v_cvt_pk_bf16_f32 v255, v206, v207
    ds_read_b64_tr_b16 a[192:193], v40 offset:49152
    ds_read_b64_tr_b16 a[194:195], v40 offset:51200
    ds_read_b64_tr_b16 a[196:197], v41 offset:49152
    ds_read_b64_tr_b16 a[198:199], v41 offset:51200
    ds_read_b64_tr_b16 a[200:201], v42 offset:49152
    ds_read_b64_tr_b16 a[202:203], v42 offset:51200
    v_mfma_f32_32x32x16_bf16 v[80:95], a[24:27], v[248:251], v[80:95]
    ds_read_b64_tr_b16 a[204:205], v43 offset:49152
    ds_read_b64_tr_b16 a[206:207], v43 offset:51200
    ds_read_b64_tr_b16 a[208:209], v40 offset:53248
    ds_read_b64_tr_b16 a[210:211], v40 offset:55296
    ds_read_b64_tr_b16 a[212:213], v41 offset:53248
    v_mfma_f32_32x32x16_bf16 v[80:95], a[28:31], v[252:255], v[80:95]
    ds_read_b64_tr_b16 a[214:215], v41 offset:55296
    ds_read_b64_tr_b16 a[216:217], v42 offset:53248
    ds_read_b64_tr_b16 a[218:219], v42 offset:55296
    ds_read_b64_tr_b16 a[220:221], v43 offset:53248
    ds_read_b64_tr_b16 a[222:223], v43 offset:55296
    v_mfma_f32_32x32x16_bf16 v[96:111], a[32:35], v[224:227], 0
    v_mfma_f32_32x32x16_bf16 v[96:111], a[36:39], v[228:231], v[96:111]
    s_nop 4
    v_max3_f32 v68, v80, v81, v82
    v_max3_f32 v69, v83, v84, v85
    v_max3_f32 v68, v68, v86, v87
    v_max3_f32 v69, v69, v88, v89
    v_max3_f32 v68, v68, v90, v91
    v_max3_f32 v69, v69, v92, v93
    v_max3_f32 v68, v68, v94, v95
    v_max_f32 v68, v68, v69
    v_mov_b32 v69, v68
    s_nop 1
    v_permlane32_swap_b32 v68, v69
    v_mfma_f32_32x32x16_bf16 v[96:111], a[40:43], v[232:235], v[96:111]
    v_max_f32 v68, v68, v69
    v_sub_f32 v80, v80, v68
    v_sub_f32 v81, v81, v68
    v_sub_f32 v82, v82, v68
    v_sub_f32 v83, v83, v68
    v_sub_f32 v84, v84, v68
    v_sub_f32 v85, v85, v68
    v_sub_f32 v86, v86, v68
    v_sub_f32 v87, v87, v68
    v_sub_f32 v88, v88, v68
    v_mfma_f32_32x32x16_bf16 v[96:111], a[44:47], v[236:239], v[96:111]
    v_sub_f32 v89, v89, v68
    v_sub_f32 v90, v90, v68
    v_sub_f32 v91, v91, v68
    v_sub_f32 v92, v92, v68
    v_sub_f32 v93, v93, v68
    v_sub_f32 v94, v94, v68
    v_sub_f32 v95, v95, v68
    v_exp_f32 v80, v80
    v_exp_f32 v81, v81
    v_mfma_f32_32x32x16_bf16 v[96:111], a[48:51], v[240:243], v[96:111]
    v_exp_f32 v82, v82
    v_exp_f32 v83, v83
    v_cvt_pk_bf16_f32 v128, v80, v81
    v_exp_f32 v84, v84
    v_exp_f32 v85, v85
    v_cvt_pk_bf16_f32 v129, v82, v83
    v_exp_f32 v86, v86
    v_exp_f32 v87, v87
    v_cvt_pk_bf16_f32 v130, v84, v85
    v_exp_f32 v88, v88
    v_mfma_f32_32x32x16_bf16 v[96:111], a[52:55], v[244:247], v[96:111]
    v_exp_f32 v89, v89
    v_cvt_pk_bf16_f32 v131, v86, v87
    v_exp_f32 v90, v90
    v_exp_f32 v91, v91
    v_cvt_pk_bf16_f32 v132, v88, v89
    v_exp_f32 v92, v92
    v_exp_f32 v93, v93
    v_cvt_pk_bf16_f32 v133, v90, v91
    v_exp_f32 v94, v94
    v_mfma_f32_32x32x16_bf16 v[96:111], a[56:59], v[248:251], v[96:111]
    v_exp_f32 v95, v95
    v_cvt_pk_bf16_f32 v134, v92, v93
    v_cvt_pk_bf16_f32 v135, v94, v95
    v_sub_f32 v112, 0, v68
    v_sub_f32 v113, 0, v68
    v_sub_f32 v114, 0, v68
    v_sub_f32 v115, 0, v68
    v_sub_f32 v116, 0, v68
    v_sub_f32 v117, 0, v68
    v_sub_f32 v118, 0, v68
    v_mfma_f32_32x32x16_bf16 v[96:111], a[60:63], v[252:255], v[96:111]
    v_sub_f32 v119, 0, v68
    v_sub_f32 v120, 0, v68
    v_sub_f32 v121, 0, v68
    v_sub_f32 v122, 0, v68
    v_sub_f32 v123, 0, v68
    v_sub_f32 v124, 0, v68
    v_sub_f32 v125, 0, v68
    v_sub_f32 v126, 0, v68
    v_sub_f32 v127, 0, v68
    s_waitcnt vmcnt(63) lgkmcnt(0)
    s_barrier
    v_mfma_f32_32x32x16_bf16 v[144:159], a[192:195], v[128:131], 0
    s_add_u32 m0, s57, 131072
    s_nop 0
    buffer_load_dwordx4 v63, s[36:39], s54 offen lds
    buffer_load_dwordx4 v64, s[36:39], s54 offen offset:1024 lds
    ds_read_b128 a[0:3], v16 offset:57344
    v_mfma_f32_32x32x16_bf16 v[160:175], a[196:199], v[128:131], 0
    v_add_f32 v96, v96, v112
    v_add_f32 v97, v97, v112
    v_add_f32 v98, v98, v112
    v_add_f32 v99, v99, v112
    v_add_f32 v100, v100, v112
    v_add_f32 v101, v101, v112
    v_add_f32 v102, v102, v112
    v_add_f32 v103, v103, v112
    v_mfma_f32_32x32x16_bf16 v[176:191], a[200:203], v[128:131], 0
    v_add_f32 v104, v104, v112
    v_add_f32 v105, v105, v112
    v_add_f32 v106, v106, v112
    v_add_f32 v107, v107, v112
    v_add_f32 v108, v108, v112
    v_add_f32 v109, v109, v112
    v_add_f32 v110, v110, v112
    v_add_f32 v111, v111, v112
    v_mfma_f32_32x32x16_bf16 v[192:207], a[204:207], v[128:131], 0
    v_max3_f32 v68, v96, v97, v98
    v_max3_f32 v69, v99, v100, v101
    v_max3_f32 v68, v68, v102, v103
    v_max3_f32 v69, v69, v104, v105
    v_max3_f32 v68, v68, v106, v107
    v_max3_f32 v69, v69, v108, v109
    v_mfma_f32_16x16x32_bf16 v[208:211], a[240:243], v[128:131], 0
    v_max3_f32 v68, v68, v110, v111
    v_max_f32 v68, v68, v69
    v_mfma_f32_32x32x16_bf16 v[144:159], a[208:211], v[132:135], v[144:159]
    ds_read_b128 a[4:7], v17 offset:57344
    ds_read_b128 a[8:11], v18 offset:57344
    v_cmp_lt_f32 vcc, 0x41000000, v68
    s_cbranch_vccnz L_stubA1
L_backA1:
    ds_read_b128 a[12:15], v19 offset:57344
    ds_read_b128 a[16:19], v20 offset:57344
    v_mfma_f32_32x32x16_bf16 v[160:175], a[212:215], v[132:135], v[160:175]
    ds_read_b128 a[20:23], v21 offset:57344
    v_exp_f32 v96, v96
    v_exp_f32 v97, v97
    v_exp_f32 v98, v98
    v_mfma_f32_32x32x16_bf16 v[176:191], a[216:219], v[132:135], v[176:191]
    ds_read_b128 a[24:27], v22 offset:57344
    ds_read_b128 a[28:31], v23 offset:57344
    v_exp_f32 v99, v99
    v_cvt_pk_bf16_f32 v136, v96, v97
    v_exp_f32 v100, v100
    v_mfma_f32_32x32x16_bf16 v[192:207], a[220:223], v[132:135], v[192:207]
    v_exp_f32 v101, v101
    buffer_load_dwordx4 v65, s[36:39], s54 offen offset:2048 lds
    v_cvt_pk_bf16_f32 v137, v98, v99
    v_exp_f32 v102, v102
    v_mfma_f32_16x16x32_bf16 v[208:211], a[240:243], v[132:135], v[208:211]
    s_waitcnt lgkmcnt(0)
    ds_read_b64_tr_b16 a[32:33], v44 offset:0
    v_mfma_f32_32x32x16_bf16 v[80:95], a[0:3], v[224:227], v[112:127]
    buffer_load_dwordx4 v66, s[36:39], s54 offen offset:3072 lds
    ds_read_b64_tr_b16 a[34:35], v44 offset:2048
    v_exp_f32 v103, v103
    s_add_u32 m0, s57, 135168
    ds_read_b64_tr_b16 a[36:37], v45 offset:0
    v_mfma_f32_32x32x16_bf16 v[80:95], a[4:7], v[228:231], v[80:95]
    ds_read_b64_tr_b16 a[38:39], v45 offset:2048
    s_add_u32 s48, s54, 36864
    v_cvt_pk_bf16_f32 v138, v100, v101
    buffer_load_dwordx4 v63, s[36:39], s48 offen lds
    ds_read_b64_tr_b16 a[40:41], v46 offset:0
    ds_read_b64_tr_b16 a[42:43], v46 offset:2048
    v_mfma_f32_32x32x16_bf16 v[80:95], a[8:11], v[232:235], v[80:95]
    v_exp_f32 v104, v104
    buffer_load_dwordx4 v64, s[36:39], s48 offen offset:1024 lds
    ds_read_b64_tr_b16 a[44:45], v47 offset:0
    v_exp_f32 v105, v105
    v_mfma_f32_32x32x16_bf16 v[80:95], a[12:15], v[236:239], v[80:95]
    ds_read_b64_tr_b16 a[46:47], v47 offset:2048
    ds_read_b64_tr_b16 a[48:49], v44 offset:4096
    buffer_load_dwordx4 v65, s[36:39], s48 offen offset:2048 lds
    v_cvt_pk_bf16_f32 v139, v102, v103
    ds_read_b64_tr_b16 a[50:51], v44 offset:6144
    v_mfma_f32_32x32x16_bf16 v[80:95], a[16:19], v[240:243], v[80:95]
    ds_read_b64_tr_b16 a[52:53], v45 offset:4096
    ds_read_b64_tr_b16 a[54:55], v45 offset:6144
    buffer_load_dwordx4 v66, s[36:39], s48 offen offset:3072 lds
    v_exp_f32 v106, v106
    ds_read_b64_tr_b16 a[56:57], v46 offset:4096
    v_mfma_f32_32x32x16_bf16 v[80:95], a[20:23], v[244:247], v[80:95]
    ds_read_b64_tr_b16 a[58:59], v46 offset:6144
    ds_read_b64_tr_b16 a[60:61], v47 offset:4096
    ds_read_b64_tr_b16 a[62:63], v47 offset:6144
    s_add_u32 s54, s54, 128
    s_sub_u32 s49, s54, 1152
    s_cselect_b32 s54, s54, s49
    s_add_u32 m0, s56, 49152
    v_mfma_f32_32x32x16_bf16 v[80:95], a[24:27], v[248:251], v[80:95]
    buffer_load_dwordx4 v54, s[28:31], s70 offen nt lds
    buffer_load_dwordx4 v54, s[28:31], s70 offen offset:1024 nt lds
    v_exp_f32 v107, v107
    v_cvt_pk_bf16_f32 v140, v104, v105
    v_mfma_f32_32x32x16_bf16 v[80:95], a[28:31], v[252:255], v[80:95]
    v_exp_f32 v108, v108
    v_exp_f32 v109, v109
    v_cvt_pk_bf16_f32 v141, v106, v107
    v_exp_f32 v110, v110
    v_exp_f32 v111, v111
    v_cvt_pk_bf16_f32 v142, v108, v109
    v_cvt_pk_bf16_f32 v143, v110, v111
    s_waitcnt vmcnt(2) lgkmcnt(0)
    s_barrier
    v_mfma_f32_32x32x16_bf16 v[144:159], a[32:35], v[136:139], v[144:159]
    ds_read_b128 a[0:3], v24 offset:8192
    ds_read_b128 a[4:7], v25 offset:8192
    ds_read_b128 a[8:11], v26 offset:8192
    ds_read_b128 a[12:15], v27 offset:8192
    s_add_u32 m0, s56, 57344
    v_mfma_f32_32x32x16_bf16 v[160:175], a[36:39], v[136:139], v[160:175]
    v_max3_f32 v68, v80, v81, v82
    v_max3_f32 v69, v83, v84, v85
    v_max3_f32 v68, v68, v86, v87
    v_max3_f32 v69, v69, v88, v89
    v_max3_f32 v68, v68, v90, v91
    v_mfma_f32_32x32x16_bf16 v[176:191], a[40:43], v[136:139], v[176:191]
    v_max3_f32 v69, v69, v92, v93
    ds_read_b64_tr_b16 a[192:193], v44 offset:16384
    v_max3_f32 v68, v68, v94, v95
    ds_read_b64_tr_b16 a[194:195], v44 offset:18432
    v_max_f32 v68, v68, v69
    ds_read_b64_tr_b16 a[196:197], v45 offset:16384
    v_mfma_f32_32x32x16_bf16 v[192:207], a[44:47], v[136:139], v[192:207]
    v_cmp_lt_f32 vcc, 0x41000000, v68
    s_cbranch_vccnz L_stubA2
L_backA2:
    ds_read_b64_tr_b16 a[198:199], v45 offset:18432
    v_exp_f32 v80, v80
    ds_read_b64_tr_b16 a[200:201], v46 offset:16384
    v_mfma_f32_16x16x32_bf16 v[208:211], a[240:243], v[136:139], v[208:211]
    ds_read_b64_tr_b16 a[202:203], v46 offset:18432
    v_mfma_f32_32x32x16_bf16 v[144:159], a[48:51], v[140:143], v[144:159]
    v_exp_f32 v81, v81
    ds_read_b64_tr_b16 a[204:205], v47 offset:16384
    v_exp_f32 v82, v82
    ds_read_b64_tr_b16 a[206:207], v47 offset:18432
    v_mfma_f32_32x32x16_bf16 v[160:175], a[52:55], v[140:143], v[160:175]
    ds_read_b128 a[16:19], v28 offset:8192
    ds_read_b128 a[20:23], v29 offset:8192
    ds_read_b64_tr_b16 a[208:209], v44 offset:20480
    v_exp_f32 v83, v83
    v_mfma_f32_32x32x16_bf16 v[176:191], a[56:59], v[140:143], v[176:191]
    ds_read_b128 a[24:27], v30 offset:8192
    ds_read_b128 a[28:31], v31 offset:8192
    ds_read_b64_tr_b16 a[210:211], v44 offset:22528
    ds_read_b64_tr_b16 a[212:213], v45 offset:20480
    v_cvt_pk_bf16_f32 v128, v80, v81
    v_mfma_f32_32x32x16_bf16 v[192:207], a[60:63], v[140:143], v[192:207]
    ds_read_b64_tr_b16 a[214:215], v45 offset:22528
    ds_read_b64_tr_b16 a[216:217], v46 offset:20480
    v_exp_f32 v84, v84
    ds_read_b64_tr_b16 a[218:219], v46 offset:22528
    ds_read_b64_tr_b16 a[220:221], v47 offset:20480
    v_mfma_f32_16x16x32_bf16 v[208:211], a[240:243], v[140:143], v[208:211]
    s_waitcnt lgkmcnt(6)
    ds_read_b64_tr_b16 a[222:223], v47 offset:22528
    v_mfma_f32_32x32x16_bf16 v[96:111], a[0:3], v[224:227], v[112:127]
    v_exp_f32 v85, v85
    v_cvt_pk_bf16_f32 v129, v82, v83
    ds_read_b64_tr_b16 a[64:65], v59 offset:0
    v_exp_f32 v86, v86
    v_mfma_f32_32x32x16_bf16 v[96:111], a[4:7], v[228:231], v[96:111]
    ds_read_b64_tr_b16 a[66:67], v59 offset:1024
    ds_read_b64_tr_b16 a[68:69], v59 offset:2048
    v_exp_f32 v87, v87
    ds_read_b64_tr_b16 a[70:71], v59 offset:3072
    v_cvt_pk_bf16_f32 v130, v84, v85
    v_mfma_f32_32x32x16_bf16 v[96:111], a[8:11], v[232:235], v[96:111]
    ds_read_b64_tr_b16 a[72:73], v59 offset:4096
    ds_read_b64_tr_b16 a[74:75], v59 offset:5120
    v_exp_f32 v88, v88
    ds_read_b64_tr_b16 a[76:77], v59 offset:6144
    ds_read_b64_tr_b16 a[78:79], v59 offset:7168
    v_mfma_f32_32x32x16_bf16 v[96:111], a[12:15], v[236:239], v[96:111]
    v_exp_f32 v89, v89
    ds_read_b64_tr_b16 a[80:81], v59 offset:8192
    v_cvt_pk_bf16_f32 v131, v86, v87
    ds_read_b64_tr_b16 a[82:83], v59 offset:9216
    v_mfma_f32_32x32x16_bf16 v[96:111], a[16:19], v[240:243], v[96:111]
    ds_read_b64_tr_b16 a[84:85], v59 offset:10240
    ds_read_b64_tr_b16 a[86:87], v59 offset:11264
    v_exp_f32 v90, v90
    ds_read_b64_tr_b16 a[88:89], v59 offset:12288
    ds_read_b64_tr_b16 a[90:91], v59 offset:13312
    v_mfma_f32_32x32x16_bf16 v[96:111], a[20:23], v[244:247], v[96:111]
    ds_read_b64_tr_b16 a[92:93], v59 offset:14336
    ds_read_b64_tr_b16 a[94:95], v59 offset:15360
    v_exp_f32 v91, v91
    v_cvt_pk_bf16_f32 v132, v88, v89
    v_mfma_f32_32x32x16_bf16 v[96:111], a[24:27], v[248:251], v[96:111]
    buffer_load_dwordx4 v52, s[24:27], s72 offen nt lds
    buffer_load_dwordx4 v53, s[24:27], s72 offen offset:1024 nt lds
    v_exp_f32 v92, v92
    v_mfma_f32_32x32x16_bf16 v[96:111], a[28:31], v[252:255], v[96:111]
    v_exp_f32 v93, v93
    v_cvt_pk_bf16_f32 v133, v90, v91
    v_exp_f32 v94, v94
    v_exp_f32 v95, v95
    v_cvt_pk_bf16_f32 v134, v92, v93
    v_cvt_pk_bf16_f32 v135, v94, v95
    s_waitcnt vmcnt(63) lgkmcnt(0)
    s_barrier
    v_mfma_f32_32x32x16_bf16 v[144:159], a[192:195], v[128:131], v[144:159]
    ds_read_b128 a[0:3], v24 offset:24576
    ds_read_b128 a[4:7], v25 offset:24576
    ds_read_b128 a[8:11], v26 offset:24576
    ds_read_b128 a[12:15], v27 offset:24576
    s_add_u32 m0, s56, 65536
    v_mfma_f32_32x32x16_bf16 v[160:175], a[196:199], v[128:131], v[160:175]
    v_max3_f32 v68, v96, v97, v98
    v_max3_f32 v69, v99, v100, v101
    v_max3_f32 v68, v68, v102, v103
    v_max3_f32 v69, v69, v104, v105
    v_max3_f32 v68, v68, v106, v107
    v_mfma_f32_32x32x16_bf16 v[176:191], a[200:203], v[128:131], v[176:191]
    v_max3_f32 v69, v69, v108, v109
    ds_read_b64_tr_b16 a[32:33], v40 offset:0
    v_max3_f32 v68, v68, v110, v111
    ds_read_b64_tr_b16 a[34:35], v40 offset:2048
    v_max_f32 v68, v68, v69
    ds_read_b64_tr_b16 a[36:37], v41 offset:0
    v_mfma_f32_32x32x16_bf16 v[192:207], a[204:207], v[128:131], v[192:207]
    v_cmp_lt_f32 vcc, 0x41000000, v68
    s_cbranch_vccnz L_stubA3
L_backA3:
    ds_read_b64_tr_b16 a[38:39], v41 offset:2048
    v_exp_f32 v96, v96
    ds_read_b64_tr_b16 a[40:41], v42 offset:0
    v_mfma_f32_16x16x32_bf16 v[208:211], a[240:243], v[128:131], v[208:211]
    ds_read_b64_tr_b16 a[42:43], v42 offset:2048
    v_mfma_f32_32x32x16_bf16 v[144:159], a[208:211], v[132:135], v[144:159]
    v_exp_f32 v97, v97
    ds_read_b64_tr_b16 a[44:45], v43 offset:0
    v_exp_f32 v98, v98
    ds_read_b64_tr_b16 a[46:47], v43 offset:2048
    v_mfma_f32_32x32x16_bf16 v[160:175], a[212:215], v[132:135], v[160:175]
    ds_read_b128 a[16:19], v28 offset:24576
    ds_read_b128 a[20:23], v29 offset:24576
    ds_read_b64_tr_b16 a[48:49], v40 offset:4096
    v_exp_f32 v99, v99
    v_mfma_f32_32x32x16_bf16 v[176:191], a[216:219], v[132:135], v[176:191]
    ds_read_b128 a[24:27], v30 offset:24576
    ds_read_b128 a[28:31], v31 offset:24576
    ds_read_b64_tr_b16 a[50:51], v40 offset:6144
    ds_read_b64_tr_b16 a[52:53], v41 offset:4096
    v_cvt_pk_bf16_f32 v136, v96, v97
    v_mfma_f32_32x32x16_bf16 v[192:207], a[220:223], v[132:135], v[192:207]
    ds_read_b64_tr_b16 a[54:55], v41 offset:6144
    ds_read_b64_tr_b16 a[56:57], v42 offset:4096
    v_exp_f32 v100, v100
    ds_read_b64_tr_b16 a[58:59], v42 offset:6144
    ds_read_b64_tr_b16 a[60:61], v43 offset:4096
    v_mfma_f32_16x16x32_bf16 v[208:211], a[240:243], v[132:135], v[208:211]
    s_waitcnt lgkmcnt(6)
    ds_read_b64_tr_b16 a[62:63], v43 offset:6144
    v_mfma_f32_32x32x16_bf16 v[80:95], a[0:3], v[224:227], v[112:127]
    v_exp_f32 v101, v101
    v_cvt_pk_bf16_f32 v137, v98, v99
    ds_read_b64_tr_b16 a[96:97], v60 offset:0
    v_exp_f32 v102, v102
    v_mfma_f32_32x32x16_bf16 v[80:95], a[4:7], v[228:231], v[80:95]
    ds_read_b64_tr_b16 a[98:99], v60 offset:1024
    ds_read_b64_tr_b16 a[100:101], v60 offset:2048
    v_exp_f32 v103, v103
    ds_read_b64_tr_b16 a[102:103], v60 offset:3072
    v_cvt_pk_bf16_f32 v138, v100, v101
    v_mfma_f32_32x32x16_bf16 v[80:95], a[8:11], v[232:235], v[80:95]
    ds_read_b64_tr_b16 a[104:105], v60 offset:4096
    ds_read_b64_tr_b16 a[106:107], v60 offset:5120
    v_exp_f32 v104, v104
    ds_read_b64_tr_b16 a[108:109], v60 offset:6144
    ds_read_b64_tr_b16 a[110:111], v60 offset:7168
    v_mfma_f32_32x32x16_bf16 v[80:95], a[12:15], v[236:239], v[80:95]
    v_exp_f32 v105, v105
    ds_read_b64_tr_b16 a[112:113], v60 offset:8192
    v_cvt_pk_bf16_f32 v139, v102, v103
    ds_read_b64_tr_b16 a[114:115], v60 offset:9216
    v_mfma_f32_32x32x16_bf16 v[80:95], a[16:19], v[240:243], v[80:95]
    ds_read_b64_tr_b16 a[116:117], v60 offset:10240
    ds_read_b64_tr_b16 a[118:119], v60 offset:11264
    v_exp_f32 v106, v106
    ds_read_b64_tr_b16 a[120:121], v60 offset:12288
    ds_read_b64_tr_b16 a[122:123], v60 offset:13312
    v_mfma_f32_32x32x16_bf16 v[80:95], a[20:23], v[244:247], v[80:95]
    ds_read_b64_tr_b16 a[124:125], v60 offset:14336
    ds_read_b64_tr_b16 a[126:127], v60 offset:15360
    v_exp_f32 v107, v107
    v_cvt_pk_bf16_f32 v140, v104, v105
    v_mfma_f32_32x32x16_bf16 v[80:95], a[24:27], v[248:251], v[80:95]
    buffer_load_dwordx4 v54, s[28:31], s71 offen nt lds
    buffer_load_dwordx4 v54, s[28:31], s71 offen offset:1024 nt lds
    v_exp_f32 v108, v108
    v_mfma_f32_32x32x16_bf16 v[80:95], a[28:31], v[252:255], v[80:95]
    v_exp_f32 v109, v109
    v_cvt_pk_bf16_f32 v141, v106, v107
    v_exp_f32 v110, v110
    v_exp_f32 v111, v111
    v_cvt_pk_bf16_f32 v142, v108, v109
    v_cvt_pk_bf16_f32 v143, v110, v111
    s_waitcnt vmcnt(63) lgkmcnt(0)
    s_barrier
    v_mfma_f32_32x32x16_bf16 v[144:159], a[32:35], v[136:139], v[144:159]
    s_add_u32 m0, s57, 131072
    s_nop 0
    buffer_load_dwordx4 v63, s[36:39], s54 offen lds
    buffer_load_dwordx4 v64, s[36:39], s54 offen offset:1024 lds
    ds_read_b128 a[0:3], v16 offset:8192
    v_mfma_f32_32x32x16_bf16 v[160:175], a[36:39], v[136:139], v[160:175]
    v_max3_f32 v68, v80, v81, v82
    v_max3_f32 v69, v83, v84, v85
    v_max3_f32 v68, v68, v86, v87
    v_max3_f32 v69, v69, v88, v89
    v_max3_f32 v68, v68, v90, v91
    v_mfma_f32_32x32x16_bf16 v[176:191], a[40:43], v[136:139], v[176:191]
    v_max3_f32 v69, v69, v92, v93
    v_max3_f32 v68, v68, v94, v95
    v_max_f32 v68, v68, v69
    v_cmp_lt_f32 vcc, 0x41000000, v68
    s_cbranch_vccnz L_stubA4
L_backA4:
    ds_read_b128 a[4:7], v17 offset:8192
    v_mfma_f32_32x32x16_bf16 v[192:207], a[44:47], v[136:139], v[192:207]
    v_exp_f32 v80, v80
    v_exp_f32 v81, v81
    v_exp_f32 v82, v82
    ds_read_b128 a[8:11], v18 offset:8192
    v_mfma_f32_16x16x32_bf16 v[208:211], a[240:243], v[136:139], v[208:211]
    v_exp_f32 v83, v83
    v_mfma_f32_32x32x16_bf16 v[144:159], a[48:51], v[140:143], v[144:159]
    ds_read_b128 a[12:15], v19 offset:8192
    ds_read_b128 a[16:19], v20 offset:8192
    v_cvt_pk_bf16_f32 v128, v80, v81
    v_exp_f32 v84, v84
    ds_read_b64_tr_b16 a[192:193], v40 offset:16384
    v_mfma_f32_32x32x16_bf16 v[160:175], a[52:55], v[140:143], v[160:175]
    ds_read_b128 a[20:23], v21 offset:8192
    ds_read_b128 a[24:27], v22 offset:8192
    v_exp_f32 v85, v85
    v_cvt_pk_bf16_f32 v129, v82, v83
    v_mfma_f32_32x32x16_bf16 v[176:191], a[56:59], v[140:143], v[176:191]
    ds_read_b128 a[28:31], v23 offset:8192
    buffer_load_dwordx4 v65, s[36:39], s54 offen offset:2048 lds
    v_exp_f32 v86, v86
    ds_read_b64_tr_b16 a[194:195], v40 offset:18432
    v_mfma_f32_32x32x16_bf16 v[192:207], a[60:63], v[140:143], v[192:207]
    buffer_load_dwordx4 v66, s[36:39], s54 offen offset:3072 lds
    v_exp_f32 v87, v87
    s_add_u32 m0, s57, 135168
    v_cvt_pk_bf16_f32 v130, v84, v85
    v_mfma_f32_16x16x32_bf16 v[208:211], a[240:243], v[140:143], v[208:211]
    s_waitcnt lgkmcnt(1)
    ds_read_b64_tr_b16 a[196:197], v41 offset:16384
    v_mfma_f32_32x32x16_bf16 v[96:111], a[0:3], v[224:227], v[112:127]
    s_add_u32 s48, s54, 36864
    ds_read_b64_tr_b16 a[198:199], v41 offset:18432
    buffer_load_dwordx4 v63, s[36:39], s48 offen lds
    v_exp_f32 v88, v88
    v_mfma_f32_32x32x16_bf16 v[96:111], a[4:7], v[228:231], v[96:111]
    ds_read_b64_tr_b16 a[200:201], v42 offset:16384
    ds_read_b64_tr_b16 a[202:203], v42 offset:18432
    v_exp_f32 v89, v89
    buffer_load_dwordx4 v64, s[36:39], s48 offen offset:1024 lds
    v_mfma_f32_32x32x16_bf16 v[96:111], a[8:11], v[232:235], v[96:111]
    ds_read_b64_tr_b16 a[204:205], v43 offset:16384
    ds_read_b64_tr_b16 a[206:207], v43 offset:18432
    v_cvt_pk_bf16_f32 v131, v86, v87
    buffer_load_dwordx4 v65, s[36:39], s48 offen offset:2048 lds
    ds_read_b64_tr_b16 a[208:209], v40 offset:20480
    v_mfma_f32_32x32x16_bf16 v[96:111], a[12:15], v[236:239], v[96:111]
    ds_read_b64_tr_b16 a[210:211], v40 offset:22528
    v_exp_f32 v90, v90
    buffer_load_dwordx4 v66, s[36:39], s48 offen offset:3072 lds
    ds_read_b64_tr_b16 a[212:213], v41 offset:20480
    v_mfma_f32_32x32x16_bf16 v[96:111], a[16:19], v[240:243], v[96:111]
    ds_read_b64_tr_b16 a[214:215], v41 offset:22528
    ds_read_b64_tr_b16 a[216:217], v42 offset:20480
    v_exp_f32 v91, v91
    s_add_u32 s54, s54, 128
    v_cvt_pk_bf16_f32 v132, v88, v89
    v_mfma_f32_32x32x16_bf16 v[96:111], a[20:23], v[244:247], v[96:111]
    ds_read_b64_tr_b16 a[218:219], v42 offset:22528
    ds_read_b64_tr_b16 a[220:221], v43 offset:20480
    ds_read_b64_tr_b16 a[222:223], v43 offset:22528
    s_sub_u32 s49, s54, 1152
    s_cselect_b32 s54, s54, s49
    s_add_u32 m0, s56, 73728
    v_mfma_f32_32x32x16_bf16 v[96:111], a[24:27], v[248:251], v[96:111]
    buffer_load_dwordx4 v52, s[24:27], s73 offen nt lds
    buffer_load_dwordx4 v53, s[24:27], s73 offen offset:1024 nt lds
    v_exp_f32 v92, v92
    v_mfma_f32_32x32x16_bf16 v[96:111], a[28:31], v[252:255], v[96:111]
    v_exp_f32 v93, v93
    v_cvt_pk_bf16_f32 v133, v90, v91
    v_exp_f32 v94, v94
    v_exp_f32 v95, v95
    v_cvt_pk_bf16_f32 v134, v92, v93
    v_cvt_pk_bf16_f32 v135, v94, v95
    s_waitcnt vmcnt(63) lgkmcnt(0)
    s_barrier
    v_mfma_f32_32x32x16_bf16 v[144:159], a[192:195], v[128:131], v[144:159]
    ds_read_b128 a[0:3], v16 offset:24576
    ds_read_b128 a[4:7], v17 offset:24576
    ds_read_b128 a[8:11], v18 offset:24576
    ds_read_b128 a[12:15], v19 offset:24576
    v_mfma_f32_32x32x16_bf16 v[160:175], a[196:199], v[128:131], v[160:175]
    v_max3_f32 v68, v96, v97, v98
    v_max3_f32 v69, v99, v100, v101
    v_max3_f32 v68, v68, v102, v103
    v_max3_f32 v69, v69, v104, v105
    v_max3_f32 v68, v68, v106, v107
    v_mfma_f32_32x32x16_bf16 v[176:191], a[200:203], v[128:131], v[176:191]
    v_max3_f32 v69, v69, v108, v109
    v_max3_f32 v68, v68, v110, v111
    v_max_f32 v68, v68, v69
    v_cmp_lt_f32 vcc, 0x41000000, v68
    s_cbranch_vccnz L_stubA5
L_backA5:
    v_mfma_f32_32x32x16_bf16 v[192:207], a[204:207], v[128:131], v[192:207]
    v_exp_f32 v96, v96
    v_exp_f32 v97, v97
    v_exp_f32 v98, v98
    v_mfma_f32_16x16x32_bf16 v[208:211], a[240:243], v[128:131], v[208:211]
    v_exp_f32 v99, v99
    v_mfma_f32_32x32x16_bf16 v[144:159], a[208:211], v[132:135], v[144:159]
    ds_read_b128 a[16:19], v20 offset:24576
    v_cvt_pk_bf16_f32 v136, v96, v97
    v_exp_f32 v100, v100
    ds_read_b128 a[20:23], v21 offset:24576
    v_mfma_f32_32x32x16_bf16 v[160:175], a[212:215], v[132:135], v[160:175]
    ds_read_b128 a[24:27], v22 offset:24576
    v_exp_f32 v101, v101
    v_cvt_pk_bf16_f32 v137, v98, v99
    ds_read_b64_tr_b16 a[32:33], v44 offset:32768
    v_mfma_f32_32x32x16_bf16 v[176:191], a[216:219], v[132:135], v[176:191]
    ds_read_b128 a[28:31], v23 offset:24576
    v_exp_f32 v102, v102
    v_exp_f32 v103, v103
    v_mfma_f32_32x32x16_bf16 v[192:207], a[220:223], v[132:135], v[192:207]
    ds_read_b64_tr_b16 a[34:35], v44 offset:34816
    v_cvt_pk_bf16_f32 v138, v100, v101
    ds_read_b64_tr_b16 a[36:37], v45 offset:32768
    v_exp_f32 v104, v104
    v_mfma_f32_16x16x32_bf16 v[208:211], a[240:243], v[132:135], v[208:211]
    s_waitcnt lgkmcnt(2)
    ds_read_b64_tr_b16 a[38:39], v45 offset:34816
    v_mfma_f32_32x32x16_bf16 v[80:95], a[0:3], v[224:227], v[112:127]
    ds_read_b64_tr_b16 a[40:41], v46 offset:32768
    v_exp_f32 v105, v105
    ds_read_b64_tr_b16 a[42:43], v46 offset:34816
    v_cvt_pk_bf16_f32 v139, v102, v103
    v_mfma_f32_32x32x16_bf16 v[80:95], a[4:7], v[228:231], v[80:95]
    ds_read_b64_tr_b16 a[44:45], v47 offset:32768
    v_exp_f32 v106, v106
    ds_read_b64_tr_b16 a[46:47], v47 offset:34816
    ds_read_b64_tr_b16 a[48:49], v44 offset:36864
    v_mfma_f32_32x32x16_bf16 v[80:95], a[8:11], v[232:235], v[80:95]
    v_exp_f32 v107, v107
    s_add_u32 m0, s56, 81920
    ds_read_b64_tr_b16 a[50:51], v44 offset:38912
    v_cvt_pk_bf16_f32 v140, v104, v105
    v_mfma_f32_32x32x16_bf16 v[80:95], a[12:15], v[236:239], v[80:95]
    ds_read_b64_tr_b16 a[52:53], v45 offset:36864
    buffer_load_dwordx4 v54, s[28:31], s72 offen nt lds
    ds_read_b64_tr_b16 a[54:55], v45 offset:38912
    ds_read_b64_tr_b16 a[56:57], v46 offset:36864
    v_mfma_f32_32x32x16_bf16 v[80:95], a[16:19], v[240:243], v[80:95]
    buffer_load_dwordx4 v54, s[28:31], s72 offen offset:1024 nt lds
    v_exp_f32 v108, v108
    ds_read_b64_tr_b16 a[58:59], v46 offset:38912
    v_mfma_f32_32x32x16_bf16 v[80:95], a[20:23], v[244:247], v[80:95]
    ds_read_b64_tr_b16 a[60:61], v47 offset:36864
    ds_read_b64_tr_b16 a[62:63], v47 offset:38912
    s_add_u32 m0, s56, 90112
    s_nop 0
    buffer_load_dwordx4 v52, s[24:27], s74 offen nt lds
    v_mfma_f32_32x32x16_bf16 v[80:95], a[24:27], v[248:251], v[80:95]
    buffer_load_dwordx4 v53, s[24:27], s74 offen offset:1024 nt lds
    v_exp_f32 v109, v109
    v_cvt_pk_bf16_f32 v141, v106, v107
    v_mfma_f32_32x32x16_bf16 v[80:95], a[28:31], v[252:255], v[80:95]
    v_exp_f32 v110, v110
    v_exp_f32 v111, v111
    v_cvt_pk_bf16_f32 v142, v108, v109
    v_cvt_pk_bf16_f32 v143, v110, v111
    s_waitcnt vmcnt(6) lgkmcnt(0)
    s_barrier
    v_mfma_f32_32x32x16_bf16 v[144:159], a[32:35], v[136:139], v[144:159]
    ds_read_b128 a[0:3], v24 offset:40960
    ds_read_b128 a[4:7], v25 offset:40960
    ds_read_b128 a[8:11], v26 offset:40960
    ds_read_b128 a[12:15], v27 offset:40960
    ds_read_b128 a[16:19], v28 offset:40960
    v_mfma_f32_32x32x16_bf16 v[160:175], a[36:39], v[136:139], v[160:175]
    v_max3_f32 v68, v80, v81, v82
    v_max3_f32 v69, v83, v84, v85
    v_max3_f32 v68, v68, v86, v87
    v_max3_f32 v69, v69, v88, v89
    v_max3_f32 v68, v68, v90, v91
    s_add_u32 m0, s56, 0
    v_mfma_f32_32x32x16_bf16 v[176:191], a[40:43], v[136:139], v[176:191]
    v_max3_f32 v69, v69, v92, v93
    ds_read_b64_tr_b16 a[192:193], v40 offset:49152
    v_max3_f32 v68, v68, v94, v95
    ds_read_b64_tr_b16 a[194:195], v40 offset:51200
    v_max_f32 v68, v68, v69
    v_mfma_f32_32x32x16_bf16 v[192:207], a[44:47], v[136:139], v[192:207]
    ds_read_b64_tr_b16 a[196:197], v41 offset:49152
    v_cmp_lt_f32 vcc, 0x41000000, v68
    s_cbranch_vccnz L_stubA6
L_backA6:
    ds_read_b64_tr_b16 a[198:199], v41 offset:51200
    v_exp_f32 v80, v80
    v_mfma_f32_16x16x32_bf16 v[208:211], a[240:243], v[136:139], v[208:211]
    ds_read_b64_tr_b16 a[200:201], v42 offset:49152
    ds_read_b64_tr_b16 a[202:203], v42 offset:51200
    v_mfma_f32_32x32x16_bf16 v[144:159], a[48:51], v[140:143], v[144:159]
    v_exp_f32 v81, v81
    ds_read_b64_tr_b16 a[204:205], v43 offset:49152
    v_exp_f32 v82, v82
    ds_read_b64_tr_b16 a[206:207], v43 offset:51200
    v_mfma_f32_32x32x16_bf16 v[160:175], a[52:55], v[140:143], v[160:175]
    ds_read_b128 a[20:23], v29 offset:40960
    ds_read_b64_tr_b16 a[208:209], v40 offset:53248
    v_exp_f32 v83, v83
    ds_read_b64_tr_b16 a[210:211], v40 offset:55296
    ds_read_b64_tr_b16 a[212:213], v41 offset:53248
    v_mfma_f32_32x32x16_bf16 v[176:191], a[56:59], v[140:143], v[176:191]
    ds_read_b128 a[24:27], v30 offset:40960
    ds_read_b128 a[28:31], v31 offset:40960
    v_cvt_pk_bf16_f32 v128, v80, v81
    ds_read_b64_tr_b16 a[214:215], v41 offset:55296
    v_exp_f32 v84, v84
    v_mfma_f32_32x32x16_bf16 v[192:207], a[60:63], v[140:143], v[192:207]
    ds_read_b64_tr_b16 a[216:217], v42 offset:53248
    ds_read_b64_tr_b16 a[218:219], v42 offset:55296
    v_exp_f32 v85, v85
    ds_read_b64_tr_b16 a[220:221], v43 offset:53248
    v_cvt_pk_bf16_f32 v129, v82, v83
    v_mfma_f32_16x16x32_bf16 v[208:211], a[240:243], v[140:143], v[208:211]
    s_waitcnt lgkmcnt(4)
    ds_read_b64_tr_b16 a[222:223], v43 offset:55296
    v_mfma_f32_32x32x16_bf16 v[96:111], a[0:3], v[224:227], v[112:127]
    ds_read_b64_tr_b16 a[128:129], v59 offset:0
    v_exp_f32 v86, v86
    ds_read_b64_tr_b16 a[130:131], v59 offset:1024
    v_exp_f32 v87, v87
    v_mfma_f32_32x32x16_bf16 v[96:111], a[4:7], v[228:231], v[96:111]
    ds_read_b64_tr_b16 a[132:133], v59 offset:2048
    ds_read_b64_tr_b16 a[134:135], v59 offset:3072
    v_cvt_pk_bf16_f32 v130, v84, v85
    ds_read_b64_tr_b16 a[136:137], v59 offset:4096
    v_exp_f32 v88, v88
    v_mfma_f32_32x32x16_bf16 v[96:111], a[8:11], v[232:235], v[96:111]
    ds_read_b64_tr_b16 a[138:139], v59 offset:5120
    ds_read_b64_tr_b16 a[140:141], v59 offset:6144
    v_exp_f32 v89, v89
    ds_read_b64_tr_b16 a[142:143], v59 offset:7168
    v_cvt_pk_bf16_f32 v131, v86, v87
    v_mfma_f32_32x32x16_bf16 v[96:111], a[12:15], v[236:239], v[96:111]
    ds_read_b64_tr_b16 a[144:145], v59 offset:8192
    ds_read_b64_tr_b16 a[146:147], v59 offset:9216
    v_exp_f32 v90, v90
    ds_read_b64_tr_b16 a[148:149], v59 offset:10240
    ds_read_b64_tr_b16 a[150:151], v59 offset:11264
    v_mfma_f32_32x32x16_bf16 v[96:111], a[16:19], v[240:243], v[96:111]
    buffer_load_dwordx4 v54, s[28:31], s73 offen nt lds
    ds_read_b64_tr_b16 a[152:153], v59 offset:12288
    v_exp_f32 v91, v91
    v_cvt_pk_bf16_f32 v132, v88, v89
    v_mfma_f32_32x32x16_bf16 v[96:111], a[20:23], v[244:247], v[96:111]
    ds_read_b64_tr_b16 a[154:155], v59 offset:13312
    ds_read_b64_tr_b16 a[156:157], v59 offset:14336
    ds_read_b64_tr_b16 a[158:159], v59 offset:15360
    buffer_load_dwordx4 v54, s[28:31], s73 offen offset:1024 nt lds
    s_add_u32 m0, s56, 8192
    v_mfma_f32_32x32x16_bf16 v[96:111], a[24:27], v[248:251], v[96:111]
    buffer_load_dwordx4 v52, s[24:27], s75 offen nt lds
    buffer_load_dwordx4 v53, s[24:27], s75 offen offset:1024 nt lds
    v_exp_f32 v92, v92
    v_mfma_f32_32x32x16_bf16 v[96:111], a[28:31], v[252:255], v[96:111]
    v_exp_f32 v93, v93
    v_cvt_pk_bf16_f32 v133, v90, v91
    v_exp_f32 v94, v94
    v_exp_f32 v95, v95
    v_cvt_pk_bf16_f32 v134, v92, v93
    v_cvt_pk_bf16_f32 v135, v94, v95
    s_waitcnt vmcnt(18) lgkmcnt(0)
    s_barrier
    v_mfma_f32_32x32x16_bf16 v[144:159], a[192:195], v[128:131], v[144:159]
    ds_read_b128 a[0:3], v16 offset:57344
    ds_read_b128 a[4:7], v17 offset:57344
    ds_read_b128 a[8:11], v18 offset:57344
    ds_read_b128 a[12:15], v19 offset:57344
    s_add_u32 m0, s56, 16384
    v_mfma_f32_32x32x16_bf16 v[160:175], a[196:199], v[128:131], v[160:175]
    v_max3_f32 v68, v96, v97, v98
    v_max3_f32 v69, v99, v100, v101
    v_max3_f32 v68, v68, v102, v103
    v_max3_f32 v69, v69, v104, v105
    v_max3_f32 v68, v68, v106, v107
    v_max3_f32 v69, v69, v108, v109
    v_mfma_f32_32x32x16_bf16 v[176:191], a[200:203], v[128:131], v[176:191]
    ds_read_b64_tr_b16 a[32:33], v44 offset:0
    v_max3_f32 v68, v68, v110, v111
    ds_read_b64_tr_b16 a[34:35], v44 offset:2048
    v_max_f32 v68, v68, v69
    v_cmp_lt_f32 vcc, 0x41000000, v68
    s_cbranch_vccnz L_stubA7
L_backA7:
    v_mfma_f32_32x32x16_bf16 v[192:207], a[204:207], v[128:131], v[192:207]
    ds_read_b64_tr_b16 a[36:37], v45 offset:0
    ds_read_b64_tr_b16 a[38:39], v45 offset:2048
    v_exp_f32 v96, v96
    ds_read_b64_tr_b16 a[40:41], v46 offset:0
    ds_read_b64_tr_b16 a[42:43], v46 offset:2048
    v_mfma_f32_16x16x32_bf16 v[208:211], a[240:243], v[128:131], v[208:211]
    v_exp_f32 v97, v97
    v_mfma_f32_32x32x16_bf16 v[144:159], a[208:211], v[132:135], v[144:159]
    ds_read_b64_tr_b16 a[44:45], v47 offset:0
    v_exp_f32 v98, v98
    ds_read_b64_tr_b16 a[46:47], v47 offset:2048
    ds_read_b64_tr_b16 a[48:49], v44 offset:4096
    v_exp_f32 v99, v99
    v_mfma_f32_32x32x16_bf16 v[160:175], a[212:215], v[132:135], v[160:175]
    ds_read_b128 a[16:19], v20 offset:57344
    ds_read_b128 a[20:23], v21 offset:57344
    ds_read_b64_tr_b16 a[50:51], v44 offset:6144
    ds_read_b64_tr_b16 a[52:53], v45 offset:4096
    v_cvt_pk_bf16_f32 v136, v96, v97
    v_mfma_f32_32x32x16_bf16 v[176:191], a[216:219], v[132:135], v[176:191]
    ds_read_b128 a[24:27], v22 offset:57344
    ds_read_b128 a[28:31], v23 offset:57344
    ds_read_b64_tr_b16 a[54:55], v45 offset:6144
    v_exp_f32 v100, v100
    ds_read_b64_tr_b16 a[56:57], v46 offset:4096
    v_mfma_f32_32x32x16_bf16 v[192:207], a[220:223], v[132:135], v[192:207]
    ds_read_b64_tr_b16 a[58:59], v46 offset:6144
    v_exp_f32 v101, v101
    ds_read_b64_tr_b16 a[60:61], v47 offset:4096
    v_cvt_pk_bf16_f32 v137, v98, v99
    ds_read_b64_tr_b16 a[62:63], v47 offset:6144
    v_mfma_f32_16x16x32_bf16 v[208:211], a[240:243], v[132:135], v[208:211]
    s_waitcnt lgkmcnt(5)
    ds_read_b64_tr_b16 a[160:161], v60 offset:0
    v_mfma_f32_32x32x16_bf16 v[80:95], a[0:3], v[224:227], v[112:127]
    v_exp_f32 v102, v102
    ds_read_b64_tr_b16 a[162:163], v60 offset:1024
    v_exp_f32 v103, v103
    ds_read_b64_tr_b16 a[164:165], v60 offset:2048
    v_cvt_pk_bf16_f32 v138, v100, v101
    v_mfma_f32_32x32x16_bf16 v[80:95], a[4:7], v[228:231], v[80:95]
    ds_read_b64_tr_b16 a[166:167], v60 offset:3072
    ds_read_b64_tr_b16 a[168:169], v60 offset:4096
    v_exp_f32 v104, v104
    ds_read_b64_tr_b16 a[170:171], v60 offset:5120
    ds_read_b64_tr_b16 a[172:173], v60 offset:6144
    v_mfma_f32_32x32x16_bf16 v[80:95], a[8:11], v[232:235], v[80:95]
    v_exp_f32 v105, v105
    ds_read_b64_tr_b16 a[174:175], v60 offset:7168
    v_cvt_pk_bf16_f32 v139, v102, v103
    buffer_load_dwordx4 v54, s[28:31], s74 offen nt lds
    v_mfma_f32_32x32x16_bf16 v[80:95], a[12:15], v[236:239], v[80:95]
    ds_read_b64_tr_b16 a[176:177], v60 offset:8192
    ds_read_b64_tr_b16 a[178:179], v60 offset:9216
    v_exp_f32 v106, v106
    buffer_load_dwordx4 v54, s[28:31], s74 offen offset:1024 nt lds
    v_mfma_f32_32x32x16_bf16 v[80:95], a[16:19], v[240:243], v[80:95]
    ds_read_b64_tr_b16 a[180:181], v60 offset:10240
    ds_read_b64_tr_b16 a[182:183], v60 offset:11264
    ds_read_b64_tr_b16 a[184:185], v60 offset:12288
    v_exp_f32 v107, v107
    s_add_u32 m0, s56, 24576
    v_mfma_f32_32x32x16_bf16 v[80:95], a[20:23], v[244:247], v[80:95]
    ds_read_b64_tr_b16 a[186:187], v60 offset:13312
    ds_read_b64_tr_b16 a[188:189], v60 offset:14336
    ds_read_b64_tr_b16 a[190:191], v60 offset:15360
    buffer_load_dwordx4 v52, s[24:27], s76 offen nt lds
    v_cvt_pk_bf16_f32 v140, v104, v105
    v_mfma_f32_32x32x16_bf16 v[80:95], a[24:27], v[248:251], v[80:95]
    buffer_load_dwordx4 v53, s[24:27], s76 offen offset:1024 nt lds
    v_mov_b32 v1, 0
    buffer_load_dwordx2 v[74:75], v1, s[92:95], 0 offen sc1
    v_mfma_f32_32x32x16_bf16 v[80:95], a[28:31], v[252:255], v[80:95]
    v_exp_f32 v108, v108
    v_exp_f32 v109, v109
    v_cvt_pk_bf16_f32 v141, v106, v107
    v_exp_f32 v110, v110
    v_exp_f32 v111, v111
    v_cvt_pk_bf16_f32 v142, v108, v109
    v_cvt_pk_bf16_f32 v143, v110, v111
    s_waitcnt vmcnt(11) lgkmcnt(0)
    s_barrier
    v_mfma_f32_32x32x16_bf16 v[144:159], a[32:35], v[136:139], v[144:159]
    ds_read_b128 a[0:3], v24 offset:8192
    ds_read_b128 a[4:7], v25 offset:8192
    ds_read_b128 a[8:11], v26 offset:8192
    ds_read_b128 a[12:15], v27 offset:8192
    v_mfma_f32_32x32x16_bf16 v[160:175], a[36:39], v[136:139], v[160:175]
    v_max3_f32 v68, v80, v81, v82
    v_max3_f32 v69, v83, v84, v85
    v_max3_f32 v68, v68, v86, v87
    v_max3_f32 v69, v69, v88, v89
    v_max3_f32 v68, v68, v90, v91
    v_mfma_f32_32x32x16_bf16 v[176:191], a[40:43], v[136:139], v[176:191]
    v_max3_f32 v69, v69, v92, v93
    v_max3_f32 v68, v68, v94, v95
    v_max_f32 v68, v68, v69
    v_cmp_lt_f32 vcc, 0x41000000, v68
    s_cbranch_vccnz L_stubA8
L_backA8:
    v_mfma_f32_32x32x16_bf16 v[192:207], a[44:47], v[136:139], v[192:207]
    v_exp_f32 v80, v80
    v_exp_f32 v81, v81
    v_exp_f32 v82, v82
    v_mfma_f32_16x16x32_bf16 v[208:211], a[240:243], v[136:139], v[208:211]
    v_exp_f32 v83, v83
    v_mfma_f32_32x32x16_bf16 v[144:159], a[48:51], v[140:143], v[144:159]
    ds_read_b128 a[16:19], v28 offset:8192
    v_cvt_pk_bf16_f32 v128, v80, v81
    v_exp_f32 v84, v84
    ds_read_b128 a[20:23], v29 offset:8192
    v_mfma_f32_32x32x16_bf16 v[160:175], a[52:55], v[140:143], v[160:175]
    ds_read_b128 a[24:27], v30 offset:8192
    v_exp_f32 v85, v85
    v_cvt_pk_bf16_f32 v129, v82, v83
    ds_read_b64_tr_b16 a[192:193], v44 offset:16384
    v_mfma_f32_32x32x16_bf16 v[176:191], a[56:59], v[140:143], v[176:191]
    ds_read_b128 a[28:31], v31 offset:8192
    v_exp_f32 v86, v86
    v_exp_f32 v87, v87
    v_mfma_f32_32x32x16_bf16 v[192:207], a[60:63], v[140:143], v[192:207]
    ds_read_b64_tr_b16 a[194:195], v44 offset:18432
    v_cvt_pk_bf16_f32 v130, v84, v85
    ds_read_b64_tr_b16 a[196:197], v45 offset:16384
    v_exp_f32 v88, v88
    v_mfma_f32_16x16x32_bf16 v[208:211], a[240:243], v[140:143], v[208:211]
    s_waitcnt lgkmcnt(2)
    ds_read_b64_tr_b16 a[198:199], v45 offset:18432
    v_mfma_f32_32x32x16_bf16 v[96:111], a[0:3], v[224:227], v[112:127]
    ds_read_b64_tr_b16 a[200:201], v46 offset:16384
    v_exp_f32 v89, v89
    ds_read_b64_tr_b16 a[202:203], v46 offset:18432
    v_cvt_pk_bf16_f32 v131, v86, v87
    v_mfma_f32_32x32x16_bf16 v[96:111], a[4:7], v[228:231], v[96:111]
    ds_read_b64_tr_b16 a[204:205], v47 offset:16384
    v_exp_f32 v90, v90
    ds_read_b64_tr_b16 a[206:207], v47 offset:18432
    ds_read_b64_tr_b16 a[208:209], v44 offset:20480
    v_mfma_f32_32x32x16_bf16 v[96:111], a[8:11], v[232:235], v[96:111]
    v_exp_f32 v91, v91
    s_add_u32 m0, s56, 32768
    ds_read_b64_tr_b16 a[210:211], v44 offset:22528
    v_cvt_pk_bf16_f32 v132, v88, v89
    v_mfma_f32_32x32x16_bf16 v[96:111], a[12:15], v[236:239], v[96:111]
    ds_read_b64_tr_b16 a[212:213], v45 offset:20480
    buffer_load_dwordx4 v54, s[28:31], s75 offen nt lds
    ds_read_b64_tr_b16 a[214:215], v45 offset:22528
    ds_read_b64_tr_b16 a[216:217], v46 offset:20480
    v_mfma_f32_32x32x16_bf16 v[96:111], a[16:19], v[240:243], v[96:111]
    buffer_load_dwordx4 v54, s[28:31], s75 offen offset:1024 nt lds
    v_exp_f32 v92, v92
    ds_read_b64_tr_b16 a[218:219], v46 offset:22528
    v_mfma_f32_32x32x16_bf16 v[96:111], a[20:23], v[244:247], v[96:111]
    ds_read_b64_tr_b16 a[220:221], v47 offset:20480
    ds_read_b64_tr_b16 a[222:223], v47 offset:22528
    s_add_u32 m0, s56, 40960
    s_nop 0
    buffer_load_dwordx4 v52, s[24:27], s77 offen nt lds
    v_mfma_f32_32x32x16_bf16 v[96:111], a[24:27], v[248:251], v[96:111]
    buffer_load_dwordx4 v53, s[24:27], s77 offen offset:1024 nt lds
    v_exp_f32 v93, v93
    v_cvt_pk_bf16_f32 v133, v90, v91
    v_mfma_f32_32x32x16_bf16 v[96:111], a[28:31], v[252:255], v[96:111]
    v_exp_f32 v94, v94
    v_exp_f32 v95, v95
    v_cvt_pk_bf16_f32 v134, v92, v93
    v_cvt_pk_bf16_f32 v135, v94, v95
    s_waitcnt vmcnt(11) lgkmcnt(0)
    s_barrier
    v_mfma_f32_32x32x16_bf16 v[144:159], a[192:195], v[128:131], v[144:159]
    ds_read_b128 a[0:3], v24 offset:24576
    ds_read_b128 a[4:7], v25 offset:24576
    ds_read_b128 a[8:11], v26 offset:24576
    ds_read_b128 a[12:15], v27 offset:24576
    v_mfma_f32_32x32x16_bf16 v[160:175], a[196:199], v[128:131], v[160:175]
    v_max3_f32 v68, v96, v97, v98
    v_max3_f32 v69, v99, v100, v101
    v_max3_f32 v68, v68, v102, v103
    v_max3_f32 v69, v69, v104, v105
    v_max3_f32 v68, v68, v106, v107
    v_mfma_f32_32x32x16_bf16 v[176:191], a[200:203], v[128:131], v[176:191]
    v_max3_f32 v69, v69, v108, v109
    v_max3_f32 v68, v68, v110, v111
    v_max_f32 v68, v68, v69
    v_cmp_lt_f32 vcc, 0x41000000, v68
    s_cbranch_vccnz L_stubA9
L_backA9:
    v_mfma_f32_32x32x16_bf16 v[192:207], a[204:207], v[128:131], v[192:207]
    v_exp_f32 v96, v96
    v_exp_f32 v97, v97
    v_exp_f32 v98, v98
    v_mfma_f32_16x16x32_bf16 v[208:211], a[240:243], v[128:131], v[208:211]
    v_exp_f32 v99, v99
    v_mfma_f32_32x32x16_bf16 v[144:159], a[208:211], v[132:135], v[144:159]
    ds_read_b128 a[16:19], v28 offset:24576
    v_cvt_pk_bf16_f32 v136, v96, v97
    v_exp_f32 v100, v100
    ds_read_b128 a[20:23], v29 offset:24576
    v_mfma_f32_32x32x16_bf16 v[160:175], a[212:215], v[132:135], v[160:175]
    ds_read_b128 a[24:27], v30 offset:24576
    v_exp_f32 v101, v101
    v_cvt_pk_bf16_f32 v137, v98, v99
    ds_read_b64_tr_b16 a[32:33], v40 offset:0
    v_mfma_f32_32x32x16_bf16 v[176:191], a[216:219], v[132:135], v[176:191]
    ds_read_b128 a[28:31], v31 offset:24576
    v_exp_f32 v102, v102
    v_exp_f32 v103, v103
    v_mfma_f32_32x32x16_bf16 v[192:207], a[220:223], v[132:135], v[192:207]
    ds_read_b64_tr_b16 a[34:35], v40 offset:2048
    v_cvt_pk_bf16_f32 v138, v100, v101
    ds_read_b64_tr_b16 a[36:37], v41 offset:0
    v_exp_f32 v104, v104
    v_mfma_f32_16x16x32_bf16 v[208:211], a[240:243], v[132:135], v[208:211]
    s_waitcnt lgkmcnt(2)
    ds_read_b64_tr_b16 a[38:39], v41 offset:2048
    v_mfma_f32_32x32x16_bf16 v[80:95], a[0:3], v[224:227], v[112:127]
    ds_read_b64_tr_b16 a[40:41], v42 offset:0
    v_exp_f32 v105, v105
    ds_read_b64_tr_b16 a[42:43], v42 offset:2048
    v_cvt_pk_bf16_f32 v139, v102, v103
    v_mfma_f32_32x32x16_bf16 v[80:95], a[4:7], v[228:231], v[80:95]
    ds_read_b64_tr_b16 a[44:45], v43 offset:0
    v_exp_f32 v106, v106
    ds_read_b64_tr_b16 a[46:47], v43 offset:2048
    ds_read_b64_tr_b16 a[48:49], v40 offset:4096
    v_mfma_f32_32x32x16_bf16 v[80:95], a[8:11], v[232:235], v[80:95]
    v_exp_f32 v107, v107
    s_add_u32 m0, s56, 49152
    ds_read_b64_tr_b16 a[50:51], v40 offset:6144
    v_cvt_pk_bf16_f32 v140, v104, v105
    v_mfma_f32_32x32x16_bf16 v[80:95], a[12:15], v[236:239], v[80:95]
    ds_read_b64_tr_b16 a[52:53], v41 offset:4096
    buffer_load_dwordx4 v54, s[28:31], s76 offen nt lds
    ds_read_b64_tr_b16 a[54:55], v41 offset:6144
    ds_read_b64_tr_b16 a[56:57], v42 offset:4096
    v_mfma_f32_32x32x16_bf16 v[80:95], a[16:19], v[240:243], v[80:95]
    buffer_load_dwordx4 v54, s[28:31], s76 offen offset:1024 nt lds
    v_exp_f32 v108, v108
    ds_read_b64_tr_b16 a[58:59], v42 offset:6144
    v_mfma_f32_32x32x16_bf16 v[80:95], a[20:23], v[244:247], v[80:95]
    ds_read_b64_tr_b16 a[60:61], v43 offset:4096
    ds_read_b64_tr_b16 a[62:63], v43 offset:6144
    s_add_u32 m0, s56, 57344
    s_nop 0
    buffer_load_dwordx4 v52, s[24:27], s78 offen nt lds
    v_mfma_f32_32x32x16_bf16 v[80:95], a[24:27], v[248:251], v[80:95]
    buffer_load_dwordx4 v53, s[24:27], s78 offen offset:1024 nt lds
    v_exp_f32 v109, v109
    v_cvt_pk_bf16_f32 v141, v106, v107
    v_mfma_f32_32x32x16_bf16 v[80:95], a[28:31], v[252:255], v[80:95]
    v_exp_f32 v110, v110
    v_exp_f32 v111, v111
    v_cvt_pk_bf16_f32 v142, v108, v109
    v_cvt_pk_bf16_f32 v143, v110, v111
    s_waitcnt vmcnt(11) lgkmcnt(0)
    s_barrier
    v_mfma_f32_32x32x16_bf16 v[144:159], a[32:35], v[136:139], v[144:159]
    ds_read_b128 a[0:3], v16 offset:8192
    ds_read_b128 a[4:7], v17 offset:8192
    ds_read_b128 a[8:11], v18 offset:8192
    ds_read_b128 a[12:15], v19 offset:8192
    v_mfma_f32_32x32x16_bf16 v[160:175], a[36:39], v[136:139], v[160:175]
    v_max3_f32 v68, v80, v81, v82
    v_max3_f32 v69, v83, v84, v85
    v_max3_f32 v68, v68, v86, v87
    v_max3_f32 v69, v69, v88, v89
    v_max3_f32 v68, v68, v90, v91
    v_mfma_f32_32x32x16_bf16 v[176:191], a[40:43], v[136:139], v[176:191]
    v_max3_f32 v69, v69, v92, v93
    v_max3_f32 v68, v68, v94, v95
    v_max_f32 v68, v68, v69
    v_cmp_lt_f32 vcc, 0x41000000, v68
    s_cbranch_vccnz L_stubA10
L_backA10:
    v_mfma_f32_32x32x16_bf16 v[192:207], a[44:47], v[136:139], v[192:207]
    v_exp_f32 v80, v80
    v_exp_f32 v81, v81
    v_exp_f32 v82, v82
    v_mfma_f32_16x16x32_bf16 v[208:211], a[240:243], v[136:139], v[208:211]
    v_exp_f32 v83, v83
    v_mfma_f32_32x32x16_bf16 v[144:159], a[48:51], v[140:143], v[144:159]
    ds_read_b128 a[16:19], v20 offset:8192
    v_cvt_pk_bf16_f32 v128, v80, v81
    v_exp_f32 v84, v84
    ds_read_b128 a[20:23], v21 offset:8192
    v_mfma_f32_32x32x16_bf16 v[160:175], a[52:55], v[140:143], v[160:175]
    ds_read_b128 a[24:27], v22 offset:8192
    v_exp_f32 v85, v85
    v_cvt_pk_bf16_f32 v129, v82, v83
    ds_read_b64_tr_b16 a[192:193], v40 offset:16384
    v_mfma_f32_32x32x16_bf16 v[176:191], a[56:59], v[140:143], v[176:191]
    ds_read_b128 a[28:31], v23 offset:8192
    v_exp_f32 v86, v86
    v_exp_f32 v87, v87
    v_mfma_f32_32x32x16_bf16 v[192:207], a[60:63], v[140:143], v[192:207]
    ds_read_b64_tr_b16 a[194:195], v40 offset:18432
    v_cvt_pk_bf16_f32 v130, v84, v85
    ds_read_b64_tr_b16 a[196:197], v41 offset:16384
    v_exp_f32 v88, v88
    v_mfma_f32_16x16x32_bf16 v[208:211], a[240:243], v[140:143], v[208:211]
    s_waitcnt lgkmcnt(2)
    ds_read_b64_tr_b16 a[198:199], v41 offset:18432
    v_mfma_f32_32x32x16_bf16 v[96:111], a[0:3], v[224:227], v[112:127]
    ds_read_b64_tr_b16 a[200:201], v42 offset:16384
    v_exp_f32 v89, v89
    ds_read_b64_tr_b16 a[202:203], v42 offset:18432
    v_cvt_pk_bf16_f32 v131, v86, v87
    v_mfma_f32_32x32x16_bf16 v[96:111], a[4:7], v[228:231], v[96:111]
    ds_read_b64_tr_b16 a[204:205], v43 offset:16384
    v_exp_f32 v90, v90
    ds_read_b64_tr_b16 a[206:207], v43 offset:18432
    ds_read_b64_tr_b16 a[208:209], v40 offset:20480
    v_mfma_f32_32x32x16_bf16 v[96:111], a[8:11], v[232:235], v[96:111]
    v_exp_f32 v91, v91
    s_add_u32 m0, s56, 65536
    ds_read_b64_tr_b16 a[210:211], v40 offset:22528
    v_cvt_pk_bf16_f32 v132, v88, v89
    v_mfma_f32_32x32x16_bf16 v[96:111], a[12:15], v[236:239], v[96:111]
    ds_read_b64_tr_b16 a[212:213], v41 offset:20480
    buffer_load_dwordx4 v54, s[28:31], s77 offen nt lds
    ds_read_b64_tr_b16 a[214:215], v41 offset:22528
    ds_read_b64_tr_b16 a[216:217], v42 offset:20480
    v_mfma_f32_32x32x16_bf16 v[96:111], a[16:19], v[240:243], v[96:111]
    buffer_load_dwordx4 v54, s[28:31], s77 offen offset:1024 nt lds
    v_exp_f32 v92, v92
    ds_read_b64_tr_b16 a[218:219], v42 offset:22528
    v_mfma_f32_32x32x16_bf16 v[96:111], a[20:23], v[244:247], v[96:111]
    ds_read_b64_tr_b16 a[220:221], v43 offset:20480
    ds_read_b64_tr_b16 a[222:223], v43 offset:22528
    s_add_u32 m0, s56, 73728
    s_nop 0
    buffer_load_dwordx4 v52, s[24:27], s79 offen nt lds
    v_mfma_f32_32x32x16_bf16 v[96:111], a[24:27], v[248:251], v[96:111]
    buffer_load_dwordx4 v53, s[24:27], s79 offen offset:1024 nt lds
    v_exp_f32 v93, v93
    v_cvt_pk_bf16_f32 v133, v90, v91
    v_mfma_f32_32x32x16_bf16 v[96:111], a[28:31], v[252:255], v[96:111]
    v_exp_f32 v94, v94
    v_exp_f32 v95, v95
    v_cvt_pk_bf16_f32 v134, v92, v93
    v_cvt_pk_bf16_f32 v135, v94, v95
    s_waitcnt vmcnt(10) lgkmcnt(0)
    s_barrier
    v_mfma_f32_32x32x16_bf16 v[144:159], a[192:195], v[128:131], v[144:159]
    ds_read_b128 a[0:3], v16 offset:24576
    ds_read_b128 a[4:7], v17 offset:24576
    ds_read_b128 a[8:11], v18 offset:24576
    ds_read_b128 a[12:15], v19 offset:24576
    v_mfma_f32_32x32x16_bf16 v[160:175], a[196:199], v[128:131], v[160:175]
    v_max3_f32 v68, v96, v97, v98
    v_max3_f32 v69, v99, v100, v101
    v_max3_f32 v68, v68, v102, v103
    v_max3_f32 v69, v69, v104, v105
    v_max3_f32 v68, v68, v106, v107
    v_mfma_f32_32x32x16_bf16 v[176:191], a[200:203], v[128:131], v[176:191]
    v_max3_f32 v69, v69, v108, v109
    v_max3_f32 v68, v68, v110, v111
    v_max_f32 v68, v68, v69
    v_cmp_lt_f32 vcc, 0x41000000, v68
    s_cbranch_vccnz L_stubA11
L_backA11:
    v_mfma_f32_32x32x16_bf16 v[192:207], a[204:207], v[128:131], v[192:207]
    v_exp_f32 v96, v96
    v_exp_f32 v97, v97
    v_exp_f32 v98, v98
    v_mfma_f32_16x16x32_bf16 v[208:211], a[240:243], v[128:131], v[208:211]
    v_exp_f32 v99, v99
    v_mfma_f32_32x32x16_bf16 v[144:159], a[208:211], v[132:135], v[144:159]
    ds_read_b128 a[16:19], v20 offset:24576
    v_cvt_pk_bf16_f32 v136, v96, v97
    v_exp_f32 v100, v100
    ds_read_b128 a[20:23], v21 offset:24576
    v_mfma_f32_32x32x16_bf16 v[160:175], a[212:215], v[132:135], v[160:175]
    ds_read_b128 a[24:27], v22 offset:24576
    v_exp_f32 v101, v101
    v_cvt_pk_bf16_f32 v137, v98, v99
    ds_read_b64_tr_b16 a[32:33], v40 offset:32768
    v_mfma_f32_32x32x16_bf16 v[176:191], a[216:219], v[132:135], v[176:191]
    ds_read_b128 a[28:31], v23 offset:24576
    v_exp_f32 v102, v102
    v_exp_f32 v103, v103
    v_mfma_f32_32x32x16_bf16 v[192:207], a[220:223], v[132:135], v[192:207]
    ds_read_b64_tr_b16 a[34:35], v40 offset:34816
    v_cvt_pk_bf16_f32 v138, v100, v101
    ds_read_b64_tr_b16 a[36:37], v41 offset:32768
    v_exp_f32 v104, v104
    v_mfma_f32_16x16x32_bf16 v[208:211], a[240:243], v[132:135], v[208:211]
    s_waitcnt lgkmcnt(2)
    ds_read_b64_tr_b16 a[38:39], v41 offset:34816
    v_mfma_f32_32x32x16_bf16 v[80:95], a[0:3], v[224:227], v[112:127]
    ds_read_b64_tr_b16 a[40:41], v42 offset:32768
    v_exp_f32 v105, v105
    ds_read_b64_tr_b16 a[42:43], v42 offset:34816
    v_cvt_pk_bf16_f32 v139, v102, v103
    v_mfma_f32_32x32x16_bf16 v[80:95], a[4:7], v[228:231], v[80:95]
    ds_read_b64_tr_b16 a[44:45], v43 offset:32768
    v_exp_f32 v106, v106
    ds_read_b64_tr_b16 a[46:47], v43 offset:34816
    ds_read_b64_tr_b16 a[48:49], v40 offset:36864
    v_mfma_f32_32x32x16_bf16 v[80:95], a[8:11], v[232:235], v[80:95]
    v_exp_f32 v107, v107
    s_add_u32 m0, s56, 81920
    ds_read_b64_tr_b16 a[50:51], v40 offset:38912
    v_cvt_pk_bf16_f32 v140, v104, v105
    v_mfma_f32_32x32x16_bf16 v[80:95], a[12:15], v[236:239], v[80:95]
    ds_read_b64_tr_b16 a[52:53], v41 offset:36864
    buffer_load_dwordx4 v54, s[28:31], s78 offen nt lds
    ds_read_b64_tr_b16 a[54:55], v41 offset:38912
    ds_read_b64_tr_b16 a[56:57], v42 offset:36864
    v_mfma_f32_32x32x16_bf16 v[80:95], a[16:19], v[240:243], v[80:95]
    buffer_load_dwordx4 v54, s[28:31], s78 offen offset:1024 nt lds
    v_exp_f32 v108, v108
    ds_read_b64_tr_b16 a[58:59], v42 offset:38912
    v_mfma_f32_32x32x16_bf16 v[80:95], a[20:23], v[244:247], v[80:95]
    ds_read_b64_tr_b16 a[60:61], v43 offset:36864
    ds_read_b64_tr_b16 a[62:63], v43 offset:38912
    s_add_u32 m0, s56, 90112
    s_nop 0
    buffer_load_dwordx4 v54, s[28:31], s79 offen nt lds
    v_mfma_f32_32x32x16_bf16 v[80:95], a[24:27], v[248:251], v[80:95]
    buffer_load_dwordx4 v54, s[28:31], s79 offen offset:1024 nt lds
    v_exp_f32 v109, v109
    v_cvt_pk_bf16_f32 v141, v106, v107
    v_mfma_f32_32x32x16_bf16 v[80:95], a[28:31], v[252:255], v[80:95]
    v_exp_f32 v110, v110
    v_exp_f32 v111, v111
    v_cvt_pk_bf16_f32 v142, v108, v109
    v_cvt_pk_bf16_f32 v143, v110, v111
    s_waitcnt vmcnt(10) lgkmcnt(0)
    s_barrier
    v_mfma_f32_32x32x16_bf16 v[144:159], a[32:35], v[136:139], v[144:159]
    ds_read_b128 a[0:3], v16 offset:40960
    s_add_u32 m0, s57, 98304
    s_nop 0
    buffer_load_dwordx4 v63, s[36:39], s54 offen lds
    ds_read_b128 a[4:7], v17 offset:40960
    v_mfma_f32_32x32x16_bf16 v[160:175], a[36:39], v[136:139], v[160:175]
    v_max3_f32 v68, v80, v81, v82
    v_max3_f32 v69, v83, v84, v85
    v_max3_f32 v68, v68, v86, v87
    v_max3_f32 v69, v69, v88, v89
    v_max3_f32 v68, v68, v90, v91
    v_mfma_f32_32x32x16_bf16 v[176:191], a[40:43], v[136:139], v[176:191]
    v_max3_f32 v69, v69, v92, v93
    v_max3_f32 v68, v68, v94, v95
    v_max_f32 v68, v68, v69
    v_cmp_lt_f32 vcc, 0x41000000, v68
    s_cbranch_vccnz L_stubA12
L_backA12:
    ds_read_b128 a[8:11], v18 offset:40960
    v_mfma_f32_32x32x16_bf16 v[192:207], a[44:47], v[136:139], v[192:207]
    v_exp_f32 v80, v80
    v_exp_f32 v81, v81
    v_exp_f32 v82, v82
    v_mfma_f32_16x16x32_bf16 v[208:211], a[240:243], v[136:139], v[208:211]
    v_exp_f32 v83, v83
    v_mfma_f32_32x32x16_bf16 v[144:159], a[48:51], v[140:143], v[144:159]
    ds_read_b128 a[12:15], v19 offset:40960
    ds_read_b128 a[16:19], v20 offset:40960
    v_cvt_pk_bf16_f32 v128, v80, v81
    v_exp_f32 v84, v84
    v_mfma_f32_32x32x16_bf16 v[160:175], a[52:55], v[140:143], v[160:175]
    ds_read_b128 a[20:23], v21 offset:40960
    ds_read_b128 a[24:27], v22 offset:40960
    v_exp_f32 v85, v85
    v_cvt_pk_bf16_f32 v129, v82, v83
    v_mfma_f32_32x32x16_bf16 v[176:191], a[56:59], v[140:143], v[176:191]
    ds_read_b128 a[28:31], v23 offset:40960
    v_exp_f32 v86, v86
    v_exp_f32 v87, v87
    ds_read_b64_tr_b16 a[192:193], v40 offset:49152
    v_mfma_f32_32x32x16_bf16 v[192:207], a[60:63], v[140:143], v[192:207]
    buffer_load_dwordx4 v64, s[36:39], s54 offen offset:1024 lds
    ds_read_b64_tr_b16 a[194:195], v40 offset:51200
    v_cvt_pk_bf16_f32 v130, v84, v85
    ds_read_b64_tr_b16 a[196:197], v41 offset:49152
    v_mfma_f32_16x16x32_bf16 v[208:211], a[240:243], v[140:143], v[208:211]
    s_waitcnt lgkmcnt(3)
    ds_read_b64_tr_b16 a[198:199], v41 offset:51200
    v_mfma_f32_32x32x16_bf16 v[96:111], a[0:3], v[224:227], v[112:127]
    buffer_load_dwordx4 v65, s[36:39], s54 offen offset:2048 lds
    v_exp_f32 v88, v88
    ds_read_b64_tr_b16 a[200:201], v42 offset:49152
    ds_read_b64_tr_b16 a[202:203], v42 offset:51200
    v_mfma_f32_32x32x16_bf16 v[96:111], a[4:7], v[228:231], v[96:111]
    buffer_load_dwordx4 v66, s[36:39], s54 offen offset:3072 lds
    v_exp_f32 v89, v89
    ds_read_b64_tr_b16 a[204:205], v43 offset:49152
    s_add_u32 m0, s57, 102400
    v_mfma_f32_32x32x16_bf16 v[96:111], a[8:11], v[232:235], v[96:111]
    ds_read_b64_tr_b16 a[206:207], v43 offset:51200
    v_cvt_pk_bf16_f32 v131, v86, v87
    s_add_u32 s48, s54, 36864
    v_exp_f32 v90, v90
    ds_read_b64_tr_b16 a[208:209], v40 offset:53248
    v_mfma_f32_32x32x16_bf16 v[96:111], a[12:15], v[236:239], v[96:111]
    buffer_load_dwordx4 v63, s[36:39], s48 offen lds
    ds_read_b64_tr_b16 a[210:211], v40 offset:55296
    ds_read_b64_tr_b16 a[212:213], v41 offset:53248
    v_exp_f32 v91, v91
    v_mfma_f32_32x32x16_bf16 v[96:111], a[16:19], v[240:243], v[96:111]
    ds_read_b64_tr_b16 a[214:215], v41 offset:55296
    buffer_load_dwordx4 v64, s[36:39], s48 offen offset:1024 lds
    ds_read_b64_tr_b16 a[216:217], v42 offset:53248
    v_cvt_pk_bf16_f32 v132, v88, v89
    v_mfma_f32_32x32x16_bf16 v[96:111], a[20:23], v[244:247], v[96:111]
    ds_read_b64_tr_b16 a[218:219], v42 offset:55296
    ds_read_b64_tr_b16 a[220:221], v43 offset:53248
    ds_read_b64_tr_b16 a[222:223], v43 offset:55296
    buffer_load_dwordx4 v65, s[36:39], s48 offen offset:2048 lds
    v_mfma_f32_32x32x16_bf16 v[96:111], a[24:27], v[248:251], v[96:111]
    buffer_load_dwordx4 v66, s[36:39], s48 offen offset:3072 lds
    s_add_u32 s54, s54, 128
    s_sub_u32 s49, s54, 1152
    s_cselect_b32 s54, s54, s49
    v_mfma_f32_32x32x16_bf16 v[96:111], a[28:31], v[252:255], v[96:111]
    v_exp_f32 v92, v92
    v_exp_f32 v93, v93
    v_cvt_pk_bf16_f32 v133, v90, v91
    v_exp_f32 v94, v94
    v_exp_f32 v95, v95
    v_cvt_pk_bf16_f32 v134, v92, v93
    v_cvt_pk_bf16_f32 v135, v94, v95
    s_waitcnt vmcnt(14) lgkmcnt(0)
    s_barrier
    v_mfma_f32_32x32x16_bf16 v[144:159], a[192:195], v[128:131], v[144:159]
    ds_read_b128 a[0:3], v16 offset:57344
    s_add_u32 m0, s57, 131072
    s_nop 0
    buffer_load_dwordx4 v63, s[36:39], s54 offen lds
    ds_read_b128 a[4:7], v17 offset:57344
    v_mfma_f32_32x32x16_bf16 v[160:175], a[196:199], v[128:131], v[160:175]
    v_max3_f32 v68, v96, v97, v98
    v_max3_f32 v69, v99, v100, v101
    v_max3_f32 v68, v68, v102, v103
    v_max3_f32 v69, v69, v104, v105
    v_max3_f32 v68, v68, v106, v107
    v_mfma_f32_32x32x16_bf16 v[176:191], a[200:203], v[128:131], v[176:191]
    v_max3_f32 v69, v69, v108, v109
    v_max3_f32 v68, v68, v110, v111
    v_max_f32 v68, v68, v69
    v_cmp_lt_f32 vcc, 0x41000000, v68
    s_cbranch_vccnz L_stubA13
L_backA13:
    ds_read_b128 a[8:11], v18 offset:57344
    v_mfma_f32_32x32x16_bf16 v[192:207], a[204:207], v[128:131], v[192:207]
    v_exp_f32 v96, v96
    v_exp_f32 v97, v97
    v_exp_f32 v98, v98
    v_mfma_f32_16x16x32_bf16 v[208:211], a[240:243], v[128:131], v[208:211]
    v_exp_f32 v99, v99
    v_mfma_f32_32x32x16_bf16 v[144:159], a[208:211], v[132:135], v[144:159]
    ds_read_b128 a[12:15], v19 offset:57344
    ds_read_b128 a[16:19], v20 offset:57344
    v_cvt_pk_bf16_f32 v136, v96, v97
    v_exp_f32 v100, v100
    v_mfma_f32_32x32x16_bf16 v[160:175], a[212:215], v[132:135], v[160:175]
    ds_read_b128 a[20:23], v21 offset:57344
    ds_read_b128 a[24:27], v22 offset:57344
    v_exp_f32 v101, v101
    v_cvt_pk_bf16_f32 v137, v98, v99
    v_mfma_f32_32x32x16_bf16 v[176:191], a[216:219], v[132:135], v[176:191]
    ds_read_b128 a[28:31], v23 offset:57344
    v_exp_f32 v102, v102
    v_exp_f32 v103, v103
    ds_read_b64_tr_b16 a[32:33], v44 offset:0
    v_mfma_f32_32x32x16_bf16 v[192:207], a[220:223], v[132:135], v[192:207]
    buffer_load_dwordx4 v64, s[36:39], s54 offen offset:1024 lds
    ds_read_b64_tr_b16 a[34:35], v44 offset:2048
    v_cvt_pk_bf16_f32 v138, v100, v101
    ds_read_b64_tr_b16 a[36:37], v45 offset:0
    v_mfma_f32_16x16x32_bf16 v[208:211], a[240:243], v[132:135], v[208:211]
    s_waitcnt lgkmcnt(3)
    ds_read_b64_tr_b16 a[38:39], v45 offset:2048
    v_mfma_f32_32x32x16_bf16 v[80:95], a[0:3], v[224:227], v[112:127]
    buffer_load_dwordx4 v65, s[36:39], s54 offen offset:2048 lds
    v_exp_f32 v104, v104
    ds_read_b64_tr_b16 a[40:41], v46 offset:0
    ds_read_b64_tr_b16 a[42:43], v46 offset:2048
    v_mfma_f32_32x32x16_bf16 v[80:95], a[4:7], v[228:231], v[80:95]
    buffer_load_dwordx4 v66, s[36:39], s54 offen offset:3072 lds
    v_exp_f32 v105, v105
    ds_read_b64_tr_b16 a[44:45], v47 offset:0
    s_add_u32 m0, s57, 135168
    v_mfma_f32_32x32x16_bf16 v[80:95], a[8:11], v[232:235], v[80:95]
    ds_read_b64_tr_b16 a[46:47], v47 offset:2048
    v_cvt_pk_bf16_f32 v139, v102, v103
    s_add_u32 s48, s54, 36864
    v_exp_f32 v106, v106
    ds_read_b64_tr_b16 a[48:49], v44 offset:4096
    v_mfma_f32_32x32x16_bf16 v[80:95], a[12:15], v[236:239], v[80:95]
    buffer_load_dwordx4 v63, s[36:39], s48 offen lds
    ds_read_b64_tr_b16 a[50:51], v44 offset:6144
    ds_read_b64_tr_b16 a[52:53], v45 offset:4096
    v_exp_f32 v107, v107
    v_mfma_f32_32x32x16_bf16 v[80:95], a[16:19], v[240:243], v[80:95]
    ds_read_b64_tr_b16 a[54:55], v45 offset:6144
    buffer_load_dwordx4 v64, s[36:39], s48 offen offset:1024 lds
    ds_read_b64_tr_b16 a[56:57], v46 offset:4096
    v_cvt_pk_bf16_f32 v140, v104, v105
    v_mfma_f32_32x32x16_bf16 v[80:95], a[20:23], v[244:247], v[80:95]
    ds_read_b64_tr_b16 a[58:59], v46 offset:6144
    ds_read_b64_tr_b16 a[60:61], v47 offset:4096
    ds_read_b64_tr_b16 a[62:63], v47 offset:6144
    buffer_load_dwordx4 v65, s[36:39], s48 offen offset:2048 lds
    v_mfma_f32_32x32x16_bf16 v[80:95], a[24:27], v[248:251], v[80:95]
    buffer_load_dwordx4 v66, s[36:39], s48 offen offset:3072 lds
    s_add_u32 s54, s54, 128
    s_sub_u32 s49, s54, 1152
    s_cselect_b32 s54, s54, s49
    v_mfma_f32_32x32x16_bf16 v[80:95], a[28:31], v[252:255], v[80:95]
    v_exp_f32 v108, v108
    v_exp_f32 v109, v109
    v_cvt_pk_bf16_f32 v141, v106, v107
    v_exp_f32 v110, v110
    v_exp_f32 v111, v111
    v_cvt_pk_bf16_f32 v142, v108, v109
    v_cvt_pk_bf16_f32 v143, v110, v111
    s_waitcnt vmcnt(16) lgkmcnt(0)
    s_barrier
    v_mfma_f32_32x32x16_bf16 v[144:159], a[32:35], v[136:139], v[144:159]
    ds_read_b128 a[0:3], v24 offset:8192
    ds_read_b128 a[4:7], v25 offset:8192
    ds_read_b128 a[8:11], v26 offset:8192
    ds_read_b128 a[12:15], v27 offset:8192
    v_mfma_f32_32x32x16_bf16 v[160:175], a[36:39], v[136:139], v[160:175]
    v_max3_f32 v68, v80, v81, v82
    v_max3_f32 v69, v83, v84, v85
    v_max3_f32 v68, v68, v86, v87
    v_max3_f32 v69, v69, v88, v89
    v_max3_f32 v68, v68, v90, v91
    v_mfma_f32_32x32x16_bf16 v[176:191], a[40:43], v[136:139], v[176:191]
    v_max3_f32 v69, v69, v92, v93
    v_max3_f32 v68, v68, v94, v95
    v_max_f32 v68, v68, v69
    v_cmp_lt_f32 vcc, 0x41000000, v68
    s_cbranch_vccnz L_stubA14
L_backA14:
    v_mfma_f32_32x32x16_bf16 v[192:207], a[44:47], v[136:139], v[192:207]
    v_exp_f32 v80, v80
    v_exp_f32 v81, v81
    v_exp_f32 v82, v82
    v_mfma_f32_16x16x32_bf16 v[208:211], a[240:243], v[136:139], v[208:211]
    v_exp_f32 v83, v83
    v_mfma_f32_32x32x16_bf16 v[144:159], a[48:51], v[140:143], v[144:159]
    ds_read_b128 a[16:19], v28 offset:8192
    v_cvt_pk_bf16_f32 v128, v80, v81
    v_exp_f32 v84, v84
    v_exp_f32 v85, v85
    v_mfma_f32_32x32x16_bf16 v[160:175], a[52:55], v[140:143], v[160:175]
    ds_read_b128 a[20:23], v29 offset:8192
    ds_read_b128 a[24:27], v30 offset:8192
    v_cvt_pk_bf16_f32 v129, v82, v83
    v_exp_f32 v86, v86
    v_mfma_f32_32x32x16_bf16 v[176:191], a[56:59], v[140:143], v[176:191]
    ds_read_b128 a[28:31], v31 offset:8192
    v_exp_f32 v87, v87
    ds_read_b64_tr_b16 a[192:193], v44 offset:16384
    ds_read_b64_tr_b16 a[194:195], v44 offset:18432
    v_mfma_f32_32x32x16_bf16 v[192:207], a[60:63], v[140:143], v[192:207]
    v_cvt_pk_bf16_f32 v130, v84, v85
    ds_read_b64_tr_b16 a[196:197], v45 offset:16384
    v_exp_f32 v88, v88
    ds_read_b64_tr_b16 a[198:199], v45 offset:18432
    v_mfma_f32_16x16x32_bf16 v[208:211], a[240:243], v[140:143], v[208:211]
    s_waitcnt lgkmcnt(4)
    ds_read_b64_tr_b16 a[200:201], v46 offset:16384
    v_mfma_f32_32x32x16_bf16 v[96:111], a[0:3], v[224:227], v[112:127]
    ds_read_b64_tr_b16 a[32:33], v44 offset:24576
    ds_read_b64_tr_b16 a[34:35], v44 offset:26624
    ds_read_b64_tr_b16 a[36:37], v45 offset:24576
    v_exp_f32 v89, v89
    v_mfma_f32_32x32x16_bf16 v[96:111], a[4:7], v[228:231], v[96:111]
    ds_read_b64_tr_b16 a[202:203], v46 offset:18432
    ds_read_b64_tr_b16 a[38:39], v45 offset:26624
    ds_read_b64_tr_b16 a[204:205], v47 offset:16384
    v_cvt_pk_bf16_f32 v131, v86, v87
    ds_read_b64_tr_b16 a[40:41], v46 offset:24576
    v_mfma_f32_32x32x16_bf16 v[96:111], a[8:11], v[232:235], v[96:111]
    ds_read_b64_tr_b16 a[206:207], v47 offset:18432
    ds_read_b64_tr_b16 a[42:43], v46 offset:26624
    v_exp_f32 v90, v90
    ds_read_b64_tr_b16 a[208:209], v44 offset:20480
    v_mfma_f32_32x32x16_bf16 v[96:111], a[12:15], v[236:239], v[96:111]
    ds_read_b64_tr_b16 a[210:211], v44 offset:22528
    ds_read_b64_tr_b16 a[44:45], v47 offset:24576
    ds_read_b64_tr_b16 a[212:213], v45 offset:20480
    v_exp_f32 v91, v91
    v_mfma_f32_32x32x16_bf16 v[96:111], a[16:19], v[240:243], v[96:111]
    ds_read_b64_tr_b16 a[214:215], v45 offset:22528
    ds_read_b64_tr_b16 a[46:47], v47 offset:26624
    ds_read_b64_tr_b16 a[216:217], v46 offset:20480
    ds_read_b64_tr_b16 a[48:49], v44 offset:28672
    ds_read_b64_tr_b16 a[50:51], v44 offset:30720
    v_mfma_f32_32x32x16_bf16 v[96:111], a[20:23], v[244:247], v[96:111]
    ds_read_b64_tr_b16 a[218:219], v46 offset:22528
    ds_read_b64_tr_b16 a[220:221], v47 offset:20480
    ds_read_b64_tr_b16 a[222:223], v47 offset:22528
    ds_read_b64_tr_b16 a[52:53], v45 offset:28672
    v_cvt_pk_bf16_f32 v132, v88, v89
    v_mfma_f32_32x32x16_bf16 v[96:111], a[24:27], v[248:251], v[96:111]
    ds_read_b64_tr_b16 a[54:55], v45 offset:30720
    ds_read_b64_tr_b16 a[56:57], v46 offset:28672
    ds_read_b64_tr_b16 a[58:59], v46 offset:30720
    ds_read_b64_tr_b16 a[60:61], v47 offset:28672
    ds_read_b64_tr_b16 a[62:63], v47 offset:30720
    v_mfma_f32_32x32x16_bf16 v[96:111], a[28:31], v[252:255], v[96:111]
    v_exp_f32 v92, v92
    v_exp_f32 v93, v93
    v_cvt_pk_bf16_f32 v133, v90, v91
    v_exp_f32 v94, v94
    v_exp_f32 v95, v95
    v_cvt_pk_bf16_f32 v134, v92, v93
    v_cvt_pk_bf16_f32 v135, v94, v95
    s_waitcnt vmcnt(16) lgkmcnt(0)
    s_barrier
    v_mfma_f32_32x32x16_bf16 v[144:159], a[192:195], v[128:131], v[144:159]
    s_add_u32 m0, s57, 0
    s_nop 0
    buffer_load_dwordx4 v63, s[36:39], s54 offen lds
    buffer_load_dwordx4 v64, s[36:39], s54 offen offset:1024 lds
    buffer_load_dwordx4 v65, s[36:39], s54 offen offset:2048 lds
    v_mfma_f32_32x32x16_bf16 v[160:175], a[196:199], v[128:131], v[160:175]
    v_max3_f32 v68, v96, v97, v98
    v_max3_f32 v69, v99, v100, v101
    v_max3_f32 v68, v68, v102, v103
    v_max3_f32 v69, v69, v104, v105
    v_max3_f32 v68, v68, v106, v107
    v_max3_f32 v69, v69, v108, v109
    v_max3_f32 v68, v68, v110, v111
    v_max_f32 v68, v68, v69
    v_mfma_f32_32x32x16_bf16 v[176:191], a[200:203], v[128:131], v[176:191]
    v_cmp_lt_f32 vcc, 0x41000000, v68
    s_cbranch_vccnz L_stubA15
L_backA15:
    v_exp_f32 v96, v96
    v_exp_f32 v97, v97
    v_exp_f32 v98, v98
    v_mfma_f32_32x32x16_bf16 v[192:207], a[204:207], v[128:131], v[192:207]
    v_exp_f32 v99, v99
    v_cvt_pk_bf16_f32 v136, v96, v97
    v_exp_f32 v100, v100
    v_exp_f32 v101, v101
    v_cvt_pk_bf16_f32 v137, v98, v99
    v_mfma_f32_16x16x32_bf16 v[208:211], a[240:243], v[128:131], v[208:211]
    v_exp_f32 v102, v102
    v_mfma_f32_32x32x16_bf16 v[144:159], a[208:211], v[132:135], v[144:159]
    v_exp_f32 v103, v103
    v_cvt_pk_bf16_f32 v138, v100, v101
    v_exp_f32 v104, v104
    v_exp_f32 v105, v105
    v_cvt_pk_bf16_f32 v139, v102, v103
    v_mfma_f32_32x32x16_bf16 v[160:175], a[212:215], v[132:135], v[160:175]
    buffer_load_dwordx4 v66, s[36:39], s54 offen offset:3072 lds
    v_exp_f32 v106, v106
    s_add_u32 m0, s57, 4096
    v_exp_f32 v107, v107
    s_add_u32 s48, s54, 36864
    v_cvt_pk_bf16_f32 v140, v104, v105
    v_mfma_f32_32x32x16_bf16 v[176:191], a[216:219], v[132:135], v[176:191]
    buffer_load_dwordx4 v63, s[36:39], s48 offen lds
    v_exp_f32 v108, v108
    buffer_load_dwordx4 v64, s[36:39], s48 offen offset:1024 lds
    v_exp_f32 v109, v109
    v_mfma_f32_32x32x16_bf16 v[192:207], a[220:223], v[132:135], v[192:207]
    buffer_load_dwordx4 v65, s[36:39], s48 offen offset:2048 lds
    v_cvt_pk_bf16_f32 v141, v106, v107
    v_exp_f32 v110, v110
    buffer_load_dwordx4 v66, s[36:39], s48 offen offset:3072 lds
    s_add_u32 s54, s54, 128
    v_mfma_f32_16x16x32_bf16 v[208:211], a[240:243], v[132:135], v[208:211]
    v_exp_f32 v111, v111
    v_cvt_pk_bf16_f32 v142, v108, v109
    v_cvt_pk_bf16_f32 v143, v110, v111
    s_sub_u32 s49, s54, 1152
    s_cselect_b32 s54, s54, s49
L_common:
    v_or_b32 v1, v74, v75
    v_cmp_eq_u32 vcc, 0, v1
    s_cbranch_vccnz L_epoch_spin
L_epoch_ok:
    v_mfma_f32_16x16x32_bf16 v[208:211], a[240:243], v[136:139], v[208:211]
    v_mfma_f32_16x16x32_bf16 v[208:211], a[240:243], v[140:143], v[208:211]
    v_mfma_f32_32x32x16_bf16 v[144:159], a[32:35], v[136:139], v[144:159]
    v_mfma_f32_32x32x16_bf16 v[144:159], a[48:51], v[140:143], v[144:159]
    v_mfma_f32_32x32x16_bf16 v[160:175], a[36:39], v[136:139], v[160:175]
    s_nop 8
    v_rcp_f32 v70, v208
    v_mfma_f32_32x32x16_bf16 v[160:175], a[52:55], v[140:143], v[160:175]
    v_mul_f32 v144, v70, v144
    v_mul_f32 v145, v70, v145
    v_mul_f32 v146, v70, v146
    v_mul_f32 v147, v70, v147
    v_mul_f32 v148, v70, v148
    v_mul_f32 v149, v70, v149
    v_mul_f32 v150, v70, v150
    v_mfma_f32_32x32x16_bf16 v[176:191], a[40:43], v[136:139], v[176:191]
    v_mul_f32 v151, v70, v151
    v_cvt_pk_bf16_f32 v224, v144, v145
    v_cvt_pk_bf16_f32 v225, v146, v147
    v_cvt_pk_bf16_f32 v226, v148, v149
    v_cvt_pk_bf16_f32 v227, v150, v151
    ds_write_b128 v61, v[224:227] offset:0
    v_mfma_f32_32x32x16_bf16 v[176:191], a[56:59], v[140:143], v[176:191]
    v_mul_f32 v152, v70, v152
    v_mul_f32 v153, v70, v153
    v_mul_f32 v154, v70, v154
    v_mul_f32 v155, v70, v155
    v_mul_f32 v156, v70, v156
    v_mul_f32 v157, v70, v157
    v_mul_f32 v158, v70, v158
    v_mfma_f32_32x32x16_bf16 v[192:207], a[44:47], v[136:139], v[192:207]
    v_mul_f32 v159, v70, v159
    v_cvt_pk_bf16_f32 v228, v152, v153
    v_cvt_pk_bf16_f32 v229, v154, v155
    v_cvt_pk_bf16_f32 v230, v156, v157
    v_cvt_pk_bf16_f32 v231, v158, v159
    ds_write_b128 v61, v[228:231] offset:1024
    v_mfma_f32_32x32x16_bf16 v[192:207], a[60:63], v[140:143], v[192:207]
    v_mul_f32 v160, v70, v160
    v_mul_f32 v161, v70, v161
    v_mul_f32 v162, v70, v162
    v_mul_f32 v163, v70, v163
    v_mul_f32 v164, v70, v164
    v_mul_f32 v165, v70, v165
    v_mul_f32 v166, v70, v166
    v_mfma_f32_32x32x16_bf16 v[80:95], a[64:67], v[224:227], 0
    v_mul_f32 v167, v70, v167
    v_cvt_pk_bf16_f32 v232, v160, v161
    v_cvt_pk_bf16_f32 v233, v162, v163
    v_cvt_pk_bf16_f32 v234, v164, v165
    v_cvt_pk_bf16_f32 v235, v166, v167
    ds_write_b128 v61, v[232:235] offset:2048
    v_mfma_f32_32x32x16_bf16 v[96:111], a[128:131], v[224:227], 0
    v_mul_f32 v168, v70, v168
    v_mul_f32 v169, v70, v169
    v_mul_f32 v170, v70, v170
    v_mul_f32 v171, v70, v171
    v_mul_f32 v172, v70, v172
    v_mul_f32 v173, v70, v173
    v_mul_f32 v174, v70, v174
    v_mfma_f32_32x32x16_bf16 v[80:95], a[68:71], v[228:231], v[80:95]
    v_mul_f32 v175, v70, v175
    v_cvt_pk_bf16_f32 v236, v168, v169
    v_cvt_pk_bf16_f32 v237, v170, v171
    v_cvt_pk_bf16_f32 v238, v172, v173
    v_cvt_pk_bf16_f32 v239, v174, v175
    ds_write_b128 v61, v[236:239] offset:3072
    v_mfma_f32_32x32x16_bf16 v[96:111], a[132:135], v[228:231], v[96:111]
    v_mul_f32 v176, v70, v176
    v_mul_f32 v177, v70, v177
    v_mul_f32 v178, v70, v178
    v_mul_f32 v179, v70, v179
    v_mul_f32 v180, v70, v180
    v_mul_f32 v181, v70, v181
    v_mul_f32 v182, v70, v182
    v_mfma_f32_32x32x16_bf16 v[80:95], a[72:75], v[232:235], v[80:95]
    v_mul_f32 v183, v70, v183
    v_cvt_pk_bf16_f32 v240, v176, v177
    v_cvt_pk_bf16_f32 v241, v178, v179
    v_cvt_pk_bf16_f32 v242, v180, v181
    v_cvt_pk_bf16_f32 v243, v182, v183
    ds_write_b128 v61, v[240:243] offset:4096
    v_mfma_f32_32x32x16_bf16 v[96:111], a[136:139], v[232:235], v[96:111]
    v_mul_f32 v184, v70, v184
    v_mul_f32 v185, v70, v185
    v_mul_f32 v186, v70, v186
    v_mul_f32 v187, v70, v187
    v_mul_f32 v188, v70, v188
    v_mul_f32 v189, v70, v189
    v_mul_f32 v190, v70, v190
    v_mfma_f32_32x32x16_bf16 v[80:95], a[76:79], v[236:239], v[80:95]
    v_mul_f32 v191, v70, v191
    v_cvt_pk_bf16_f32 v244, v184, v185
    v_cvt_pk_bf16_f32 v245, v186, v187
    v_cvt_pk_bf16_f32 v246, v188, v189
    v_cvt_pk_bf16_f32 v247, v190, v191
    ds_write_b128 v61, v[244:247] offset:5120
    v_mfma_f32_32x32x16_bf16 v[96:111], a[140:143], v[236:239], v[96:111]
    v_mul_f32 v192, v70, v192
    v_mul_f32 v193, v70, v193
    v_mul_f32 v194, v70, v194
    v_mul_f32 v195, v70, v195
    v_mul_f32 v196, v70, v196
    v_mul_f32 v197, v70, v197
    v_mul_f32 v198, v70, v198
    v_mfma_f32_32x32x16_bf16 v[80:95], a[80:83], v[240:243], v[80:95]
    v_mul_f32 v199, v70, v199
    v_cvt_pk_bf16_f32 v248, v192, v193
    v_cvt_pk_bf16_f32 v249, v194, v195
    v_cvt_pk_bf16_f32 v250, v196, v197
    v_cvt_pk_bf16_f32 v251, v198, v199
    ds_write_b128 v61, v[248:251] offset:6144
    v_mfma_f32_32x32x16_bf16 v[96:111], a[144:147], v[240:243], v[96:111]
    v_mul_f32 v200, v70, v200
    v_mul_f32 v201, v70, v201
    v_mul_f32 v202, v70, v202
    v_mul_f32 v203, v70, v203
    v_mul_f32 v204, v70, v204
    v_mul_f32 v205, v70, v205
    v_mul_f32 v206, v70, v206
    v_mfma_f32_32x32x16_bf16 v[80:95], a[84:87], v[244:247], v[80:95]
    v_mul_f32 v207, v70, v207
    v_cvt_pk_bf16_f32 v252, v200, v201
    v_cvt_pk_bf16_f32 v253, v202, v203
    v_cvt_pk_bf16_f32 v254, v204, v205
    v_cvt_pk_bf16_f32 v255, v206, v207
    ds_write_b128 v61, v[252:255] offset:7168
    v_mfma_f32_32x32x16_bf16 v[96:111], a[148:151], v[244:247], v[96:111]
    s_waitcnt vmcnt(16) lgkmcnt(0)
    s_barrier
    ds_read_b128 a[192:195], v62 offset:0
    ds_read_b128 a[196:199], v62 offset:1024
    ds_read_b128 a[200:203], v62 offset:2048
    ds_read_b128 a[204:207], v62 offset:3072
    v_mfma_f32_32x32x16_bf16 v[80:95], a[88:91], v[248:251], v[80:95]
    ds_read_b128 a[208:211], v62 offset:4096
    ds_read_b128 a[212:215], v62 offset:5120
    ds_read_b128 a[216:219], v62 offset:6144
    ds_read_b128 a[220:223], v62 offset:7168
    s_add_u32 m0, s57, 32768
    s_nop 0
    buffer_load_dwordx4 v63, s[36:39], s54 offen lds
    v_mfma_f32_32x32x16_bf16 v[96:111], a[152:155], v[248:251], v[96:111]
    buffer_load_dwordx4 v64, s[36:39], s54 offen offset:1024 lds
    v_mfma_f32_32x32x16_bf16 v[80:95], a[92:95], v[252:255], v[80:95]
    buffer_load_dwordx4 v65, s[36:39], s54 offen offset:2048 lds
    v_mfma_f32_32x32x16_bf16 v[96:111], a[156:159], v[252:255], v[96:111]
    buffer_load_dwordx4 v66, s[36:39], s54 offen offset:3072 lds
    s_waitcnt lgkmcnt(7)
    v_mfma_f32_32x32x16_bf16 v[80:95], a[96:99], a[192:195], v[80:95]
    s_add_u32 m0, s57, 36864
    ds_read_b64_tr_b16 a[64:65], v57 offset:32768
    ds_read_b64_tr_b16 a[66:67], v57 offset:33792
    s_waitcnt lgkmcnt(8)
    v_mfma_f32_32x32x16_bf16 v[80:95], a[100:103], a[196:199], v[80:95]
    s_add_u32 s48, s54, 36864
    ds_read_b64_tr_b16 a[68:69], v57 offset:34816
    ds_read_b64_tr_b16 a[70:71], v57 offset:35840
    s_waitcnt lgkmcnt(9)
    v_mfma_f32_32x32x16_bf16 v[80:95], a[104:107], a[200:203], v[80:95]
    buffer_load_dwordx4 v63, s[36:39], s48 offen lds
    ds_read_b64_tr_b16 a[72:73], v57 offset:36864
    ds_read_b64_tr_b16 a[74:75], v57 offset:37888
    s_waitcnt lgkmcnt(10)
    v_mfma_f32_32x32x16_bf16 v[80:95], a[108:111], a[204:207], v[80:95]
    buffer_load_dwordx4 v64, s[36:39], s48 offen offset:1024 lds
    ds_read_b64_tr_b16 a[76:77], v57 offset:38912
    ds_read_b64_tr_b16 a[78:79], v57 offset:39936
    s_waitcnt lgkmcnt(11)
    v_mfma_f32_32x32x16_bf16 v[80:95], a[112:115], a[208:211], v[80:95]
    buffer_load_dwordx4 v65, s[36:39], s48 offen offset:2048 lds
    ds_read_b64_tr_b16 a[80:81], v57 offset:40960
    ds_read_b64_tr_b16 a[82:83], v57 offset:41984
    s_waitcnt lgkmcnt(12)
    v_mfma_f32_32x32x16_bf16 v[80:95], a[116:119], a[212:215], v[80:95]
    buffer_load_dwordx4 v66, s[36:39], s48 offen offset:3072 lds
    ds_read_b64_tr_b16 a[84:85], v57 offset:43008
    ds_read_b64_tr_b16 a[86:87], v57 offset:44032
    s_waitcnt lgkmcnt(13)
    v_mfma_f32_32x32x16_bf16 v[80:95], a[120:123], a[216:219], v[80:95]
    s_add_u32 s54, s54, 128
    ds_read_b64_tr_b16 a[88:89], v57 offset:45056
    ds_read_b64_tr_b16 a[90:91], v57 offset:46080
    s_waitcnt lgkmcnt(14)
    v_mfma_f32_32x32x16_bf16 v[80:95], a[124:127], a[220:223], v[80:95]
    s_sub_u32 s49, s54, 1152
    s_cselect_b32 s54, s54, s49
    ds_read_b64_tr_b16 a[92:93], v57 offset:47104
    ds_read_b64_tr_b16 a[94:95], v57 offset:48128
    v_mfma_f32_32x32x16_bf16 v[96:111], a[160:163], a[192:195], v[96:111]
    ds_read_b64_tr_b16 a[96:97], v58 offset:32768
    ds_read_b64_tr_b16 a[98:99], v58 offset:33792
    ds_read_b64_tr_b16 a[100:101], v58 offset:34816
    v_mfma_f32_32x32x16_bf16 v[96:111], a[164:167], a[196:199], v[96:111]
    ds_read_b64_tr_b16 a[102:103], v58 offset:35840
    ds_read_b64_tr_b16 a[104:105], v58 offset:36864
    ds_read_b64_tr_b16 a[106:107], v58 offset:37888
    v_mfma_f32_32x32x16_bf16 v[96:111], a[168:171], a[200:203], v[96:111]
    ds_read_b64_tr_b16 a[108:109], v58 offset:38912
    ds_read_b64_tr_b16 a[110:111], v58 offset:39936
    v_cvt_pk_bf16_f32 v128, v80, v81
    v_cvt_pk_bf16_f32 v129, v82, v83
    v_mfma_f32_32x32x16_bf16 v[96:111], a[172:175], a[204:207], v[96:111]
    ds_read_b64_tr_b16 a[112:113], v58 offset:40960
    ds_read_b64_tr_b16 a[114:115], v58 offset:41984
    ds_read_b64_tr_b16 a[116:117], v58 offset:43008
    v_cvt_pk_bf16_f32 v130, v84, v85
    v_cvt_pk_bf16_f32 v131, v86, v87
    v_mfma_f32_32x32x16_bf16 v[96:111], a[176:179], a[208:211], v[96:111]
    ds_read_b64_tr_b16 a[118:119], v58 offset:44032
    ds_read_b64_tr_b16 a[120:121], v58 offset:45056
    ds_read_b64_tr_b16 a[122:123], v58 offset:46080
    buffer_store_dwordx4 v[128:131], v67, s[40:43], s64 offen sc1
    v_mfma_f32_32x32x16_bf16 v[96:111], a[180:183], a[212:215], v[96:111]
    ds_read_b64_tr_b16 a[124:125], v58 offset:47104
    ds_read_b64_tr_b16 a[126:127], v58 offset:48128
    v_cvt_pk_bf16_f32 v132, v88, v89
    v_cvt_pk_bf16_f32 v133, v90, v91
    v_mfma_f32_32x32x16_bf16 v[96:111], a[184:187], a[216:219], v[96:111]
    v_cvt_pk_bf16_f32 v134, v92, v93
    v_cvt_pk_bf16_f32 v135, v94, v95
    v_mfma_f32_32x32x16_bf16 v[96:111], a[188:191], a[220:223], v[96:111]
    buffer_store_dwordx4 v[132:135], v67, s[40:43], s64 offen offset:1024 sc1
    s_waitcnt vmcnt(18) lgkmcnt(0)
    s_barrier
    s_add_u32 m0, s57, 65536
    s_nop 0
    buffer_load_dwordx4 v63, s[36:39], s54 offen lds
    v_mfma_f32_32x32x16_bf16 v[80:95], a[64:67], v[224:227], 0
    buffer_load_dwordx4 v64, s[36:39], s54 offen offset:1024 lds
    ds_read_b64_tr_b16 a[128:129], v59 offset:0
    ds_read_b64_tr_b16 a[130:131], v59 offset:1024
    ds_read_b64_tr_b16 a[132:133], v59 offset:2048
    v_mfma_f32_32x32x16_bf16 v[80:95], a[68:71], v[228:231], v[80:95]
    buffer_load_dwordx4 v65, s[36:39], s54 offen offset:2048 lds
    ds_read_b64_tr_b16 a[134:135], v59 offset:3072
    ds_read_b64_tr_b16 a[136:137], v59 offset:4096
    v_mfma_f32_32x32x16_bf16 v[80:95], a[72:75], v[232:235], v[80:95]
    buffer_load_dwordx4 v66, s[36:39], s54 offen offset:3072 lds
    ds_read_b64_tr_b16 a[138:139], v59 offset:5120
    ds_read_b64_tr_b16 a[140:141], v59 offset:6144
    v_mfma_f32_32x32x16_bf16 v[80:95], a[76:79], v[236:239], v[80:95]
    s_add_u32 m0, s57, 69632
    ds_read_b64_tr_b16 a[142:143], v59 offset:7168
    ds_read_b64_tr_b16 a[144:145], v59 offset:8192
    ds_read_b64_tr_b16 a[146:147], v59 offset:9216
    v_mfma_f32_32x32x16_bf16 v[80:95], a[80:83], v[240:243], v[80:95]
    s_add_u32 s48, s54, 36864
    buffer_load_dwordx4 v63, s[36:39], s48 offen lds
    ds_read_b64_tr_b16 a[148:149], v59 offset:10240
    ds_read_b64_tr_b16 a[150:151], v59 offset:11264
    v_mfma_f32_32x32x16_bf16 v[80:95], a[84:87], v[244:247], v[80:95]
    buffer_load_dwordx4 v64, s[36:39], s48 offen offset:1024 lds
    ds_read_b64_tr_b16 a[152:153], v59 offset:12288
    ds_read_b64_tr_b16 a[154:155], v59 offset:13312
    v_mfma_f32_32x32x16_bf16 v[80:95], a[88:91], v[248:251], v[80:95]
    buffer_load_dwordx4 v65, s[36:39], s48 offen offset:2048 lds
    ds_read_b64_tr_b16 a[156:157], v59 offset:14336
    ds_read_b64_tr_b16 a[158:159], v59 offset:15360
    v_mfma_f32_32x32x16_bf16 v[80:95], a[92:95], v[252:255], v[80:95]
    buffer_load_dwordx4 v66, s[36:39], s48 offen offset:3072 lds
    ds_read_b64_tr_b16 a[160:161], v60 offset:0
    ds_read_b64_tr_b16 a[162:163], v60 offset:1024
    ds_read_b64_tr_b16 a[164:165], v60 offset:2048
    v_mfma_f32_32x32x16_bf16 v[80:95], a[96:99], a[192:195], v[80:95]
    s_add_u32 s54, s54, 128
    ds_read_b64_tr_b16 a[166:167], v60 offset:3072
    ds_read_b64_tr_b16 a[168:169], v60 offset:4096
    v_cvt_pk_bf16_f32 v136, v96, v97
    v_cvt_pk_bf16_f32 v137, v98, v99
    v_mfma_f32_32x32x16_bf16 v[80:95], a[100:103], a[196:199], v[80:95]
    s_sub_u32 s49, s54, 1152
    s_cselect_b32 s54, s54, s49
    ds_read_b64_tr_b16 a[170:171], v60 offset:5120
    ds_read_b64_tr_b16 a[172:173], v60 offset:6144
    v_cvt_pk_bf16_f32 v138, v100, v101
    v_mfma_f32_32x32x16_bf16 v[80:95], a[104:107], a[200:203], v[80:95]
    ds_read_b64_tr_b16 a[174:175], v60 offset:7168
    ds_read_b64_tr_b16 a[176:177], v60 offset:8192
    ds_read_b64_tr_b16 a[178:179], v60 offset:9216
    v_cvt_pk_bf16_f32 v139, v102, v103
    v_mfma_f32_32x32x16_bf16 v[80:95], a[108:111], a[204:207], v[80:95]
    ds_read_b64_tr_b16 a[180:181], v60 offset:10240
    ds_read_b64_tr_b16 a[182:183], v60 offset:11264
    buffer_store_dwordx4 v[136:139], v67, s[40:43], s65 offen sc1
    v_mfma_f32_32x32x16_bf16 v[80:95], a[112:115], a[208:211], v[80:95]
    ds_read_b64_tr_b16 a[184:185], v60 offset:12288
    ds_read_b64_tr_b16 a[186:187], v60 offset:13312
    v_cvt_pk_bf16_f32 v140, v104, v105
    v_cvt_pk_bf16_f32 v141, v106, v107
    v_mfma_f32_32x32x16_bf16 v[80:95], a[116:119], a[212:215], v[80:95]
    ds_read_b64_tr_b16 a[188:189], v60 offset:14336
    ds_read_b64_tr_b16 a[190:191], v60 offset:15360
    v_cvt_pk_bf16_f32 v142, v108, v109
    v_mfma_f32_32x32x16_bf16 v[80:95], a[120:123], a[216:219], v[80:95]
    v_cvt_pk_bf16_f32 v143, v110, v111
    v_mfma_f32_32x32x16_bf16 v[80:95], a[124:127], a[220:223], v[80:95]
    buffer_store_dwordx4 v[140:143], v67, s[40:43], s65 offen offset:1024 sc1
    s_waitcnt vmcnt(20) lgkmcnt(0)
    s_barrier
    s_add_u32 m0, s57, 98304
    s_nop 0
    buffer_load_dwordx4 v63, s[36:39], s54 offen lds
    v_mfma_f32_32x32x16_bf16 v[96:111], a[128:131], v[224:227], 0
    buffer_load_dwordx4 v64, s[36:39], s54 offen offset:1024 lds
    ds_read_b64_tr_b16 a[64:65], v55 offset:0
    ds_read_b64_tr_b16 a[66:67], v55 offset:1024
    ds_read_b64_tr_b16 a[68:69], v55 offset:2048
    v_mfma_f32_32x32x16_bf16 v[96:111], a[132:135], v[228:231], v[96:111]
    buffer_load_dwordx4 v65, s[36:39], s54 offen offset:2048 lds
    ds_read_b64_tr_b16 a[70:71], v55 offset:3072
    ds_read_b64_tr_b16 a[72:73], v55 offset:4096
    v_mfma_f32_32x32x16_bf16 v[96:111], a[136:139], v[232:235], v[96:111]
    buffer_load_dwordx4 v66, s[36:39], s54 offen offset:3072 lds
    ds_read_b64_tr_b16 a[74:75], v55 offset:5120
    ds_read_b64_tr_b16 a[76:77], v55 offset:6144
    v_mfma_f32_32x32x16_bf16 v[96:111], a[140:143], v[236:239], v[96:111]
    s_add_u32 m0, s57, 102400
    ds_read_b64_tr_b16 a[78:79], v55 offset:7168
    ds_read_b64_tr_b16 a[80:81], v55 offset:8192
    ds_read_b64_tr_b16 a[82:83], v55 offset:9216
    v_mfma_f32_32x32x16_bf16 v[96:111], a[144:147], v[240:243], v[96:111]
    s_add_u32 s48, s54, 36864
    buffer_load_dwordx4 v63, s[36:39], s48 offen lds
    ds_read_b64_tr_b16 a[84:85], v55 offset:10240
    ds_read_b64_tr_b16 a[86:87], v55 offset:11264
    v_mfma_f32_32x32x16_bf16 v[96:111], a[148:151], v[244:247], v[96:111]
    buffer_load_dwordx4 v64, s[36:39], s48 offen offset:1024 lds
    ds_read_b64_tr_b16 a[88:89], v55 offset:12288
    ds_read_b64_tr_b16 a[90:91], v55 offset:13312
    v_mfma_f32_32x32x16_bf16 v[96:111], a[152:155], v[248:251], v[96:111]
    buffer_load_dwordx4 v65, s[36:39], s48 offen offset:2048 lds
    ds_read_b64_tr_b16 a[92:93], v55 offset:14336
    ds_read_b64_tr_b16 a[94:95], v55 offset:15360
    v_mfma_f32_32x32x16_bf16 v[96:111], a[156:159], v[252:255], v[96:111]
    buffer_load_dwordx4 v66, s[36:39], s48 offen offset:3072 lds
    ds_read_b64_tr_b16 a[96:97], v56 offset:0
    ds_read_b64_tr_b16 a[98:99], v56 offset:1024
    ds_read_b64_tr_b16 a[100:101], v56 offset:2048
    v_mfma_f32_32x32x16_bf16 v[96:111], a[160:163], a[192:195], v[96:111]
    s_add_u32 s54, s54, 128
    ds_read_b64_tr_b16 a[102:103], v56 offset:3072
    ds_read_b64_tr_b16 a[104:105], v56 offset:4096
    v_cvt_pk_bf16_f32 v128, v80, v81
    v_cvt_pk_bf16_f32 v129, v82, v83
    v_mfma_f32_32x32x16_bf16 v[96:111], a[164:167], a[196:199], v[96:111]
    s_sub_u32 s49, s54, 1152
    s_cselect_b32 s54, s54, s49
    ds_read_b64_tr_b16 a[106:107], v56 offset:5120
    ds_read_b64_tr_b16 a[108:109], v56 offset:6144
    v_cvt_pk_bf16_f32 v130, v84, v85
    v_mfma_f32_32x32x16_bf16 v[96:111], a[168:171], a[200:203], v[96:111]
    ds_read_b64_tr_b16 a[110:111], v56 offset:7168
    ds_read_b64_tr_b16 a[112:113], v56 offset:8192
    ds_read_b64_tr_b16 a[114:115], v56 offset:9216
    v_cvt_pk_bf16_f32 v131, v86, v87
    v_mfma_f32_32x32x16_bf16 v[96:111], a[172:175], a[204:207], v[96:111]
    ds_read_b64_tr_b16 a[116:117], v56 offset:10240
    ds_read_b64_tr_b16 a[118:119], v56 offset:11264
    buffer_store_dwordx4 v[128:131], v67, s[40:43], s66 offen sc1
    v_mfma_f32_32x32x16_bf16 v[96:111], a[176:179], a[208:211], v[96:111]
    ds_read_b64_tr_b16 a[120:121], v56 offset:12288
    ds_read_b64_tr_b16 a[122:123], v56 offset:13312
    v_cvt_pk_bf16_f32 v132, v88, v89
    v_cvt_pk_bf16_f32 v133, v90, v91
    v_mfma_f32_32x32x16_bf16 v[96:111], a[180:183], a[212:215], v[96:111]
    ds_read_b64_tr_b16 a[124:125], v56 offset:14336
    ds_read_b64_tr_b16 a[126:127], v56 offset:15360
    v_cvt_pk_bf16_f32 v134, v92, v93
    v_mfma_f32_32x32x16_bf16 v[96:111], a[184:187], a[216:219], v[96:111]
    v_cvt_pk_bf16_f32 v135, v94, v95
    v_mfma_f32_32x32x16_bf16 v[96:111], a[188:191], a[220:223], v[96:111]
    buffer_store_dwordx4 v[132:135], v67, s[40:43], s66 offen offset:1024 sc1
    s_waitcnt vmcnt(22) lgkmcnt(0)
    s_barrier
    s_add_u32 m0, s57, 131072
    s_nop 0
    buffer_load_dwordx4 v63, s[36:39], s54 offen lds
    v_mfma_f32_32x32x16_bf16 v[80:95], a[64:67], v[224:227], 0
    buffer_load_dwordx4 v64, s[36:39], s54 offen offset:1024 lds
    ds_read_b64_tr_b16 a[128:129], v55 offset:32768
    ds_read_b64_tr_b16 a[130:131], v55 offset:33792
    ds_read_b64_tr_b16 a[132:133], v55 offset:34816
    v_mfma_f32_32x32x16_bf16 v[80:95], a[68:71], v[228:231], v[80:95]
    buffer_load_dwordx4 v65, s[36:39], s54 offen offset:2048 lds
    ds_read_b64_tr_b16 a[134:135], v55 offset:35840
    ds_read_b64_tr_b16 a[136:137], v55 offset:36864
    v_mfma_f32_32x32x16_bf16 v[80:95], a[72:75], v[232:235], v[80:95]
    buffer_load_dwordx4 v66, s[36:39], s54 offen offset:3072 lds
    ds_read_b64_tr_b16 a[138:139], v55 offset:37888
    ds_read_b64_tr_b16 a[140:141], v55 offset:38912
    v_mfma_f32_32x32x16_bf16 v[80:95], a[76:79], v[236:239], v[80:95]
    s_add_u32 m0, s57, 135168
    ds_read_b64_tr_b16 a[142:143], v55 offset:39936
    ds_read_b64_tr_b16 a[144:145], v55 offset:40960
    ds_read_b64_tr_b16 a[146:147], v55 offset:41984
    v_mfma_f32_32x32x16_bf16 v[80:95], a[80:83], v[240:243], v[80:95]
    s_add_u32 s48, s54, 36864
    buffer_load_dwordx4 v63, s[36:39], s48 offen lds
    ds_read_b64_tr_b16 a[148:149], v55 offset:43008
    ds_read_b64_tr_b16 a[150:151], v55 offset:44032
    v_mfma_f32_32x32x16_bf16 v[80:95], a[84:87], v[244:247], v[80:95]
    buffer_load_dwordx4 v64, s[36:39], s48 offen offset:1024 lds
    ds_read_b64_tr_b16 a[152:153], v55 offset:45056
    ds_read_b64_tr_b16 a[154:155], v55 offset:46080
    v_mfma_f32_32x32x16_bf16 v[80:95], a[88:91], v[248:251], v[80:95]
    buffer_load_dwordx4 v65, s[36:39], s48 offen offset:2048 lds
    ds_read_b64_tr_b16 a[156:157], v55 offset:47104
    ds_read_b64_tr_b16 a[158:159], v55 offset:48128
    v_mfma_f32_32x32x16_bf16 v[80:95], a[92:95], v[252:255], v[80:95]
    buffer_load_dwordx4 v66, s[36:39], s48 offen offset:3072 lds
    ds_read_b64_tr_b16 a[160:161], v56 offset:32768
    ds_read_b64_tr_b16 a[162:163], v56 offset:33792
    ds_read_b64_tr_b16 a[164:165], v56 offset:34816
    v_mfma_f32_32x32x16_bf16 v[80:95], a[96:99], a[192:195], v[80:95]
    s_add_u32 s54, s54, 128
    ds_read_b64_tr_b16 a[166:167], v56 offset:35840
    ds_read_b64_tr_b16 a[168:169], v56 offset:36864
    v_cvt_pk_bf16_f32 v136, v96, v97
    v_cvt_pk_bf16_f32 v137, v98, v99
    v_mfma_f32_32x32x16_bf16 v[80:95], a[100:103], a[196:199], v[80:95]
    s_sub_u32 s49, s54, 1152
    s_cselect_b32 s54, s54, s49
    ds_read_b64_tr_b16 a[170:171], v56 offset:37888
    ds_read_b64_tr_b16 a[172:173], v56 offset:38912
    v_cvt_pk_bf16_f32 v138, v100, v101
    v_mfma_f32_32x32x16_bf16 v[80:95], a[104:107], a[200:203], v[80:95]
    ds_read_b64_tr_b16 a[174:175], v56 offset:39936
    ds_read_b64_tr_b16 a[176:177], v56 offset:40960
    ds_read_b64_tr_b16 a[178:179], v56 offset:41984
    v_cvt_pk_bf16_f32 v139, v102, v103
    v_mfma_f32_32x32x16_bf16 v[80:95], a[108:111], a[204:207], v[80:95]
    ds_read_b64_tr_b16 a[180:181], v56 offset:43008
    ds_read_b64_tr_b16 a[182:183], v56 offset:44032
    buffer_store_dwordx4 v[136:139], v67, s[40:43], s67 offen sc1
    v_mfma_f32_32x32x16_bf16 v[80:95], a[112:115], a[208:211], v[80:95]
    ds_read_b64_tr_b16 a[184:185], v56 offset:45056
    ds_read_b64_tr_b16 a[186:187], v56 offset:46080
    v_cvt_pk_bf16_f32 v140, v104, v105
    v_cvt_pk_bf16_f32 v141, v106, v107
    v_mfma_f32_32x32x16_bf16 v[80:95], a[116:119], a[212:215], v[80:95]
    ds_read_b64_tr_b16 a[188:189], v56 offset:47104
    ds_read_b64_tr_b16 a[190:191], v56 offset:48128
    v_cvt_pk_bf16_f32 v142, v108, v109
    v_mfma_f32_32x32x16_bf16 v[80:95], a[120:123], a[216:219], v[80:95]
    v_cvt_pk_bf16_f32 v143, v110, v111
    v_mfma_f32_32x32x16_bf16 v[80:95], a[124:127], a[220:223], v[80:95]
    buffer_store_dwordx4 v[140:143], v67, s[40:43], s67 offen offset:1024 sc1
    s_waitcnt vmcnt(22) lgkmcnt(0)
    s_barrier
    v_mfma_f32_32x32x16_bf16 v[96:111], a[128:131], v[224:227], 0
    ds_read_b64_tr_b16 a[64:65], v57 offset:0
    ds_read_b64_tr_b16 a[66:67], v57 offset:1024
    ds_read_b64_tr_b16 a[68:69], v57 offset:2048
    s_lshl_b32 s20, s44, 4
    s_add_u32 s20, s20, s45
    v_mfma_f32_32x32x16_bf16 v[96:111], a[132:135], v[228:231], v[96:111]
    ds_read_b64_tr_b16 a[70:71], v57 offset:3072
    ds_read_b64_tr_b16 a[72:73], v57 offset:4096
    s_lshl_b32 s26, s20, 10
    s_lshr_b32 s28, s20, 3
    v_mfma_f32_32x32x16_bf16 v[96:111], a[136:139], v[232:235], v[96:111]
    ds_read_b64_tr_b16 a[74:75], v57 offset:5120
    ds_read_b64_tr_b16 a[76:77], v57 offset:6144
    s_add_u32 s28, s28, s47
    v_mfma_f32_32x32x16_bf16 v[96:111], a[140:143], v[236:239], v[96:111]
    ds_read_b64_tr_b16 a[78:79], v57 offset:7168
    ds_read_b64_tr_b16 a[80:81], v57 offset:8192
    ds_read_b64_tr_b16 a[82:83], v57 offset:9216
    v_cvt_pk_bf16_f32 v128, v80, v81
    v_cvt_pk_bf16_f32 v129, v82, v83
    s_sub_u32 s24, s28, 9
    s_cselect_b32 s28, s28, s24
    s_lshl_b32 s28, s28, 7
    v_mfma_f32_32x32x16_bf16 v[96:111], a[144:147], v[240:243], v[96:111]
    ds_read_b64_tr_b16 a[84:85], v57 offset:10240
    ds_read_b64_tr_b16 a[86:87], v57 offset:11264
    v_cvt_pk_bf16_f32 v130, v84, v85
    s_bfe_u32 s24, s20, 0x10001
    v_mfma_f32_32x32x16_bf16 v[96:111], a[148:151], v[244:247], v[96:111]
    ds_read_b64_tr_b16 a[88:89], v57 offset:12288
    ds_read_b64_tr_b16 a[90:91], v57 offset:13312
    v_cvt_pk_bf16_f32 v131, v86, v87
    s_mul_i32 s24, s24, 36864
    s_add_u32 s28, s28, s24
    v_mfma_f32_32x32x16_bf16 v[96:111], a[152:155], v[248:251], v[96:111]
    ds_read_b64_tr_b16 a[92:93], v57 offset:14336
    ds_read_b64_tr_b16 a[94:95], v57 offset:15360
    buffer_store_dwordx4 v[128:131], v67, s[40:43], s68 offen sc1
    s_bfe_u32 s24, s20, 0x10002
    v_mfma_f32_32x32x16_bf16 v[96:111], a[156:159], v[252:255], v[96:111]
    ds_read_b64_tr_b16 a[96:97], v58 offset:0
    ds_read_b64_tr_b16 a[98:99], v58 offset:1024
    ds_read_b64_tr_b16 a[100:101], v58 offset:2048
    v_cvt_pk_bf16_f32 v132, v88, v89
    s_lshl_b32 s24, s24, 6
    s_add_u32 s28, s28, s24
    v_mfma_f32_32x32x16_bf16 v[96:111], a[160:163], a[192:195], v[96:111]
    ds_read_b64_tr_b16 a[102:103], v58 offset:3072
    ds_read_b64_tr_b16 a[104:105], v58 offset:4096
    v_cvt_pk_bf16_f32 v133, v90, v91
    s_and_b32 s24, s20, 1
    s_lshl_b32 s24, s24, 4
    v_mfma_f32_32x32x16_bf16 v[96:111], a[164:167], a[196:199], v[96:111]
    ds_read_b64_tr_b16 a[106:107], v58 offset:5120
    ds_read_b64_tr_b16 a[108:109], v58 offset:6144
    v_cvt_pk_bf16_f32 v134, v92, v93
    s_add_u32 s28, s28, s24
    v_mfma_f32_32x32x16_bf16 v[96:111], a[168:171], a[200:203], v[96:111]
    ds_read_b64_tr_b16 a[110:111], v58 offset:7168
    ds_read_b64_tr_b16 a[112:113], v58 offset:8192
    ds_read_b64_tr_b16 a[114:115], v58 offset:9216
    v_cvt_pk_bf16_f32 v135, v94, v95
    s_sub_u32 s29, s47, 1
    s_cselect_b32 s29, 8, s29
    s_lshl_b32 s29, s29, 7
    v_mfma_f32_32x32x16_bf16 v[96:111], a[172:175], a[204:207], v[96:111]
    ds_read_b64_tr_b16 a[116:117], v58 offset:10240
    ds_read_b64_tr_b16 a[118:119], v58 offset:11264
    buffer_store_dwordx4 v[132:135], v67, s[40:43], s68 offen offset:1024 sc1
    s_and_b32 s24, s44, 1
    v_mfma_f32_32x32x16_bf16 v[96:111], a[176:179], a[208:211], v[96:111]
    ds_read_b64_tr_b16 a[120:121], v58 offset:12288
    ds_read_b64_tr_b16 a[122:123], v58 offset:13312
    s_mul_i32 s24, s24, 36864
    s_add_u32 s29, s29, s24
    v_mfma_f32_32x32x16_bf16 v[96:111], a[180:183], a[212:215], v[96:111]
    ds_read_b64_tr_b16 a[124:125], v58 offset:14336
    ds_read_b64_tr_b16 a[126:127], v58 offset:15360
    s_and_b32 s24, s45, 3
    v_mfma_f32_32x32x16_bf16 v[96:111], a[184:187], a[216:219], v[96:111]
    s_mul_i32 s24, s24, 9216
    s_add_u32 s29, s29, s24
    v_mfma_f32_32x32x16_bf16 v[96:111], a[188:191], a[220:223], v[96:111]
    s_lshr_b32 s24, s44, 1
    s_waitcnt vmcnt(14) lgkmcnt(0)
    s_barrier
    v_mfma_f32_32x32x16_bf16 v[80:95], a[64:67], v[224:227], 0
    ds_read_b64_tr_b16 a[128:129], v57 offset:32768
    ds_read_b64_tr_b16 a[130:131], v57 offset:33792
    ds_read_b64_tr_b16 a[132:133], v57 offset:34816
    s_lshl_b32 s24, s24, 6
    s_add_u32 s29, s29, s24
    v_mfma_f32_32x32x16_bf16 v[80:95], a[68:71], v[228:231], v[80:95]
    ds_read_b64_tr_b16 a[134:135], v57 offset:35840
    ds_read_b64_tr_b16 a[136:137], v57 offset:36864
    s_bfe_u32 s24, s45, 0x10002
    s_lshl_b32 s24, s24, 5
    v_mfma_f32_32x32x16_bf16 v[80:95], a[72:75], v[232:235], v[80:95]
    ds_read_b64_tr_b16 a[138:139], v57 offset:37888
    ds_read_b64_tr_b16 a[140:141], v57 offset:38912
    s_add_u32 s29, s29, s24
    v_mfma_f32_32x32x16_bf16 v[80:95], a[76:79], v[236:239], v[80:95]
    ds_read_b64_tr_b16 a[142:143], v57 offset:39936
    ds_read_b64_tr_b16 a[144:145], v57 offset:40960
    ds_read_b64_tr_b16 a[146:147], v57 offset:41984
    v_cvt_pk_bf16_f32 v136, v96, v97
    v_cvt_pk_bf16_f32 v137, v98, v99
    s_lshr_b32 s24, s45, 3
    s_lshl_b32 s24, s24, 4
    v_mfma_f32_32x32x16_bf16 v[80:95], a[80:83], v[240:243], v[80:95]
    ds_read_b64_tr_b16 a[148:149], v57 offset:43008
    ds_read_b64_tr_b16 a[150:151], v57 offset:44032
    v_cvt_pk_bf16_f32 v138, v100, v101
    s_add_u32 s29, s29, s24
    v_mfma_f32_32x32x16_bf16 v[80:95], a[84:87], v[244:247], v[80:95]
    ds_read_b64_tr_b16 a[152:153], v57 offset:45056
    ds_read_b64_tr_b16 a[154:155], v57 offset:46080
    v_cvt_pk_bf16_f32 v139, v102, v103
    s_lshl_b32 s32, s20, 7
    s_add_u32 s32, s32, 65536
    v_mfma_f32_32x32x16_bf16 v[80:95], a[88:91], v[248:251], v[80:95]
    ds_read_b64_tr_b16 a[156:157], v57 offset:47104
    ds_read_b64_tr_b16 a[158:159], v57 offset:48128
    buffer_store_dwordx4 v[136:139], v67, s[40:43], s69 offen sc1
    s_mov_b32 s22, -1
    v_mfma_f32_32x32x16_bf16 v[80:95], a[92:95], v[252:255], v[80:95]
    ds_read_b64_tr_b16 a[160:161], v58 offset:32768
    ds_read_b64_tr_b16 a[162:163], v58 offset:33792
    ds_read_b64_tr_b16 a[164:165], v58 offset:34816
    v_cvt_pk_bf16_f32 v140, v104, v105
    s_bfe_u32 s24, s20, 0x20001
    s_lshl_b32 s24, s24, 7
    v_mfma_f32_32x32x16_bf16 v[80:95], a[96:99], a[192:195], v[80:95]
    ds_read_b64_tr_b16 a[166:167], v58 offset:35840
    ds_read_b64_tr_b16 a[168:169], v58 offset:36864
    v_cvt_pk_bf16_f32 v141, v106, v107
    s_lshl_b32 s25, s44, 7
    s_sub_u32 s25, s25, s24
    v_mfma_f32_32x32x16_bf16 v[80:95], a[100:103], a[196:199], v[80:95]
    ds_read_b64_tr_b16 a[170:171], v58 offset:37888
    ds_read_b64_tr_b16 a[172:173], v58 offset:38912
    v_cvt_pk_bf16_f32 v142, v108, v109
    v_and_b32 v1, 15, v0
    v_mfma_f32_32x32x16_bf16 v[80:95], a[104:107], a[200:203], v[80:95]
    ds_read_b64_tr_b16 a[174:175], v58 offset:39936
    ds_read_b64_tr_b16 a[176:177], v58 offset:40960
    ds_read_b64_tr_b16 a[178:179], v58 offset:41984
    v_cvt_pk_bf16_f32 v143, v110, v111
    v_lshlrev_b32 v1, 9, v1
    v_add_u32 v1, s24, v1
    v_mfma_f32_32x32x16_bf16 v[80:95], a[108:111], a[204:207], v[80:95]
    ds_read_b64_tr_b16 a[180:181], v58 offset:43008
    ds_read_b64_tr_b16 a[182:183], v58 offset:44032
    buffer_store_dwordx4 v[140:143], v67, s[40:43], s69 offen offset:1024 sc1
    v_bfe_u32 v2, v0, 4, 1
    v_mfma_f32_32x32x16_bf16 v[80:95], a[112:115], a[208:211], v[80:95]
    ds_read_b64_tr_b16 a[184:185], v58 offset:45056
    ds_read_b64_tr_b16 a[186:187], v58 offset:46080
    v_mul_lo_u32 v2, s25, v2
    v_add_u32 v1, v1, v2
    v_mfma_f32_32x32x16_bf16 v[80:95], a[116:119], a[212:215], v[80:95]
    ds_read_b64_tr_b16 a[188:189], v58 offset:47104
    ds_read_b64_tr_b16 a[190:191], v58 offset:48128
    s_mul_i32 s27, s44, 18432
    v_mfma_f32_32x32x16_bf16 v[80:95], a[120:123], a[216:219], v[80:95]
    s_add_u32 s27, s27, 32768
    v_add_u32 v3, s27, v77
    v_mfma_f32_32x32x16_bf16 v[80:95], a[124:127], a[220:223], v[80:95]
    v_and_b32 v2, 31, v0
    s_waitcnt vmcnt(6) lgkmcnt(0)
    s_barrier
    v_mfma_f32_32x32x16_bf16 v[96:111], a[128:131], v[224:227], 0
    ds_read_b64_tr_b16 a[64:65], v59 offset:0
    ds_read_b64_tr_b16 a[66:67], v59 offset:1024
    ds_read_b64_tr_b16 a[68:69], v59 offset:2048
    v_lshlrev_b32 v7, 20, v2
    v_mul_u32_u24 v2, 1152, v2
    v_mfma_f32_32x32x16_bf16 v[96:111], a[132:135], v[228:231], v[96:111]
    ds_read_b64_tr_b16 a[70:71], v59 offset:3072
    ds_read_b64_tr_b16 a[72:73], v59 offset:4096
    v_bfe_u32 v6, v0, 5, 1
    v_lshl_add_u32 v2, v6, 5, v2
    v_mfma_f32_32x32x16_bf16 v[96:111], a[136:139], v[232:235], v[96:111]
    ds_read_b64_tr_b16 a[74:75], v59 offset:5120
    ds_read_b64_tr_b16 a[76:77], v59 offset:6144
    v_mul_u32_u24 v8, 2304, v6
    v_mfma_f32_32x32x16_bf16 v[96:111], a[140:143], v[236:239], v[96:111]
    ds_read_b64_tr_b16 a[78:79], v59 offset:7168
    ds_read_b64_tr_b16 a[80:81], v59 offset:8192
    ds_read_b64_tr_b16 a[82:83], v59 offset:9216
    v_cvt_pk_bf16_f32 v128, v80, v81
    v_cvt_pk_bf16_f32 v129, v82, v83
    v_add_u32 v214, v7, v8
    v_bfe_u32 v7, v0, 3, 3
    v_mfma_f32_32x32x16_bf16 v[96:111], a[144:147], v[240:243], v[96:111]
    ds_read_b64_tr_b16 a[84:85], v59 offset:10240
    ds_read_b64_tr_b16 a[86:87], v59 offset:11264
    v_cvt_pk_bf16_f32 v130, v84, v85
    v_mul_u32_u24 v7, 73728, v7
    v_mfma_f32_32x32x16_bf16 v[96:111], a[148:151], v[244:247], v[96:111]
    ds_read_b64_tr_b16 a[88:89], v59 offset:12288
    ds_read_b64_tr_b16 a[90:91], v59 offset:13312
    v_cvt_pk_bf16_f32 v131, v86, v87
    v_and_b32 v8, 7, v0
    v_lshl_add_u32 v212, v8, 4, v7
    v_mfma_f32_32x32x16_bf16 v[96:111], a[152:155], v[248:251], v[96:111]
    ds_read_b64_tr_b16 a[92:93], v59 offset:14336
    ds_read_b64_tr_b16 a[94:95], v59 offset:15360
    buffer_store_dwordx4 v[128:131], v67, s[40:43], s70 offen sc1
    v_lshlrev_b32 v7, 10, v6
    v_mfma_f32_32x32x16_bf16 v[96:111], a[156:159], v[252:255], v[96:111]
    ds_read_b64_tr_b16 a[96:97], v60 offset:0
    ds_read_b64_tr_b16 a[98:99], v60 offset:1024
    ds_read_b64_tr_b16 a[100:101], v60 offset:2048
    v_cvt_pk_bf16_f32 v132, v88, v89
    v_bfe_u32 v8, v0, 2, 2
    v_lshl_add_u32 v7, v8, 7, v7
    v_mfma_f32_32x32x16_bf16 v[96:111], a[160:163], a[192:195], v[96:111]
    ds_read_b64_tr_b16 a[102:103], v60 offset:3072
    ds_read_b64_tr_b16 a[104:105], v60 offset:4096
    v_cvt_pk_bf16_f32 v133, v90, v91
    v_and_b32 v8, 1, v0
    v_lshl_add_u32 v7, v8, 5, v7
    v_mfma_f32_32x32x16_bf16 v[96:111], a[164:167], a[196:199], v[96:111]
    ds_read_b64_tr_b16 a[106:107], v60 offset:5120
    ds_read_b64_tr_b16 a[108:109], v60 offset:6144
    v_cvt_pk_bf16_f32 v134, v92, v93
    v_bfe_u32 v8, v0, 4, 1
    v_mfma_f32_32x32x16_bf16 v[96:111], a[168:171], a[200:203], v[96:111]
    ds_read_b64_tr_b16 a[110:111], v60 offset:7168
    ds_read_b64_tr_b16 a[112:113], v60 offset:8192
    ds_read_b64_tr_b16 a[114:115], v60 offset:9216
    v_cvt_pk_bf16_f32 v135, v94, v95
    v_lshl_add_u32 v7, v8, 4, v7
    v_bfe_u32 v8, v0, 1, 1
    v_mfma_f32_32x32x16_bf16 v[96:111], a[172:175], a[204:207], v[96:111]
    ds_read_b64_tr_b16 a[116:117], v60 offset:10240
    ds_read_b64_tr_b16 a[118:119], v60 offset:11264
    buffer_store_dwordx4 v[132:135], v67, s[40:43], s70 offen offset:1024 sc1
    v_lshl_add_u32 v7, v8, 3, v7
    v_mfma_f32_32x32x16_bf16 v[96:111], a[176:179], a[208:211], v[96:111]
    ds_read_b64_tr_b16 a[120:121], v60 offset:12288
    ds_read_b64_tr_b16 a[122:123], v60 offset:13312
    v_add_u32 v213, s27, v7
    s_mov_b32 s21, 200000
    v_mfma_f32_32x32x16_bf16 v[96:111], a[180:183], a[212:215], v[96:111]
    ds_read_b64_tr_b16 a[124:125], v60 offset:14336
    ds_read_b64_tr_b16 a[126:127], v60 offset:15360
    v_mov_b32 v112, 0x3f803f80
    v_mfma_f32_32x32x16_bf16 v[96:111], a[184:187], a[216:219], v[96:111]
    v_mov_b32 v113, 0x3f803f80
    v_mov_b32 v114, 0x3f803f80
    v_mfma_f32_32x32x16_bf16 v[96:111], a[188:191], a[220:223], v[96:111]
    v_mov_b32 v115, 0x3f803f80
    s_waitcnt lgkmcnt(14)
    v_mfma_f32_32x32x16_bf16 v[80:95], a[64:67], v[224:227], 0
    v_mfma_f32_32x32x16_bf16 v[80:95], a[68:71], v[228:231], v[80:95]
    v_mfma_f32_32x32x16_bf16 v[80:95], a[72:75], v[232:235], v[80:95]
    v_mfma_f32_32x32x16_bf16 v[80:95], a[76:79], v[236:239], v[80:95]
    s_nop 5
    v_cvt_pk_bf16_f32 v136, v96, v97
    v_cvt_pk_bf16_f32 v137, v98, v99
    v_mfma_f32_32x32x16_bf16 v[80:95], a[80:83], v[240:243], v[80:95]
    v_cvt_pk_bf16_f32 v138, v100, v101
    v_mfma_f32_32x32x16_bf16 v[80:95], a[84:87], v[244:247], v[80:95]
    v_cvt_pk_bf16_f32 v139, v102, v103
    v_mfma_f32_32x32x16_bf16 v[80:95], a[88:91], v[248:251], v[80:95]
    buffer_store_dwordx4 v[136:139], v67, s[40:43], s71 offen sc1
    v_mfma_f32_32x32x16_bf16 v[80:95], a[92:95], v[252:255], v[80:95]
    v_cvt_pk_bf16_f32 v140, v104, v105
    v_mfma_f32_32x32x16_bf16 v[80:95], a[96:99], a[192:195], v[80:95]
    v_cvt_pk_bf16_f32 v141, v106, v107
    s_waitcnt lgkmcnt(12)
    v_mfma_f32_32x32x16_bf16 v[80:95], a[100:103], a[196:199], v[80:95]
    v_cvt_pk_bf16_f32 v142, v108, v109
    s_waitcnt lgkmcnt(10)
    v_mfma_f32_32x32x16_bf16 v[80:95], a[104:107], a[200:203], v[80:95]
    v_cvt_pk_bf16_f32 v143, v110, v111
    s_waitcnt lgkmcnt(8)
    v_mfma_f32_32x32x16_bf16 v[80:95], a[108:111], a[204:207], v[80:95]
    buffer_store_dwordx4 v[140:143], v67, s[40:43], s71 offen offset:1024 sc1
    s_waitcnt lgkmcnt(6)
    v_mfma_f32_32x32x16_bf16 v[80:95], a[112:115], a[208:211], v[80:95]
    s_waitcnt lgkmcnt(4)
    v_mfma_f32_32x32x16_bf16 v[80:95], a[116:119], a[212:215], v[80:95]
    s_waitcnt lgkmcnt(2)
    v_mfma_f32_32x32x16_bf16 v[80:95], a[120:123], a[216:219], v[80:95]
    s_waitcnt lgkmcnt(0)
    v_mfma_f32_32x32x16_bf16 v[80:95], a[124:127], a[220:223], v[80:95]
    s_nop 11
    v_cvt_pk_bf16_f32 v128, v80, v81
    v_cvt_pk_bf16_f32 v129, v82, v83
    v_cvt_pk_bf16_f32 v130, v84, v85
    v_cvt_pk_bf16_f32 v131, v86, v87
    buffer_store_dwordx4 v[128:131], v67, s[40:43], s72 offen sc1
    v_cvt_pk_bf16_f32 v132, v88, v89
    v_cvt_pk_bf16_f32 v133, v90, v91
    v_cvt_pk_bf16_f32 v134, v92, v93
    v_cvt_pk_bf16_f32 v135, v94, v95
    buffer_store_dwordx4 v[132:135], v67, s[40:43], s72 offen offset:1024 sc1
    s_lshl_b32 s22, 1, s45
    s_andn2_b32 s22, 0xffff, s22
    v_and_b32 v1, 15, v0
    v_lshlrev_b32 v1, 9, v1
    s_cmp_lg_u32 s44, 0
    s_cbranch_scc1 L_w123
    buffer_load_dwordx2 v[4:5], v1, s[80:83], 0 offen sc1
    s_waitcnt vmcnt(0)
    s_barrier
    v_cmp_ne_u64 vcc, v[4:5], v[74:75]
    s_nop 0
    s_and_b32 s23, vcc_lo, s22
    s_cbranch_scc0 L_rel
L_poll:
    buffer_load_dwordx2 v[4:5], v1, s[80:83], 0 offen sc1
    s_waitcnt vmcnt(0)
    v_cmp_ne_u64 vcc, v[4:5], v[74:75]
    s_nop 0
    s_and_b32 s23, vcc_lo, s22
    s_cbranch_scc0 L_rel
    s_sub_u32 s21, s21, 1
    s_cbranch_scc0 L_poll
    s_branch L_rel
L_w123:
    s_waitcnt vmcnt(0)
    s_barrier
    s_cmp_lg_u32 s44, 1
    s_cbranch_scc1 L_nopub
    v_subrev_u32 v76, 128, v76
    buffer_store_dwordx2 v[74:75], v76, s[80:83], 0 offen sc1
L_nopub:
L_rel:
    s_barrier
    s_add_u32 m0, s27, 16384
    s_add_u32 s25, s32, 588800
    buffer_load_dwordx4 v212, s[84:87], s32 offen sc1 lds
    buffer_load_dwordx4 v212, s[84:87], s25 offen offset:1024 sc1 lds
    buffer_load_dwordx4 a[0:3], v77, s[84:87], s26 offen sc1
    s_add_u32 s26, s26, 73728
    buffer_load_dwordx4 a[4:7], v77, s[84:87], s26 offen sc1
    s_add_u32 s26, s26, 73728
    buffer_load_dwordx4 a[8:11], v77, s[84:87], s26 offen sc1
    s_add_u32 s26, s26, 73728
    buffer_load_dwordx4 a[12:15], v77, s[84:87], s26 offen sc1
    s_add_u32 s26, s26, 73728
    buffer_load_dwordx4 a[16:19], v77, s[84:87], s26 offen sc1
    s_add_u32 s26, s26, 73728
    buffer_load_dwordx4 a[20:23], v77, s[84:87], s26 offen sc1
    s_add_u32 s26, s26, 73728
    buffer_load_dwordx4 a[24:27], v77, s[84:87], s26 offen sc1
    s_add_u32 s26, s26, 73728
    buffer_load_dwordx4 a[28:31], v77, s[84:87], s26 offen sc1
    s_add_u32 s26, s26, 73728
    buffer_load_dwordx4 a[32:35], v77, s[84:87], s26 offen sc1
    s_add_u32 s26, s26, 73728
    buffer_load_dwordx4 a[36:39], v77, s[84:87], s26 offen sc1
    s_add_u32 s26, s26, 73728
    buffer_load_dwordx4 a[40:43], v77, s[84:87], s26 offen sc1
    s_add_u32 s26, s26, 73728
    buffer_load_dwordx4 a[44:47], v77, s[84:87], s26 offen sc1
    s_add_u32 s26, s26, 73728
    buffer_load_dwordx4 a[48:51], v77, s[84:87], s26 offen sc1
    s_add_u32 s26, s26, 73728
    buffer_load_dwordx4 a[52:55], v77, s[84:87], s26 offen sc1
    s_add_u32 s26, s26, 73728
    buffer_load_dwordx4 a[56:59], v77, s[84:87], s26 offen sc1
    s_add_u32 s26, s26, 73728
    buffer_load_dwordx4 a[60:63], v77, s[84:87], s26 offen sc1
    s_waitcnt vmcnt(16)
    ds_read_b64_tr_b16 a[64:65], v213 offset:16384
    ds_read_b64_tr_b16 a[66:67], v213 offset:16896
    ds_read_b64_tr_b16 a[68:69], v213 offset:16448
    ds_read_b64_tr_b16 a[70:71], v213 offset:16960
    s_waitcnt lgkmcnt(2)
    v_mfma_f32_32x32x16_bf16 v[144:159], a[64:67], v[112:115], 0
    s_waitcnt lgkmcnt(0)
    v_mfma_f32_32x32x16_bf16 v[160:175], a[68:71], v[112:115], 0
    s_add_u32 s24, s29, 4608
    s_waitcnt vmcnt(15)
    v_mfma_f32_32x32x16_bf16 v[80:95], a[244:247], a[0:3], 0
    s_waitcnt vmcnt(14)
    v_mfma_f32_32x32x16_bf16 v[80:95], a[244:247], a[4:7], v[80:95]
    s_waitcnt vmcnt(13)
    v_mfma_f32_32x32x16_bf16 v[80:95], a[244:247], a[8:11], v[80:95]
    s_waitcnt vmcnt(12)
    v_mfma_f32_32x32x16_bf16 v[80:95], a[244:247], a[12:15], v[80:95]
    s_waitcnt vmcnt(11)
    v_mfma_f32_32x32x16_bf16 v[80:95], a[244:247], a[16:19], v[80:95]
    s_waitcnt vmcnt(10)
    v_mfma_f32_32x32x16_bf16 v[80:95], a[244:247], a[20:23], v[80:95]
    v_cvt_pk_bf16_f32 v176, v144, v145
    v_cvt_pk_bf16_f32 v177, v146, v147
    s_waitcnt vmcnt(9)
    v_mfma_f32_32x32x16_bf16 v[80:95], a[244:247], a[24:27], v[80:95]
    v_cvt_pk_bf16_f32 v178, v148, v149
    v_cvt_pk_bf16_f32 v179, v150, v151
    s_waitcnt vmcnt(8)
    v_mfma_f32_32x32x16_bf16 v[80:95], a[244:247], a[28:31], v[80:95]
    v_cvt_pk_bf16_f32 v180, v152, v153
    v_cvt_pk_bf16_f32 v181, v154, v155
    s_waitcnt vmcnt(7)
    v_mfma_f32_32x32x16_bf16 v[80:95], a[244:247], a[32:35], v[80:95]
    v_cvt_pk_bf16_f32 v182, v156, v157
    v_cvt_pk_bf16_f32 v183, v158, v159
    s_waitcnt vmcnt(6)
    v_mfma_f32_32x32x16_bf16 v[80:95], a[244:247], a[36:39], v[80:95]
    v_cvt_pk_bf16_f32 v184, v160, v161
    v_cvt_pk_bf16_f32 v185, v162, v163
    s_waitcnt vmcnt(5)
    v_mfma_f32_32x32x16_bf16 v[80:95], a[244:247], a[40:43], v[80:95]
    v_cvt_pk_bf16_f32 v186, v164, v165
    v_cvt_pk_bf16_f32 v187, v166, v167
    s_waitcnt vmcnt(4)
    v_mfma_f32_32x32x16_bf16 v[80:95], a[244:247], a[44:47], v[80:95]
    v_cvt_pk_bf16_f32 v188, v168, v169
    v_cvt_pk_bf16_f32 v189, v170, v171
    s_waitcnt vmcnt(3)
    v_mfma_f32_32x32x16_bf16 v[80:95], a[244:247], a[48:51], v[80:95]
    v_cvt_pk_bf16_f32 v190, v172, v173
    v_cvt_pk_bf16_f32 v191, v174, v175
    s_waitcnt vmcnt(2)
    v_mfma_f32_32x32x16_bf16 v[80:95], a[244:247], a[52:55], v[80:95]
    s_waitcnt vmcnt(1)
    v_mfma_f32_32x32x16_bf16 v[80:95], a[244:247], a[56:59], v[80:95]
    s_waitcnt vmcnt(0)
    v_mfma_f32_32x32x16_bf16 v[80:95], a[244:247], a[60:63], v[80:95]
    buffer_store_dwordx4 v[176:179], v214, s[88:91], s29 offen offset:0
    buffer_store_dwordx4 v[180:183], v214, s[88:91], s29 offen offset:1152
    buffer_store_dwordx4 v[184:187], v214, s[88:91], s24 offen offset:0
    buffer_store_dwordx4 v[188:191], v214, s[88:91], s24 offen offset:1152
    s_nop 7
    v_cvt_pk_bf16_f32 v128, v80, v81
    v_cvt_pk_bf16_f32 v129, v82, v83
    v_cvt_pk_bf16_f32 v130, v84, v85
    v_cvt_pk_bf16_f32 v131, v86, v87
    buffer_store_dwordx4 v[128:131], v2, s[88:91], s28 offen
L_done:
L_end:
    s_endpgm
L_epoch_spin:
    s_mov_b32 s3, 200000
    v_mov_b32 v1, 0
L_epoch_loop:
    buffer_load_dwordx2 v[74:75], v1, s[92:95], 0 offen sc1
    s_sub_u32 s3, s3, 1
    s_cbranch_scc1 L_epoch_ok
    s_waitcnt vmcnt(0)
    v_or_b32 v2, v74, v75
    v_cmp_eq_u32 vcc, 0, v2
    s_cbranch_vccnz L_epoch_loop
    s_branch L_epoch_ok
L_stubB1:
    s_call_b64 s[50:51], L_rescale
    s_branch L_backB1
L_stubB2:
    s_call_b64 s[50:51], L_rescale
    s_branch L_backB2
L_stubB3:
    s_call_b64 s[50:51], L_rescale
    s_branch L_backB3
L_stubB4:
    s_call_b64 s[50:51], L_rescale
    s_branch L_backB4
L_stubB5:
    s_call_b64 s[50:51], L_rescale
    s_branch L_backB5
L_stubB6:
    s_call_b64 s[50:51], L_rescale
    s_branch L_backB6
L_stubB7:
    s_call_b64 s[50:51], L_rescale
    s_branch L_backB7
L_stubB8:
    s_call_b64 s[50:51], L_rescale
    s_branch L_backB8
L_stubB9:
    s_call_b64 s[50:51], L_rescale
    s_branch L_backB9
L_stubB10:
    s_call_b64 s[50:51], L_rescale
    s_branch L_backB10
L_stubB11:
    s_call_b64 s[50:51], L_rescale
    s_branch L_backB11
L_stubB12:
    s_call_b64 s[50:51], L_rescale
    s_branch L_backB12
L_stubB13:
    s_call_b64 s[50:51], L_rescale
    s_branch L_backB13
L_stubB14:
    s_call_b64 s[50:51], L_rescale
    s_branch L_backB14
L_stubB15:
    s_call_b64 s[50:51], L_rescale
    s_branch L_backB15
L_stubA1:
    s_call_b64 s[50:51], L_rescale
    s_branch L_backA1
L_stubA2:
    s_call_b64 s[50:51], L_rescale
    s_branch L_backA2
L_stubA3:
    s_call_b64 s[50:51], L_rescale
    s_branch L_backA3
L_stubA4:
    s_call_b64 s[50:51], L_rescale
    s_branch L_backA4
L_stubA5:
    s_call_b64 s[50:51], L_rescale
    s_branch L_backA5
L_stubA6:
    s_call_b64 s[50:51], L_rescale
    s_branch L_backA6
L_stubA7:
    s_call_b64 s[50:51], L_rescale
    s_branch L_backA7
L_stubA8:
    s_call_b64 s[50:51], L_rescale
    s_branch L_backA8
L_stubA9:
    s_call_b64 s[50:51], L_rescale
    s_branch L_backA9
L_stubA10:
    s_call_b64 s[50:51], L_rescale
    s_branch L_backA10
L_stubA11:
    s_call_b64 s[50:51], L_rescale
    s_branch L_backA11
L_stubA12:
    s_call_b64 s[50:51], L_rescale
    s_branch L_backA12
L_stubA13:
    s_call_b64 s[50:51], L_rescale
    s_branch L_backA13
L_stubA14:
    s_call_b64 s[50:51], L_rescale
    s_branch L_backA14
L_stubA15:
    s_call_b64 s[50:51], L_rescale
    s_branch L_backA15
L_rescale:
    s_nop 15
    s_nop 15
    v_mov_b32 v69, v68
    s_nop 1
    v_permlane32_swap_b32 v68, v69
    v_max3_f32 v68, v68, v69, 0
    v_ceil_f32 v68, v68
    v_exp_f32 v69, -v68
    v_sub_f32 v80, v80, v68
    v_sub_f32 v81, v81, v68
    v_sub_f32 v82, v82, v68
    v_sub_f32 v83, v83, v68
    v_sub_f32 v84, v84, v68
    v_sub_f32 v85, v85, v68
    v_sub_f32 v86, v86, v68
    v_sub_f32 v87, v87, v68
    v_sub_f32 v88, v88, v68
    v_sub_f32 v89, v89, v68
    v_sub_f32 v90, v90, v68
    v_sub_f32 v91, v91, v68
    v_sub_f32 v92, v92, v68
    v_sub_f32 v93, v93, v68
    v_sub_f32 v94, v94, v68
    v_sub_f32 v95, v95, v68
    v_sub_f32 v96, v96, v68
    v_sub_f32 v97, v97, v68
    v_sub_f32 v98, v98, v68
    v_sub_f32 v99, v99, v68
    v_sub_f32 v100, v100, v68
    v_sub_f32 v101, v101, v68
    v_sub_f32 v102, v102, v68
    v_sub_f32 v103, v103, v68
    v_sub_f32 v104, v104, v68
    v_sub_f32 v105, v105, v68
    v_sub_f32 v106, v106, v68
    v_sub_f32 v107, v107, v68
    v_sub_f32 v108, v108, v68
    v_sub_f32 v109, v109, v68
    v_sub_f32 v110, v110, v68
    v_sub_f32 v111, v111, v68
    v_sub_f32 v112, v112, v68
    v_sub_f32 v113, v113, v68
    v_sub_f32 v114, v114, v68
    v_sub_f32 v115, v115, v68
    v_sub_f32 v116, v116, v68
    v_sub_f32 v117, v117, v68
    v_sub_f32 v118, v118, v68
    v_sub_f32 v119, v119, v68
    v_sub_f32 v120, v120, v68
    v_sub_f32 v121, v121, v68
    v_sub_f32 v122, v122, v68
    v_sub_f32 v123, v123, v68
    v_sub_f32 v124, v124, v68
    v_sub_f32 v125, v125, v68
    v_sub_f32 v126, v126, v68
    v_sub_f32 v127, v127, v68
    v_mul_f32 v144, v144, v69
    v_mul_f32 v145, v145, v69
    v_mul_f32 v146, v146, v69
    v_mul_f32 v147, v147, v69
    v_mul_f32 v148, v148, v69
    v_mul_f32 v149, v149, v69
    v_mul_f32 v150, v150, v69
    v_mul_f32 v151, v151, v69
    v_mul_f32 v152, v152, v69
    v_mul_f32 v153, v153, v69
    v_mul_f32 v154, v154, v69
    v_mul_f32 v155, v155, v69
    v_mul_f32 v156, v156, v69
    v_mul_f32 v157, v157, v69
    v_mul_f32 v158, v158, v69
    v_mul_f32 v159, v159, v69
    v_mul_f32 v160, v160, v69
    v_mul_f32 v161, v161, v69
    v_mul_f32 v162, v162, v69
    v_mul_f32 v163, v163, v69
    v_mul_f32 v164, v164, v69
    v_mul_f32 v165, v165, v69
    v_mul_f32 v166, v166, v69
    v_mul_f32 v167, v167, v69
    v_mul_f32 v168, v168, v69
    v_mul_f32 v169, v169, v69
    v_mul_f32 v170, v170, v69
    v_mul_f32 v171, v171, v69
    v_mul_f32 v172, v172, v69
    v_mul_f32 v173, v173, v69
    v_mul_f32 v174, v174, v69
    v_mul_f32 v175, v175, v69
    v_mul_f32 v176, v176, v69
    v_mul_f32 v177, v177, v69
    v_mul_f32 v178, v178, v69
    v_mul_f32 v179, v179, v69
    v_mul_f32 v180, v180, v69
    v_mul_f32 v181, v181, v69
    v_mul_f32 v182, v182, v69
    v_mul_f32 v183, v183, v69
    v_mul_f32 v184, v184, v69
    v_mul_f32 v185, v185, v69
    v_mul_f32 v186, v186, v69
    v_mul_f32 v187, v187, v69
    v_mul_f32 v188, v188, v69
    v_mul_f32 v189, v189, v69
    v_mul_f32 v190, v190, v69
    v_mul_f32 v191, v191, v69
    v_mul_f32 v192, v192, v69
    v_mul_f32 v193, v193, v69
    v_mul_f32 v194, v194, v69
    v_mul_f32 v195, v195, v69
    v_mul_f32 v196, v196, v69
    v_mul_f32 v197, v197, v69
    v_mul_f32 v198, v198, v69
    v_mul_f32 v199, v199, v69
    v_mul_f32 v200, v200, v69
    v_mul_f32 v201, v201, v69
    v_mul_f32 v202, v202, v69
    v_mul_f32 v203, v203, v69
    v_mul_f32 v204, v204, v69
    v_mul_f32 v205, v205, v69
    v_mul_f32 v206, v206, v69
    v_mul_f32 v207, v207, v69
    v_mul_f32 v208, v208, v69
    v_mul_f32 v209, v209, v69
    v_mul_f32 v210, v210, v69
    v_mul_f32 v211, v211, v69
    v_lshlrev_b32 v2, 16, v128
    v_and_b32 v3, 0xffff0000, v128
    v_mul_f32 v2, v2, v69
    v_mul_f32 v3, v3, v69
    v_cvt_pk_bf16_f32 v128, v2, v3
    v_lshlrev_b32 v2, 16, v129
    v_and_b32 v3, 0xffff0000, v129
    v_mul_f32 v2, v2, v69
    v_mul_f32 v3, v3, v69
    v_cvt_pk_bf16_f32 v129, v2, v3
    v_lshlrev_b32 v2, 16, v130
    v_and_b32 v3, 0xffff0000, v130
    v_mul_f32 v2, v2, v69
    v_mul_f32 v3, v3, v69
    v_cvt_pk_bf16_f32 v130, v2, v3
    v_lshlrev_b32 v2, 16, v131
    v_and_b32 v3, 0xffff0000, v131
    v_mul_f32 v2, v2, v69
    v_mul_f32 v3, v3, v69
    v_cvt_pk_bf16_f32 v131, v2, v3
    v_lshlrev_b32 v2, 16, v132
    v_and_b32 v3, 0xffff0000, v132
    v_mul_f32 v2, v2, v69
    v_mul_f32 v3, v3, v69
    v_cvt_pk_bf16_f32 v132, v2, v3
    v_lshlrev_b32 v2, 16, v133
    v_and_b32 v3, 0xffff0000, v133
    v_mul_f32 v2, v2, v69
    v_mul_f32 v3, v3, v69
    v_cvt_pk_bf16_f32 v133, v2, v3
    v_lshlrev_b32 v2, 16, v134
    v_and_b32 v3, 0xffff0000, v134
    v_mul_f32 v2, v2, v69
    v_mul_f32 v3, v3, v69
    v_cvt_pk_bf16_f32 v134, v2, v3
    v_lshlrev_b32 v2, 16, v135
    v_and_b32 v3, 0xffff0000, v135
    v_mul_f32 v2, v2, v69
    v_mul_f32 v3, v3, v69
    v_cvt_pk_bf16_f32 v135, v2, v3
    v_lshlrev_b32 v2, 16, v136
    v_and_b32 v3, 0xffff0000, v136
    v_mul_f32 v2, v2, v69
    v_mul_f32 v3, v3, v69
    v_cvt_pk_bf16_f32 v136, v2, v3
    v_lshlrev_b32 v2, 16, v137
    v_and_b32 v3, 0xffff0000, v137
    v_mul_f32 v2, v2, v69
    v_mul_f32 v3, v3, v69
    v_cvt_pk_bf16_f32 v137, v2, v3
    v_lshlrev_b32 v2, 16, v138
    v_and_b32 v3, 0xffff0000, v138
    v_mul_f32 v2, v2, v69
    v_mul_f32 v3, v3, v69
    v_cvt_pk_bf16_f32 v138, v2, v3
    v_lshlrev_b32 v2, 16, v139
    v_and_b32 v3, 0xffff0000, v139
    v_mul_f32 v2, v2, v69
    v_mul_f32 v3, v3, v69
    v_cvt_pk_bf16_f32 v139, v2, v3
    v_lshlrev_b32 v2, 16, v140
    v_and_b32 v3, 0xffff0000, v140
    v_mul_f32 v2, v2, v69
    v_mul_f32 v3, v3, v69
    v_cvt_pk_bf16_f32 v140, v2, v3
    v_lshlrev_b32 v2, 16, v141
    v_and_b32 v3, 0xffff0000, v141
    v_mul_f32 v2, v2, v69
    v_mul_f32 v3, v3, v69
    v_cvt_pk_bf16_f32 v141, v2, v3
    v_lshlrev_b32 v2, 16, v142
    v_and_b32 v3, 0xffff0000, v142
    v_mul_f32 v2, v2, v69
    v_mul_f32 v3, v3, v69
    v_cvt_pk_bf16_f32 v142, v2, v3
    v_lshlrev_b32 v2, 16, v143
    v_and_b32 v3, 0xffff0000, v143
    v_mul_f32 v2, v2, v69
    v_mul_f32 v3, v3, v69
    v_cvt_pk_bf16_f32 v143, v2, v3
    s_nop 3
    s_setpc_b64 s[50:51]
L_textend:
.section .rodata,"a"
.p2align 6
.amdhsa_kernel standalone__gqa_block_cached__near_ridge_kernel
  .amdhsa_next_free_vgpr 512
  .amdhsa_next_free_sgpr 102
  .amdhsa_accum_offset 256
  .amdhsa_group_segment_fixed_size 0
  .amdhsa_kernarg_size 64
  .amdhsa_user_sgpr_count 2
  .amdhsa_user_sgpr_kernarg_segment_ptr 1
  .amdhsa_system_sgpr_workgroup_id_x 1
.end_amdhsa_kernel
```
